```python
import torch

def _softmax(x, axis=-1):
    return torch.softmax(x, dim=axis)
def _gelu(x):
    return torch.nn.functional.gelu(x, approximate="tanh")
def _silu(x):
    return torch.nn.functional.silu(x)
def _sigmoid(x):
    return torch.sigmoid(x)
def _layernorm(x, axis=-1, eps=1e-5):
    m = x.mean(dim=axis, keepdim=True)
    v = x.var(dim=axis, keepdim=True, unbiased=False)
    return (x - m) / torch.sqrt(v + eps)
def _scatter_add(tgt, idx, src, axis=0):
    return tgt.clone().index_add_(axis, idx, src)
def _segment_sum(src, seg, n):
    out = torch.zeros((n,) + src.shape[1:], dtype=src.dtype)
    return out.index_add_(0, seg, src)
def _pad(x, pw):
    flat = tuple(v for pair in reversed(pw) for v in pair)
    return torch.nn.functional.pad(x, flat)

kernel_name = 'parallel_sum__sliding_local_dilated__mixer_s_mlp__prompt'

def setup_inputs():

    _w = (lambda a: (lambda t: t.to(torch.bfloat16) if t.is_floating_point() else t)(torch.as_tensor(a)))
    def _A_setup():
        B, S, D = 1, 2048, 576
        return {
            "x": _w((lambda *s: torch.randn(*s, dtype=torch.bfloat16) * 0.05)(B, S, D)),
            "wqkv": _w((lambda *s: torch.randn(*s, dtype=torch.bfloat16) * 0.1)(D, 3 * D)),
            "wo": _w((lambda *s: torch.randn(*s, dtype=torch.bfloat16) * 0.05)(D, D)),
        }
    _A_in = _A_setup()

    def _B_setup():
        B, S, D, F = 1, 2048, 576, 4608
        return {
            "x":  _w((lambda *s: torch.randn(*s, dtype=torch.bfloat16) * 0.05)(B, S, D)),
            "w1": _w((lambda *s: torch.randn(*s, dtype=torch.bfloat16) * 3.2)(D, D) * (D ** -0.5)),
            "w2": _w((lambda *s: torch.randn(*s, dtype=torch.bfloat16) * 3.2)(D, D) * (D ** -0.5)),
            "w3": _w((lambda *s: torch.randn(*s, dtype=torch.bfloat16) * 3.2)(D, F) * (D ** -0.5)),
            "w4": _w((lambda *s: torch.randn(*s, dtype=torch.bfloat16) * 3.2)(F, D) * (F ** -0.5)),
        }
    _B_in = _B_setup()

    return {
        "A_x": _A_in["x"],
        "A_wqkv": _A_in["wqkv"],
        "A_wo": _A_in["wo"],
        "B_x": _B_in["x"],
        "B_w1": _B_in["w1"],
        "B_w2": _B_in["w2"],
        "B_w3": _B_in["w3"],
        "B_w4": _B_in["w4"],
    }

def reference(A_x, A_wqkv, A_wo, B_x, B_w1, B_w2, B_w3, B_w4):
    def _A_ref(x, wqkv, wo):
        B, S, D = x.shape
        H = 32; Dh = D // H
        W, dil = 8, 2
        qkv = (lambda x, *d: x.permute(*d))((x @ wqkv).reshape(B, S, 3, H, Dh), 2, 0, 3, 1, 4)
        q, k, v = qkv[0], qkv[1], qkv[2]
        scale = Dh ** -0.5
        pos = torch.arange(S)
        off = torch.arange(W) * dil
        idx = pos[:, None] - off[None, :]
        mask = idx >= 0
        idx_c = torch.where(mask, idx, 0).reshape(-1)
        kg = k[:, :, idx_c, :].reshape(B, H, S, W, Dh)
        vg = v[:, :, idx_c, :].reshape(B, H, S, W, Dh)
        logits = torch.einsum("bhsd,bhswd->bhsw", q, kg) * scale
        logits = torch.where(mask[None, None, :, :], logits, -1e9)
        attn = _softmax(logits, axis=-1)
        o = torch.einsum("bhsw,bhswd->bhsd", attn, vg)
        return (lambda x, *d: x.permute(*d))(o, 0, 2, 1, 3).reshape(B, S, D) @ wo

    def _B_ref(x, w1, w2, w3, w4):
        B, S, D = x.shape
        h = _gelu(_layernorm(x, axis=-1) @ w1)
        c = D // 4
        g0 = _pad(h[:, :, 0*c:1*c], ((0, 0), (1, 0), (0, 0)))[:, :S, :]
        g1 = _pad(h[:, :, 1*c:2*c], ((0, 0), (0, 1), (0, 0)))[:, 1:, :]
        g2 = _pad(h[:, :, 2*c:3*c], ((0, 0), (2, 0), (0, 0)))[:, :S, :]
        g3 = _pad(h[:, :, 3*c:   ], ((0, 0), (0, 2), (0, 0)))[:, 2:, :]
        hs = torch.concatenate([g0, g1, g2, g3], axis=-1) @ w2
        x1 = x + hs
        h2 = _gelu(_layernorm(x1, axis=-1) @ w3) @ w4
        return x1 + h2

    x = A_x
    xn = _layernorm(x, axis=-1)
    return x + _A_ref(xn, A_wqkv, A_wo) + _B_ref(xn, B_w1, B_w2, B_w3, B_w4)
```

```asm
; @launch grid=(256,1,1) block=(256,1,1) lds=163840
.amdgcn_target "amdgcn-amd-amdhsa--gfx950"
.text
.p2align 12
.globl parallel_sum__sliding_local_dilated__mixer_s_mlp__prompt_kernel
.p2align 8
.type parallel_sum__sliding_local_dilated__mixer_s_mlp__prompt_kernel,@function
parallel_sum__sliding_local_dilated__mixer_s_mlp__prompt_kernel:
  s_cmp_ge_u32 s2, 256
  s_cbranch_scc0 M_go
  s_endpgm
M_go:
  s_load_dwordx2 s[8:9], s[0:1], 0
  s_load_dwordx4 s[40:43], s[0:1], 8
  s_load_dwordx8 s[44:51], s[0:1], 32
  s_load_dwordx4 s[52:55], s[0:1], 64
  s_load_dwordx2 s[12:13], s[0:1], 80
  v_lshrrev_b32 v1, 6, v0
  v_mov_b32 v4, v0
  v_readfirstlane_b32 s24, v1
  v_and_b32 v0, 63, v0
  s_and_b32 s22, s2, 7
  s_lshr_b32 s39, s2, 3
  s_lshr_b32 s26, s22, 2
  s_mul_i32 s26, s26, 16
  s_lshr_b32 s37, s39, 1
  s_add_u32 s26, s26, s37
  s_mul_i32 s31, s26, 73728
  s_mul_i32 s58, s24, 18432
  s_add_u32 s63, s31, s58
  s_add_u32 s64, s63, 9216
  v_lshrrev_b32 v2, 4, v0
  v_lshrrev_b32 v26, 3, v0
  v_mul_u32_u24 v26, 1152, v26
  v_xor_b32 v27, v2, v0
  v_and_b32 v27, 7, v27
  v_lshl_add_u32 v11, v27, 4, v26
  v_xor_b32 v12, 64, v11
  s_mov_b32 s14, 18432
  s_mov_b32 s15, 0x20000
  s_lshl_b32 s3, s2, 8
  v_add_lshl_u32 v36, v4, s3, 4
  v_mov_b32 v32, 0
  v_mov_b32 v33, 0
  v_mov_b32 v34, 0
  v_mov_b32 v35, 0
  s_mov_b32 s10, 2359296
  s_mov_b32 s11, 0x20000
  s_waitcnt lgkmcnt(0)
  s_add_u32 m0, s58, 0
  s_nop 0
  buffer_load_dwordx4 v11, s[8:11], s63 offen offset:0 lds
  s_add_u32 m0, s58, 9216
  s_nop 0
  buffer_load_dwordx4 v12, s[8:11], s64 offen offset:0 lds
  buffer_store_dwordx4 v[32:35], v36, s[12:15], 0 offen sc1
  s_add_u32 m0, s58, 896
  s_nop 0
  buffer_load_dwordx4 v11, s[8:11], s63 offen offset:128 lds
  s_add_u32 m0, s58, 10112
  s_nop 0
  buffer_load_dwordx4 v12, s[8:11], s64 offen offset:128 lds
  s_add_u32 m0, s58, 1792
  s_nop 0
  buffer_load_dwordx4 v11, s[8:11], s63 offen offset:256 lds
  s_add_u32 m0, s58, 11008
  s_nop 0
  buffer_load_dwordx4 v12, s[8:11], s64 offen offset:256 lds
  s_getpc_b64 s[60:61]
PC_HERE:
  s_mul_i32 s3, s39, 13
  v_min_u32 v27, 12, v4
  v_add_lshl_u32 v27, v27, s3, 7
  v_min_u32 v27, CODE_END-PC_HERE, v27
  global_load_dword a255, v27, s[60:61]
  s_add_u32 m0, s58, 2688
  s_nop 0
  buffer_load_dwordx4 v11, s[8:11], s63 offen offset:384 lds
  s_add_u32 m0, s58, 11904
  s_nop 0
  buffer_load_dwordx4 v12, s[8:11], s64 offen offset:384 lds
  s_add_u32 m0, s58, 3584
  s_nop 0
  buffer_load_dwordx4 v11, s[8:11], s63 offen offset:512 lds
  s_add_u32 m0, s58, 12800
  s_nop 0
  buffer_load_dwordx4 v12, s[8:11], s64 offen offset:512 lds
  s_and_b32 s25, s22, 3
  s_lshl_b32 s25, s25, 1
  s_and_b32 s3, s39, 1
  s_add_u32 s25, s25, s3
  s_mov_b32 s20, s44
  s_mov_b32 s21, s45
  s_mov_b32 s22, 663552
  s_mov_b32 s23, 0x20000
  s_mov_b32 s14, 40894464
  v_and_b32 v1, 15, v0
  v_lshlrev_b32 v3, 4, v0
  s_mov_b32 s4, s54
  s_mov_b32 s5, s55
  s_mov_b32 s6, 20
  s_mov_b32 s7, 0x20000
  s_mul_i32 s68, s2, 911
  s_lshr_b32 s68, s68, 16
  s_mul_i32 s69, s68, 72
  s_sub_u32 s69, s2, s69
  s_add_u32 s76, s68, 1
  s_mul_i32 s76, s76, 1152
  s_cmp_ge_u32 s68, 2
  s_cselect_b32 s76, 0, s76
  s_lshl_b32 s3, s24, 8
  s_add_u32 s76, s76, s3
  s_mov_b32 s74, 1990656
  s_mov_b32 s67, 3456
  s_cmp_eq_u32 s68, 2
  s_cselect_b32 s74, 663552, s74
  s_cselect_b32 s67, 1152, s67
  s_mov_b32 s75, 0x20000
  s_mul_i32 s3, s67, s69
  s_lshl_b32 s3, s3, 3
  s_add_u32 s76, s76, s3
  v_lshrrev_b32 v87, 3, v0
  v_mul_u32_u24 v176, s67, v87
  v_lshrrev_b32 v87, 2, v0
  v_and_b32 v87, 4, v87
  v_xor_b32 v87, v87, v0
  v_and_b32 v87, 7, v87
  v_lshl_add_u32 v176, v87, 4, v176
  s_mul_i32 s80, s24, 6144
  s_add_u32 s80, s80, 132096
  s_add_u32 s81, s76, 1105920
  s_cmp_eq_u32 s68, 2
  s_cselect_b32 s72, s46, s40
  s_cselect_b32 s73, s47, s41
  s_mul_i32 s77, s24, 663552
  s_lshl_b32 s3, s69, 8
  s_add_u32 s77, s77, s3
  s_add_u32 s77, s77, 1048576
  s_lshr_b32 s79, s68, 1
  s_mul_i32 s79, s79, 18432
  s_and_b32 s3, s68, 1
  s_lshl_b32 s3, s3, 7
  s_add_u32 s79, s79, s3
  s_add_u32 s79, s79, s77
  s_add_u32 s79, s79, 294912
  s_mul_i32 s3, s68, 73728
  s_add_u32 s77, s77, s3
  s_add_u32 s78, s77, 331776
  s_lshl_b32 s3, s24, 5
  v_bfe_u32 v26, v0, 2, 2
  v_and_b32 v27, 2, v26
  v_lshlrev_b32 v27, 5, v27
  v_lshl_add_u32 v26, v26, 7, s80
  v_and_b32 v28, 3, v0
  v_lshlrev_b32 v177, 5, v2
  v_lshl_add_u32 v177, v28, 3, v177
  v_add_u32 v177, s3, v177
  v_add_u32 v178, 144, v177
  v_lshrrev_b32 v29, 1, v28
  v_mul_u32_u24 v29, 128, v29
  v_lshl_add_u32 v29, v28, 3, v29
  s_add_u32 s3, s3, 128
  v_add_u32 v179, s3, v29
  v_lshrrev_b32 v28, 7, v177
  v_xor_b32 v177, v177, v27
  v_mul_u32_u24 v28, 896, v28
  v_add3_u32 v177, v177, v28, v26
  v_lshrrev_b32 v28, 7, v178
  v_xor_b32 v178, v178, v27
  v_mul_u32_u24 v28, 896, v28
  v_add3_u32 v178, v178, v28, v26
  v_lshrrev_b32 v28, 7, v179
  v_xor_b32 v179, v179, v27
  v_mul_u32_u24 v28, 896, v28
  v_add3_u32 v179, v179, v28, v26
  v_mul_u32_u24 v180, 18432, v2
  v_lshl_add_u32 v180, v1, 4, v180
  v_lshrrev_b32 v26, 3, v1
  v_mul_u32_u24 v26, 331648, v26
  v_lshl_add_u32 v26, v1, 4, v26
  v_lshl_add_u32 v181, v2, 28, v26
  v_mov_b32 v5, 1
  v_mov_b32 v27, 2147483648
  v_cmp_eq_u32 vcc, 0, v4
  s_lshl_b32 s3, s2, 2
  v_mov_b32 v26, s3
  v_cndmask_b32 v87, v27, v26, vcc
  s_lshl_b32 s99, s26, 3
  s_add_u32 s99, s99, s25
  s_lshl_b32 s36, s99, 13
  s_add_u32 s36, s36, 19922944
  s_lshl_b32 s3, s24, 7
  v_mov_b32 v6, s3
  s_lshl_b32 s3, s24, 7
  s_add_u32 s3, s3, 0
  v_add_u32 v26, s3, v0
  v_mul_u32_u24 v27, 3641, v26
  v_lshrrev_b32 v27, 16, v27
  v_mul_u32_u24 v28, 18, v27
  v_sub_u32 v26, v26, v28
  v_cmp_lt_u32 vcc, 15, v26
  v_lshrrev_b32 v28, 3, v26
  v_and_b32 v29, 1, v26
  v_cndmask_b32 v28, v28, v29, vcc
  v_and_b32 v26, 7, v26
  v_cndmask_b32 v26, v26, 8, vcc
  v_lshl_add_u32 v27, v27, 1, v28
  v_lshrrev_b32 v28, 1, v27
  v_xor_b32 v28, v28, v27
  v_bfe_u32 v28, v28, 2, 1
  v_mul_u32_u24 v28, 12, v28
  v_xor_b32 v27, v27, v28
  v_mul_u32_u24 v27, 1152, v27
  v_lshl_add_u32 v84, v26, 4, v27
  s_lshl_b32 s3, s24, 7
  s_add_u32 s3, s3, 64
  v_add_u32 v26, s3, v0
  v_mul_u32_u24 v27, 3641, v26
  v_lshrrev_b32 v27, 16, v27
  v_mul_u32_u24 v28, 18, v27
  v_sub_u32 v26, v26, v28
  v_cmp_lt_u32 vcc, 15, v26
  v_lshrrev_b32 v28, 3, v26
  v_and_b32 v29, 1, v26
  v_cndmask_b32 v28, v28, v29, vcc
  v_and_b32 v26, 7, v26
  v_cndmask_b32 v26, v26, 8, vcc
  v_lshl_add_u32 v27, v27, 1, v28
  v_lshrrev_b32 v28, 1, v27
  v_xor_b32 v28, v28, v27
  v_bfe_u32 v28, v28, 2, 1
  v_mul_u32_u24 v28, 12, v28
  v_xor_b32 v27, v27, v28
  v_mul_u32_u24 v27, 1152, v27
  v_lshl_add_u32 v85, v26, 4, v27
  v_add_u32 v26, 512, v0
  v_mul_u32_u24 v27, 3641, v26
  v_lshrrev_b32 v27, 16, v27
  v_mul_u32_u24 v28, 18, v27
  v_sub_u32 v26, v26, v28
  v_cmp_lt_u32 vcc, 15, v26
  v_lshrrev_b32 v28, 3, v26
  v_and_b32 v29, 1, v26
  v_cndmask_b32 v28, v28, v29, vcc
  v_and_b32 v26, 7, v26
  v_cndmask_b32 v26, v26, 8, vcc
  v_lshl_add_u32 v27, v27, 1, v28
  v_lshrrev_b32 v28, 1, v27
  v_xor_b32 v28, v28, v27
  v_bfe_u32 v28, v28, 2, 1
  v_mul_u32_u24 v28, 12, v28
  v_xor_b32 v27, v27, v28
  v_mul_u32_u24 v27, 1152, v27
  v_lshl_add_u32 v86, v26, 4, v27
  s_mul_i32 s60, s25, 144
  s_lshl_b32 s61, s24, 11
  s_add_u32 s61, s61, 73728
  s_lshr_b32 s62, s58, 1
  s_add_u32 s62, s62, 81920
  s_lshl_b32 s66, s58, 2
  s_add_u32 s66, s66, s60
  v_min_u32 v27, 53, v4
  v_mul_u32_u24 v28, 21846, v27
  v_lshrrev_b32 v28, 16, v28
  v_mul_u32_u24 v28, 768, v28
  v_lshl_add_u32 v27, v27, 7, v28
  s_mul_i32 s57, s39, 20736
  s_lshr_b32 s3, s25, 1
  s_lshl_b32 s3, s3, 8
  s_add_u32 s57, s57, s3
  buffer_load_dword a255, v27, s[20:23], s57 offen
  s_mov_b64 exec, 0
  s_cmp_eq_u32 s24, 0
  s_cbranch_scc1 PAD_1
  s_cmp_eq_u32 s24, 1
  s_cbranch_scc1 PAD_2
  s_cmp_eq_u32 s24, 2
  s_cbranch_scc1 PAD_3
  s_branch PAD_4
WRET_0:
  s_mov_b64 exec, -1
  s_waitcnt vmcnt(8)
  s_barrier
  buffer_store_dword v5, v87, s[4:7], 0 offen sc1
  s_add_u32 m0, s58, 4480
  s_nop 0
  buffer_load_dwordx4 v11, s[8:11], s63 offen offset:640 lds
  s_add_u32 m0, s58, 13696
  s_nop 0
  buffer_load_dwordx4 v12, s[8:11], s64 offen offset:640 lds
  s_add_u32 m0, s58, 5376
  s_nop 0
  buffer_load_dwordx4 v11, s[8:11], s63 offen offset:768 lds
  s_add_u32 m0, s58, 14592
  s_nop 0
  buffer_load_dwordx4 v12, s[8:11], s64 offen offset:768 lds
  s_add_u32 m0, s58, 6272
  s_nop 0
  buffer_load_dwordx4 v11, s[8:11], s63 offen offset:896 lds
  s_add_u32 m0, s58, 15488
  s_nop 0
  buffer_load_dwordx4 v12, s[8:11], s64 offen offset:896 lds
  s_add_u32 m0, s58, 7168
  s_nop 0
  buffer_load_dwordx4 v11, s[8:11], s63 offen offset:1024 lds
  s_add_u32 m0, s58, 16384
  s_nop 0
  buffer_load_dwordx4 v12, s[8:11], s64 offen offset:1024 lds
  s_cmp_lt_u32 s2, 216
  s_cbranch_scc1 L_q1
  s_add_u32 m0, s80, 3072
  s_nop 0
  buffer_load_dwordx4 v176, s[72:75], s81 offen offset:0 nt lds
  s_add_u32 m0, s80, 3968
  s_nop 0
  buffer_load_dwordx4 v176, s[72:75], s81 offen offset:128 nt lds
  s_add_u32 m0, s80, 4864
  s_nop 0
  buffer_load_dwordx4 v176, s[72:75], s81 offen offset:256 nt lds
L_q1:
  s_add_u32 m0, s80, 0
  s_nop 0
  buffer_load_dwordx4 v176, s[72:75], s76 offen offset:0 nt lds
  s_add_u32 m0, s80, 896
  s_nop 0
  buffer_load_dwordx4 v176, s[72:75], s76 offen offset:128 nt lds
  s_add_u32 m0, s80, 1792
  s_nop 0
  buffer_load_dwordx4 v176, s[72:75], s76 offen offset:256 nt lds
  v_lshl_add_u32 v26, v6, 1, v3
  s_mul_i32 s57, s99, 1152
  s_add_u32 s57, s57, 458752
  s_mov_b64 exec, 0xffff
  buffer_store_dwordx4 v[32:35], v26, s[12:15], s57 offen sc1
  s_mov_b64 exec, -1
  v_lshrrev_b32 v26, 3, v1
  v_mul_u32_u24 v26, 8192, v26
  v_lshl_add_u32 v26, v1, 7, v26
  v_lshrrev_b32 v27, 1, v1
  v_xor_b32 v27, v27, v2
  v_lshl_add_u32 v26, v27, 4, v26
  v_add_u32 v11, s58, v26
  v_xor_b32 v12, 64, v11
  s_lshl_b32 s3, s24, 8
  v_lshlrev_b32 v26, 4, v1
  v_add_u32 v26, s3, v26
  v_lshl_add_u32 v14, v2, 10, v26
  v_lshrrev_b32 v27, 1, v2
  v_and_b32 v28, 1, v2
  s_lshl_b32 s3, s24, 11
  v_lshl_add_u32 v27, v27, 10, s3
  v_lshl_add_u32 v29, v28, 3, v26
  v_add_u32 v22, v27, v29
  s_mul_i32 s33, s25, 9216
  s_add_u32 s3, s33, 8192
  v_add_u32 v8, s3, v29
  v_lshlrev_b32 v28, 8, v28
  v_xor_b32 v28, v28, v26
  v_add3_u32 v9, v27, v28, s33
  v_xor_b32 v10, 512, v9
  v_xor_b32 v15, 256, v14
  v_xor_b32 v23, 256, v22
  v_xor_b32 v16, 512, v14
  v_xor_b32 v24, 512, v22
  v_xor_b32 v17, 768, v14
  v_xor_b32 v25, 768, v22
  v_add_u32 v18, 36864, v14
  v_add_u32 v19, 36864, v15
  v_add_u32 v20, 36864, v16
  v_add_u32 v21, 36864, v17
  v_add_u32 v7, 73728, v3
  s_mul_i32 s27, s25, 331776
  s_add_u32 s27, s27, 1048576
  s_add_u32 s28, s27, s58
  v_lshrrev_b32 v26, 1, v2
  v_and_b32 v27, 1, v2
  v_lshl_add_u32 v26, v26, 2, v27
  v_bfe_u32 v27, v0, 3, 1
  v_lshl_add_u32 v26, v26, 1, v27
  v_mul_u32_u24 v26, 288, v26
  v_bfe_u32 v27, v0, 2, 1
  v_and_b32 v28, 3, v0
  v_lshlrev_b32 v28, 3, v28
  v_lshl_add_u32 v29, v27, 7, v26
  s_lshl_b32 s3, s24, 5
  s_add_u32 s3, s3, 73728
  v_add3_u32 v56, v29, v28, s3
  v_add_u32 v57, 41472, v56
  v_and_b32 v28, 8, v28
  v_lshl_add_u32 v29, v27, 4, v26
  v_add_u32 v29, v29, v28
  v_add_u32 v58, 73984, v29
  v_add_u32 v59, 115456, v29
  v_lshrrev_b32 v26, 2, v1
  v_cmp_eq_u32 s[0:1], v26, v2
  v_and_b32 v27, 1, v0
  v_lshlrev_b32 v27, 4, v27
  v_mov_b32 v26, 0x3f80
  v_lshlrev_b32 v26, v27, v26
  v_cndmask_b32 v26, 0, v26, s[0:1]
  v_and_b32 v27, 2, v0
  v_cmp_eq_u32 s[0:1], 0, v27
  v_mov_b32 v30, 0
  v_mov_b32 v31, 0
  v_mov_b32 v27, 0
  v_cndmask_b32 v28, 0, v26, s[0:1]
  v_cndmask_b32 v29, v26, 0, s[0:1]
  v_mov_b32 v26, 0
  v_mov_b32 v32, 0x3f803f80
  v_mov_b32 v33, 0x3f803f80
  v_mov_b32 v34, 0x3f803f80
  v_mov_b32 v35, 0x3f803f80
  s_add_u32 m0, s61, 0
  s_add_u32 s57, s60, 0
  buffer_load_dwordx4 v84, s[20:23], s57 offen lds
  s_add_u32 m0, s61, 1024
  s_add_u32 s57, s60, 0
  buffer_load_dwordx4 v85, s[20:23], s57 offen lds
  s_add_u32 m0, s61, 9216
  s_add_u32 s57, s60, 73728
  buffer_load_dwordx4 v84, s[20:23], s57 offen lds
  s_add_u32 m0, s61, 10240
  s_add_u32 s57, s60, 73728
  buffer_load_dwordx4 v85, s[20:23], s57 offen lds
  s_add_u32 m0, s61, 18432
  s_add_u32 s57, s60, 147456
  buffer_load_dwordx4 v84, s[20:23], s57 offen lds
  s_mul_i32 s80, s24, 6144
  s_add_u32 s80, s80, 73728
  s_cmp_eq_u32 s24, 3
  s_cselect_b32 s80, 157696, s80
  s_lshl_b32 s67, s2, 2
  s_add_u32 s67, s67, s24
  s_cmp_ge_u32 s2, 216
  s_cbranch_scc1 L_th1
  s_mul_i32 s68, s67, 5462
  s_lshr_b32 s68, s68, 16
  s_mul_i32 s69, s68, 12
  s_sub_u32 s69, s67, s69
  s_mov_b32 s72, s48
  s_mov_b32 s73, s49
  s_mov_b32 s74, 5308416
  s_mov_b32 s83, 73728
  s_mov_b32 s64, 9216
  s_mov_b32 s65, 18432
  s_mul_i32 s76, s68, 73728
  s_mul_i32 s3, s69, 768
  s_add_u32 s76, s76, s3
  s_lshl_b32 s98, s68, 8
  s_mul_i32 s3, s69, 442368
  s_add_u32 s98, s98, s3
  s_add_u32 s98, s98, 3702784
  s_add_u32 s81, s76, 384
  s_add_u32 s82, s98, 221184
  s_branch L_te2
L_th1:
  s_mov_b32 s72, s42
  s_mov_b32 s73, s43
  s_mov_b32 s74, 663552
  s_mov_b32 s83, 86016
  s_mov_b32 s64, 1152
  s_mov_b32 s65, 21504
  s_sub_u32 s67, s67, 864
  s_lshl_b32 s67, s67, 1
  s_mul_i32 s68, s67, 21846
  s_lshr_b32 s68, s68, 16
  s_mul_i32 s69, s68, 3
  s_sub_u32 s69, s67, s69
  s_mul_i32 s76, s68, 9216
  s_mul_i32 s3, s69, 384
  s_add_u32 s76, s76, s3
  s_mul_i32 s98, s68, 57
  s_lshr_b32 s98, s98, 9
  s_mul_i32 s98, s98, 771840
  s_lshl_b32 s3, s68, 8
  s_add_u32 s98, s98, s3
  s_mul_i32 s3, s69, 258048
  s_add_u32 s98, s98, s3
  s_add_u32 s98, s98, 9011200
  s_cmp_ge_u32 s67, 216
  s_cselect_b32 s98, 536870912, s98
  s_add_u32 s67, s67, 1
  s_mul_i32 s68, s67, 21846
  s_lshr_b32 s68, s68, 16
  s_mul_i32 s69, s68, 3
  s_sub_u32 s69, s67, s69
  s_mul_i32 s81, s68, 9216
  s_mul_i32 s3, s69, 384
  s_add_u32 s81, s81, s3
  s_mul_i32 s82, s68, 57
  s_lshr_b32 s82, s82, 9
  s_mul_i32 s82, s82, 771840
  s_lshl_b32 s3, s68, 8
  s_add_u32 s82, s82, s3
  s_mul_i32 s3, s69, 258048
  s_add_u32 s82, s82, s3
  s_add_u32 s82, s82, 9011200
  s_cmp_ge_u32 s67, 216
  s_cselect_b32 s82, 536870912, s82
L_te2:
  v_lshrrev_b32 v87, 3, v0
  v_mul_u32_u24 v176, s64, v87
  v_lshrrev_b32 v87, 2, v0
  v_and_b32 v87, 4, v87
  v_xor_b32 v87, v87, v0
  v_and_b32 v87, 7, v87
  v_lshl_add_u32 v176, v87, 4, v176
  v_mul_u32_u24 v183, s65, v2
  v_lshl_add_u32 v183, v1, 4, v183
  v_bfe_u32 v87, v0, 2, 2
  v_lshl_add_u32 v182, v87, 7, s80
  v_and_b32 v87, 2, v87
  v_xor_b32 v87, v87, v2
  v_lshl_add_u32 v182, v87, 5, v182
  v_and_b32 v87, 3, v0
  v_lshl_add_u32 v182, v87, 3, v182
  ds_read_b128 v[184:187], v11 offset:0
  ds_read_b128 v[188:191], v12 offset:0
  ds_read_b128 v[192:195], v11 offset:1024
  ds_read_b128 v[196:199], v12 offset:1024
  s_waitcnt vmcnt(24)
  ds_read_b128 v[200:203], v11 offset:2048
  ds_read_b128 v[204:207], v12 offset:2048
  s_waitcnt lgkmcnt(5)
  v_mfma_f32_16x16x32_bf16 v[76:79], v[32:35], v[184:187], 0
  s_waitcnt vmcnt(21)
  ds_read_b128 v[208:211], v11 offset:3072
  s_waitcnt lgkmcnt(5)
  v_mfma_f32_16x16x32_bf16 v[76:79], v[32:35], v[188:191], v[76:79]
  ds_read_b128 v[212:215], v12 offset:3072
  s_waitcnt lgkmcnt(5)
  v_mfma_f32_16x16x32_bf16 v[76:79], v[32:35], v[192:195], v[76:79]
  s_waitcnt vmcnt(19)
  ds_read_b128 v[216:219], v11 offset:4096
  s_waitcnt lgkmcnt(5)
  v_mfma_f32_16x16x32_bf16 v[76:79], v[32:35], v[196:199], v[76:79]
  ds_read_b128 v[220:223], v12 offset:4096
  s_waitcnt lgkmcnt(5)
  v_mfma_f32_16x16x32_bf16 v[76:79], v[32:35], v[200:203], v[76:79]
  s_waitcnt vmcnt(15)
  ds_read_b128 v[224:227], v11 offset:5120
  s_waitcnt lgkmcnt(5)
  v_mfma_f32_16x16x32_bf16 v[76:79], v[32:35], v[204:207], v[76:79]
  ds_read_b128 v[228:231], v12 offset:5120
  s_add_u32 m0, s61, 19456
  s_add_u32 s57, s60, 147456
  buffer_load_dwordx4 v85, s[20:23], s57 offen lds
  s_waitcnt lgkmcnt(5)
  v_mfma_f32_16x16x32_bf16 v[76:79], v[32:35], v[208:211], v[76:79]
  s_waitcnt vmcnt(14)
  ds_read_b128 v[232:235], v11 offset:6144
  s_waitcnt lgkmcnt(5)
  v_mfma_f32_16x16x32_bf16 v[76:79], v[32:35], v[212:215], v[76:79]
  ds_read_b128 v[236:239], v12 offset:6144
  s_waitcnt lgkmcnt(5)
  v_mfma_f32_16x16x32_bf16 v[76:79], v[32:35], v[216:219], v[76:79]
  s_waitcnt vmcnt(12)
  ds_read_b128 v[240:243], v11 offset:7168
  s_waitcnt lgkmcnt(5)
  v_mfma_f32_16x16x32_bf16 v[76:79], v[32:35], v[220:223], v[76:79]
  ds_read_b128 v[244:247], v12 offset:7168
  s_waitcnt lgkmcnt(5)
  v_mfma_f32_16x16x32_bf16 v[76:79], v[32:35], v[224:227], v[76:79]
  s_waitcnt vmcnt(10)
  ds_read_b128 v[248:251], v11 offset:8192
  s_waitcnt lgkmcnt(5)
  v_mfma_f32_16x16x32_bf16 v[76:79], v[32:35], v[228:231], v[76:79]
  ds_read_b128 v[252:255], v12 offset:8192
  s_add_u32 m0, s61, 27648
  s_add_u32 s57, s60, 221184
PAD_1:
  s_cbranch_execz WRET_0
  buffer_load_dwordx4 v84, s[20:23], s57 offen lds
  s_waitcnt lgkmcnt(5)
  v_mfma_f32_16x16x32_bf16 v[76:79], v[32:35], v[232:235], v[76:79]
  s_waitcnt lgkmcnt(4)
  v_mfma_f32_16x16x32_bf16 v[76:79], v[32:35], v[236:239], v[76:79]
  s_waitcnt lgkmcnt(3)
  v_mfma_f32_16x16x32_bf16 v[76:79], v[32:35], v[240:243], v[76:79]
  s_waitcnt lgkmcnt(2)
  v_mfma_f32_16x16x32_bf16 v[76:79], v[32:35], v[244:247], v[76:79]
  s_waitcnt lgkmcnt(1)
  v_mfma_f32_16x16x32_bf16 v[76:79], v[32:35], v[248:251], v[76:79]
  s_waitcnt lgkmcnt(0)
  v_mfma_f32_16x16x32_bf16 v[76:79], v[32:35], v[252:255], v[76:79]
  s_add_u32 m0, s61, 28672
  s_add_u32 s57, s60, 221184
  buffer_load_dwordx4 v85, s[20:23], s57 offen lds
  s_barrier
  s_nop 3
  v_mul_f32 v76, 0xbae38e39, v76
  v_mul_f32 v77, 0xbae38e39, v77
  v_mul_f32 v78, 0xbae38e39, v78
  v_mul_f32 v79, 0xbae38e39, v79
  s_nop 1
  v_mfma_f32_16x16x32_bf16 v[40:43], v[28:31], v[184:187], v[76:79]
  v_mfma_f32_16x16x32_bf16 v[44:47], v[26:29], v[184:187], v[76:79]
  v_mfma_f32_16x16x32_bf16 v[48:51], v[28:31], v[188:191], v[76:79]
  s_nop 5
  v_cvt_pk_bf16_f32 v184, v40, v41
  v_cvt_pk_bf16_f32 v185, v42, v43
  v_mfma_f32_16x16x32_bf16 v[52:55], v[26:29], v[188:191], v[76:79]
  v_cvt_pk_bf16_f32 v186, v44, v45
  v_cvt_pk_bf16_f32 v187, v46, v47
  ds_write_b128 v14, v[184:187] offset:0
  s_add_u32 m0, s62, 0
  s_add_u32 s57, s66, 0
  buffer_load_dwordx4 v86, s[20:23], s57 offen lds
  s_waitcnt vmcnt(10)
  ds_read_b64_tr_b16 a[216:217], v177 offset:3072
  ds_read_b64_tr_b16 a[218:219], v177 offset:3584
  ds_read_b64_tr_b16 a[220:221], v178 offset:3072
  ds_read_b64_tr_b16 a[222:223], v178 offset:3584
  ds_read_b64_tr_b16 a[224:225], v179 offset:3072
  ds_read_b64_tr_b16 a[226:227], v179 offset:3584
  ds_read_b64_tr_b16 a[240:241], v177 offset:0
  ds_read_b64_tr_b16 a[242:243], v177 offset:512
  ds_read_b64_tr_b16 a[244:245], v178 offset:0
  ds_read_b64_tr_b16 a[246:247], v178 offset:512
  ds_read_b64_tr_b16 a[248:249], v179 offset:0
  ds_read_b64_tr_b16 a[250:251], v179 offset:512
  v_mfma_f32_16x16x32_bf16 v[40:43], v[28:31], v[192:195], v[76:79]
  v_cvt_pk_bf16_f32 v188, v48, v49
  v_cvt_pk_bf16_f32 v189, v50, v51
  v_mfma_f32_16x16x32_bf16 v[44:47], v[26:29], v[192:195], v[76:79]
  v_cvt_pk_bf16_f32 v190, v52, v53
  v_cvt_pk_bf16_f32 v191, v54, v55
  v_mfma_f32_16x16x32_bf16 v[60:63], v[184:187], v[184:187], 0
  ds_write_b128 v14, v[188:191] offset:4096
  s_waitcnt lgkmcnt(5)
  buffer_store_dwordx4 a[240:243], v180, s[12:15], s77 offen sc1
  s_waitcnt lgkmcnt(3)
  buffer_store_dwordx4 a[244:247], v180, s[12:15], s78 offen sc1
  s_waitcnt lgkmcnt(1)
  buffer_store_dwordx4 a[248:251], v181, s[12:15], s79 offen sc1
  s_cmp_lt_u32 s2, 216
  s_cbranch_scc1 L_q2
  s_cmp_ge_u32 s2, 248
  s_cselect_b32 s3, 536870912, 0
  s_add_u32 s3, s3, 10240
  s_add_u32 s77, s77, s3
  s_add_u32 s78, s78, s3
  s_add_u32 s79, s79, s3
  buffer_store_dwordx4 a[216:219], v180, s[12:15], s77 offen sc1
  buffer_store_dwordx4 a[220:223], v180, s[12:15], s78 offen sc1
  buffer_store_dwordx4 a[224:227], v181, s[12:15], s79 offen sc1
L_q2:
  s_barrier
  v_mfma_f32_16x16x32_bf16 v[48:51], v[28:31], v[196:199], v[76:79]
  v_cvt_pk_bf16_f32 v192, v40, v41
  v_cvt_pk_bf16_f32 v193, v42, v43
  v_mfma_f32_16x16x32_bf16 v[52:55], v[26:29], v[196:199], v[76:79]
  v_cvt_pk_bf16_f32 v194, v44, v45
  v_cvt_pk_bf16_f32 v195, v46, v47
  v_mfma_f32_16x16x32_bf16 v[60:63], v[188:191], v[188:191], v[60:63]
  ds_write_b128 v14, v[192:195] offset:8192
  v_min_u32 v11, 4, v0
  v_lshlrev_b32 v11, 2, v11
  s_mov_b32 s57, 0
  buffer_load_dword v12, v11, s[4:7], s57 offen sc1
  v_mfma_f32_16x16x32_bf16 v[40:43], v[28:31], v[200:203], v[76:79]
  v_cvt_pk_bf16_f32 v196, v48, v49
  v_cvt_pk_bf16_f32 v197, v50, v51
  v_mfma_f32_16x16x32_bf16 v[44:47], v[26:29], v[200:203], v[76:79]
  v_cvt_pk_bf16_f32 v198, v52, v53
  v_cvt_pk_bf16_f32 v199, v54, v55
  v_mfma_f32_16x16x32_bf16 v[60:63], v[192:195], v[192:195], v[60:63]
  ds_write_b128 v14, v[196:199] offset:12288
  v_mfma_f32_16x16x32_bf16 v[48:51], v[28:31], v[204:207], v[76:79]
  v_cvt_pk_bf16_f32 v200, v40, v41
  v_cvt_pk_bf16_f32 v201, v42, v43
  v_mfma_f32_16x16x32_bf16 v[52:55], v[26:29], v[204:207], v[76:79]
  v_cvt_pk_bf16_f32 v202, v44, v45
  v_cvt_pk_bf16_f32 v203, v46, v47
  v_mfma_f32_16x16x32_bf16 v[60:63], v[196:199], v[196:199], v[60:63]
  ds_write_b128 v14, v[200:203] offset:16384
  s_add_u32 m0, s61, 36864
  s_add_u32 s57, s60, 294912
  buffer_load_dwordx4 v84, s[20:23], s57 offen lds
  v_mfma_f32_16x16x32_bf16 v[40:43], v[28:31], v[208:211], v[76:79]
  v_cvt_pk_bf16_f32 v204, v48, v49
  v_cvt_pk_bf16_f32 v205, v50, v51
  v_mfma_f32_16x16x32_bf16 v[44:47], v[26:29], v[208:211], v[76:79]
  v_cvt_pk_bf16_f32 v206, v52, v53
  v_cvt_pk_bf16_f32 v207, v54, v55
  v_mfma_f32_16x16x32_bf16 v[60:63], v[200:203], v[200:203], v[60:63]
  ds_write_b128 v14, v[204:207] offset:20480
  v_mfma_f32_16x16x32_bf16 v[48:51], v[28:31], v[212:215], v[76:79]
  v_cvt_pk_bf16_f32 v208, v40, v41
  v_cvt_pk_bf16_f32 v209, v42, v43
  v_mfma_f32_16x16x32_bf16 v[52:55], v[26:29], v[212:215], v[76:79]
  v_cvt_pk_bf16_f32 v210, v44, v45
  v_cvt_pk_bf16_f32 v211, v46, v47
  v_mfma_f32_16x16x32_bf16 v[60:63], v[204:207], v[204:207], v[60:63]
  ds_write_b128 v14, v[208:211] offset:24576
  v_mfma_f32_16x16x32_bf16 v[40:43], v[28:31], v[216:219], v[76:79]
  v_cvt_pk_bf16_f32 v212, v48, v49
  v_cvt_pk_bf16_f32 v213, v50, v51
  v_mfma_f32_16x16x32_bf16 v[44:47], v[26:29], v[216:219], v[76:79]
  v_cvt_pk_bf16_f32 v214, v52, v53
  v_cvt_pk_bf16_f32 v215, v54, v55
  v_mfma_f32_16x16x32_bf16 v[60:63], v[208:211], v[208:211], v[60:63]
  ds_write_b128 v14, v[212:215] offset:28672
  s_add_u32 m0, s61, 37888
  s_add_u32 s57, s60, 294912
  buffer_load_dwordx4 v85, s[20:23], s57 offen lds
  v_mfma_f32_16x16x32_bf16 v[48:51], v[28:31], v[220:223], v[76:79]
  v_cvt_pk_bf16_f32 v216, v40, v41
  v_cvt_pk_bf16_f32 v217, v42, v43
  v_mfma_f32_16x16x32_bf16 v[52:55], v[26:29], v[220:223], v[76:79]
  v_cvt_pk_bf16_f32 v218, v44, v45
  v_cvt_pk_bf16_f32 v219, v46, v47
  v_mfma_f32_16x16x32_bf16 v[60:63], v[212:215], v[212:215], v[60:63]
  ds_write_b128 v14, v[216:219] offset:32768
  s_waitcnt vmcnt(2)
  v_cmp_gt_u32 vcc, 1, v12
  s_mov_b32 s58, 0
  s_nop 3
  s_cbranch_vccz L_ok3
L_sp4:
  s_sleep 8
  s_mov_b32 s57, 0
  buffer_load_dword v12, v11, s[4:7], s57 offen sc1
  s_add_u32 s58, s58, 1
  s_cmp_gt_u32 s58, 400000
  s_cbranch_scc1 L_ok3
  s_waitcnt vmcnt(0)
  v_cmp_gt_u32 vcc, 1, v12
  s_nop 4
  s_cbranch_vccnz L_sp4
L_ok3:
  s_barrier
  s_cmp_lg_u32 s24, 0
  s_cbranch_scc1 L_fs5
  s_mul_i32 s57, s99, 64
  s_add_u32 s57, s57, 2048
  s_mov_b64 exec, 1
  buffer_store_dword v5, v6, s[12:15], s57 offen sc1
  s_mov_b64 exec, -1
L_fs5:
  v_mfma_f32_16x16x32_bf16 v[40:43], v[28:31], v[224:227], v[76:79]
  v_cvt_pk_bf16_f32 v220, v48, v49
  v_cvt_pk_bf16_f32 v221, v50, v51
  v_mfma_f32_16x16x32_bf16 v[44:47], v[26:29], v[224:227], v[76:79]
  v_cvt_pk_bf16_f32 v222, v52, v53
  v_cvt_pk_bf16_f32 v223, v54, v55
  v_mfma_f32_16x16x32_bf16 v[60:63], v[216:219], v[216:219], v[60:63]
  ds_write_b128 v18, v[220:223] offset:0
  v_mfma_f32_16x16x32_bf16 v[48:51], v[28:31], v[228:231], v[76:79]
  v_cvt_pk_bf16_f32 v224, v40, v41
  v_cvt_pk_bf16_f32 v225, v42, v43
  v_mfma_f32_16x16x32_bf16 v[52:55], v[26:29], v[228:231], v[76:79]
  v_cvt_pk_bf16_f32 v226, v44, v45
  v_cvt_pk_bf16_f32 v227, v46, v47
  v_mfma_f32_16x16x32_bf16 v[60:63], v[220:223], v[220:223], v[60:63]
  ds_write_b128 v18, v[224:227] offset:4096
  s_add_u32 m0, s61, 46080
  s_add_u32 s57, s60, 368640
  buffer_load_dwordx4 v84, s[20:23], s57 offen lds
  v_mfma_f32_16x16x32_bf16 v[40:43], v[28:31], v[232:235], v[76:79]
  v_cvt_pk_bf16_f32 v228, v48, v49
  v_cvt_pk_bf16_f32 v229, v50, v51
  v_mfma_f32_16x16x32_bf16 v[44:47], v[26:29], v[232:235], v[76:79]
  v_cvt_pk_bf16_f32 v230, v52, v53
  v_cvt_pk_bf16_f32 v231, v54, v55
  v_mfma_f32_16x16x32_bf16 v[60:63], v[224:227], v[224:227], v[60:63]
  ds_write_b128 v18, v[228:231] offset:8192
  v_mfma_f32_16x16x32_bf16 v[48:51], v[28:31], v[236:239], v[76:79]
  v_cvt_pk_bf16_f32 v232, v40, v41
  v_cvt_pk_bf16_f32 v233, v42, v43
  v_mfma_f32_16x16x32_bf16 v[52:55], v[26:29], v[236:239], v[76:79]
  v_cvt_pk_bf16_f32 v234, v44, v45
  v_cvt_pk_bf16_f32 v235, v46, v47
  v_mfma_f32_16x16x32_bf16 v[60:63], v[228:231], v[228:231], v[60:63]
  ds_write_b128 v18, v[232:235] offset:12288
  v_mfma_f32_16x16x32_bf16 v[40:43], v[28:31], v[240:243], v[76:79]
  v_cvt_pk_bf16_f32 v236, v48, v49
  v_cvt_pk_bf16_f32 v237, v50, v51
  v_mfma_f32_16x16x32_bf16 v[44:47], v[26:29], v[240:243], v[76:79]
  v_cvt_pk_bf16_f32 v238, v52, v53
  v_cvt_pk_bf16_f32 v239, v54, v55
  v_mfma_f32_16x16x32_bf16 v[60:63], v[232:235], v[232:235], v[60:63]
  ds_write_b128 v18, v[236:239] offset:16384
  s_add_u32 m0, s61, 47104
  s_add_u32 s57, s60, 368640
  buffer_load_dwordx4 v85, s[20:23], s57 offen lds
  v_mfma_f32_16x16x32_bf16 v[48:51], v[28:31], v[244:247], v[76:79]
  v_cvt_pk_bf16_f32 v240, v40, v41
  v_cvt_pk_bf16_f32 v241, v42, v43
  v_mfma_f32_16x16x32_bf16 v[52:55], v[26:29], v[244:247], v[76:79]
  v_cvt_pk_bf16_f32 v242, v44, v45
  v_cvt_pk_bf16_f32 v243, v46, v47
  v_mfma_f32_16x16x32_bf16 v[60:63], v[236:239], v[236:239], v[60:63]
  ds_write_b128 v18, v[240:243] offset:20480
  v_mfma_f32_16x16x32_bf16 v[40:43], v[28:31], v[248:251], v[76:79]
  v_cvt_pk_bf16_f32 v244, v48, v49
  v_cvt_pk_bf16_f32 v245, v50, v51
  v_mfma_f32_16x16x32_bf16 v[44:47], v[26:29], v[248:251], v[76:79]
  v_cvt_pk_bf16_f32 v246, v52, v53
  v_cvt_pk_bf16_f32 v247, v54, v55
  v_mfma_f32_16x16x32_bf16 v[60:63], v[240:243], v[240:243], v[60:63]
  ds_write_b128 v18, v[244:247] offset:24576
  v_mfma_f32_16x16x32_bf16 v[48:51], v[28:31], v[252:255], v[76:79]
  v_cvt_pk_bf16_f32 v248, v40, v41
  v_cvt_pk_bf16_f32 v249, v42, v43
  v_mfma_f32_16x16x32_bf16 v[52:55], v[26:29], v[252:255], v[76:79]
  v_cvt_pk_bf16_f32 v250, v44, v45
  v_cvt_pk_bf16_f32 v251, v46, v47
  v_mfma_f32_16x16x32_bf16 v[60:63], v[244:247], v[244:247], v[60:63]
  ds_write_b128 v18, v[248:251] offset:28672
  s_add_u32 m0, s61, 55296
  s_add_u32 s57, s60, 442368
  buffer_load_dwordx4 v84, s[20:23], s57 offen lds
  v_cvt_pk_bf16_f32 v252, v48, v49
  v_cvt_pk_bf16_f32 v253, v50, v51
  v_cvt_pk_bf16_f32 v254, v52, v53
  v_cvt_pk_bf16_f32 v255, v54, v55
  v_mfma_f32_16x16x32_bf16 v[60:63], v[248:251], v[248:251], v[60:63]
  ds_write_b128 v18, v[252:255] offset:32768
  v_mfma_f32_16x16x32_bf16 v[60:63], v[252:255], v[252:255], v[60:63]
  s_waitcnt lgkmcnt(0)
  s_barrier
  ds_read_b64_tr_b16 a[216:217], v58 offset:0
  ds_read_b64_tr_b16 a[218:219], v58 offset:1152
  ds_read_b64_tr_b16 a[240:241], v56 offset:0
  ds_read_b64_tr_b16 a[242:243], v56 offset:1152
  ds_read_b128 a[0:3], v15 offset:0
  ds_read_b128 a[4:7], v16 offset:0
  ds_read_b128 a[8:11], v17 offset:0
  ds_read_b64_tr_b16 a[220:221], v58 offset:4608
  ds_read_b64_tr_b16 a[222:223], v58 offset:5760
  ds_read_b64_tr_b16 a[244:245], v56 offset:4608
  ds_read_b64_tr_b16 a[246:247], v56 offset:5760
  ds_read_b128 a[12:15], v15 offset:4096
  ds_read_b128 a[16:19], v16 offset:4096
  ds_read_b128 a[20:23], v17 offset:4096
  s_waitcnt lgkmcnt(7)
  v_mfma_f32_16x16x32_bf16 v[72:75], a[216:219], v[184:187], 0
  ds_read_b64_tr_b16 a[224:225], v58 offset:9216
  ds_read_b64_tr_b16 a[226:227], v58 offset:10368
  v_and_b32 v32, 1, v0
  v_mfma_f32_16x16x32_bf16 v[40:43], a[240:243], v[184:187], 0
  ds_read_b64_tr_b16 a[248:249], v56 offset:9216
  s_add_u32 m0, s61, 56320
  s_add_u32 s57, s60, 442368
  buffer_load_dwordx4 v85, s[20:23], s57 offen lds
  v_cmp_eq_u32 s[0:1], 0, v32
  v_mfma_f32_16x16x32_bf16 v[44:47], a[240:243], a[0:3], 0
  ds_read_b64_tr_b16 a[250:251], v56 offset:10368
  ds_read_b128 a[24:27], v15 offset:8192
  v_and_b32 v32, 2, v0
  v_mfma_f32_16x16x32_bf16 v[48:51], a[240:243], a[4:7], 0
  ds_read_b128 a[28:31], v16 offset:8192
  v_cmp_eq_u32 s[94:95], 0, v32
  v_mfma_f32_16x16x32_bf16 v[52:55], a[240:243], a[8:11], 0
  ds_read_b128 a[32:35], v17 offset:8192
  v_cndmask_b32 v60, v61, v60, s[0:1]
  s_waitcnt lgkmcnt(7)
  v_mfma_f32_16x16x32_bf16 v[72:75], a[220:223], v[188:191], v[72:75]
  ds_read_b64_tr_b16 a[216:217], v58 offset:13824
  ds_read_b64_tr_b16 a[218:219], v58 offset:14976
  v_cndmask_b32 v62, v63, v62, s[0:1]
  v_mfma_f32_16x16x32_bf16 v[40:43], a[244:247], v[188:191], v[40:43]
  ds_read_b64_tr_b16 a[240:241], v56 offset:13824
  s_add_u32 m0, s61, 64512
  s_add_u32 s57, s60, 516096
  buffer_load_dwordx4 v84, s[20:23], s57 offen lds
  v_cndmask_b32 v32, v62, v60, s[94:95]
  v_mfma_f32_16x16x32_bf16 v[44:47], a[244:247], a[12:15], v[44:47]
  ds_read_b64_tr_b16 a[242:243], v56 offset:14976
  ds_read_b128 a[36:39], v15 offset:12288
  v_lshrrev_b32 v36, 2, v1
  v_mfma_f32_16x16x32_bf16 v[48:51], a[244:247], a[16:19], v[48:51]
  ds_read_b128 a[40:43], v16 offset:12288
  v_cmp_eq_u32 s[96:97], v36, v2
  v_mfma_f32_16x16x32_bf16 v[52:55], a[244:247], a[20:23], v[52:55]
  ds_read_b128 a[44:47], v17 offset:12288
  v_mul_f32 v32, 0x3ae38e39, v32
  s_waitcnt lgkmcnt(7)
  v_mfma_f32_16x16x32_bf16 v[72:75], a[224:227], v[192:195], v[72:75]
  ds_read_b64_tr_b16 a[220:221], v58 offset:18432
  ds_read_b64_tr_b16 a[222:223], v58 offset:19584
  v_bfe_u32 v36, v14, 1, 9
  v_mfma_f32_16x16x32_bf16 v[40:43], a[248:251], v[192:195], v[40:43]
  ds_read_b64_tr_b16 a[244:245], v56 offset:18432
  s_add_u32 m0, s61, 65536
  s_add_u32 s57, s60, 516096
  buffer_load_dwordx4 v85, s[20:23], s57 offen lds
  v_add_f32 v33, 0x3727c5ac, v32
  v_mfma_f32_16x16x32_bf16 v[44:47], a[248:251], a[24:27], v[44:47]
  ds_read_b64_tr_b16 a[246:247], v56 offset:19584
  ds_read_b128 a[48:51], v15 offset:16384
  v_rsq_f32 v35, v33
  v_mfma_f32_16x16x32_bf16 v[48:51], a[248:251], a[28:31], v[48:51]
  ds_read_b128 a[52:55], v16 offset:16384
  v_add_u32 v36, 156672, v36
  v_mfma_f32_16x16x32_bf16 v[52:55], a[248:251], a[32:35], v[52:55]
  ds_read_b128 a[56:59], v17 offset:16384
  v_mul_f32 v34, v35, v35
  s_waitcnt lgkmcnt(7)
  v_mfma_f32_16x16x32_bf16 v[72:75], a[216:219], v[196:199], v[72:75]
  ds_read_b64_tr_b16 a[224:225], v58 offset:23040
  ds_read_b64_tr_b16 a[226:227], v58 offset:24192
  v_fmaak_f32 v34, v34, v32, 0x3727c5ac
  v_mfma_f32_16x16x32_bf16 v[40:43], a[240:243], v[196:199], v[40:43]
  ds_read_b64_tr_b16 a[248:249], v56 offset:23040
  s_add_u32 m0, s62, 36864
  s_add_u32 s57, s66, 294912
  buffer_load_dwordx4 v86, s[20:23], s57 offen lds
  v_rsq_f32 v34, v34
  v_mfma_f32_16x16x32_bf16 v[44:47], a[240:243], a[36:39], v[44:47]
  ds_read_b64_tr_b16 a[250:251], v56 offset:24192
  ds_read_b128 a[60:63], v15 offset:20480
  v_mov_b32 v37, 157184
  v_mfma_f32_16x16x32_bf16 v[48:51], a[240:243], a[40:43], v[48:51]
  ds_read_b128 a[64:67], v16 offset:20480
  v_mul_f32 v34, v34, v35
  v_mfma_f32_16x16x32_bf16 v[52:55], a[240:243], a[44:47], v[52:55]
  ds_read_b128 a[68:71], v17 offset:20480
  v_cndmask_b32 v36, v37, v36, s[96:97]
  s_waitcnt lgkmcnt(7)
  v_mfma_f32_16x16x32_bf16 v[72:75], a[220:223], v[200:203], v[72:75]
  ds_read_b64_tr_b16 a[216:217], v58 offset:27648
  ds_read_b64_tr_b16 a[218:219], v58 offset:28800
  v_mul_f32 v34, 0xbeeff558, v34
  v_mfma_f32_16x16x32_bf16 v[40:43], a[244:247], v[200:203], v[40:43]
  ds_read_b64_tr_b16 a[240:241], v56 offset:27648
  s_cmp_lg_u32 s24, 3
  s_cbranch_scc1 L_w8
  s_mov_b32 m0, 155648
  s_add_u32 s57, s60, 589824
  buffer_load_dwordx4 v86, s[20:23], s57 offen lds
L_w8:
  s_add_u32 m0, s61, 73728
  s_add_u32 s57, s60, 589824
  buffer_load_dwordx4 v84, s[20:23], s57 offen lds
  ds_write_b64 v36, v[34:35]
  v_mfma_f32_16x16x32_bf16 v[44:47], a[244:247], a[48:51], v[44:47]
  ds_read_b64_tr_b16 a[242:243], v56 offset:28800
  ds_read_b128 a[72:75], v15 offset:24576
  v_mfma_f32_16x16x32_bf16 v[48:51], a[244:247], a[52:55], v[48:51]
  ds_read_b128 a[76:79], v16 offset:24576
  v_mfma_f32_16x16x32_bf16 v[52:55], a[244:247], a[56:59], v[52:55]
  ds_read_b128 a[80:83], v17 offset:24576
  s_waitcnt lgkmcnt(8)
  v_mfma_f32_16x16x32_bf16 v[72:75], a[224:227], v[204:207], v[72:75]
  ds_read_b64_tr_b16 a[220:221], v58 offset:32256
  ds_read_b64_tr_b16 a[222:223], v58 offset:33408
  v_mfma_f32_16x16x32_bf16 v[40:43], a[248:251], v[204:207], v[40:43]
  ds_read_b64_tr_b16 a[244:245], v56 offset:32256
  v_lshlrev_b32 v11, 6, v4
  s_mov_b32 s57, 2048
  buffer_load_dword v12, v11, s[12:15], s57 offen sc1
  s_add_u32 m0, s61, 74752
  s_add_u32 s57, s60, 589824
  buffer_load_dwordx4 v85, s[20:23], s57 offen lds
  v_mfma_f32_16x16x32_bf16 v[44:47], a[248:251], a[60:63], v[44:47]
  ds_read_b64_tr_b16 a[246:247], v56 offset:33408
  ds_read_b128 a[84:87], v15 offset:28672
  v_mfma_f32_16x16x32_bf16 v[48:51], a[248:251], a[64:67], v[48:51]
  ds_read_b128 a[88:91], v16 offset:28672
  v_mfma_f32_16x16x32_bf16 v[52:55], a[248:251], a[68:71], v[52:55]
  ds_read_b128 a[92:95], v17 offset:28672
  s_waitcnt lgkmcnt(7)
  v_mfma_f32_16x16x32_bf16 v[72:75], a[216:219], v[208:211], v[72:75]
  s_waitcnt vmcnt(3)
  s_barrier
  ds_read_b64_tr_b16 a[224:225], v58 offset:36864
  ds_read_b64_tr_b16 a[226:227], v58 offset:38016
  v_mfma_f32_16x16x32_bf16 v[40:43], a[240:243], v[208:211], v[40:43]
  ds_read_b64_tr_b16 a[248:249], v56 offset:36864
  s_add_u32 m0, s80, 0
  s_nop 0
  buffer_load_dwordx4 v176, s[72:75], s76 offen offset:0 nt lds
  v_mfma_f32_16x16x32_bf16 v[44:47], a[240:243], a[72:75], v[44:47]
  ds_read_b64_tr_b16 a[250:251], v56 offset:38016
  ds_read_b128 a[96:99], v15 offset:32768
  v_mfma_f32_16x16x32_bf16 v[48:51], a[240:243], a[76:79], v[48:51]
  ds_read_b128 a[100:103], v16 offset:32768
  v_mfma_f32_16x16x32_bf16 v[52:55], a[240:243], a[80:83], v[52:55]
  ds_read_b128 a[104:107], v17 offset:32768
  s_waitcnt lgkmcnt(7)
  v_mfma_f32_16x16x32_bf16 v[72:75], a[220:223], v[212:215], v[72:75]
  ds_read_b64_tr_b16 a[216:217], v59 offset:0
  ds_read_b64_tr_b16 a[218:219], v59 offset:1152
  v_mfma_f32_16x16x32_bf16 v[40:43], a[244:247], v[212:215], v[40:43]
  ds_read_b64_tr_b16 a[240:241], v57 offset:0
  s_add_u32 m0, s80, 896
  s_nop 0
  buffer_load_dwordx4 v176, s[72:75], s76 offen offset:128 nt lds
  v_mfma_f32_16x16x32_bf16 v[44:47], a[244:247], a[84:87], v[44:47]
  ds_read_b64_tr_b16 a[242:243], v57 offset:1152
  ds_read_b128 a[108:111], v19 offset:0
  v_mfma_f32_16x16x32_bf16 v[48:51], a[244:247], a[88:91], v[48:51]
  ds_read_b128 a[112:115], v20 offset:0
  v_mfma_f32_16x16x32_bf16 v[52:55], a[244:247], a[92:95], v[52:55]
  ds_read_b128 a[116:119], v21 offset:0
  s_waitcnt lgkmcnt(7)
  v_mfma_f32_16x16x32_bf16 v[72:75], a[224:227], v[216:219], v[72:75]
  ds_read_b64_tr_b16 a[220:221], v59 offset:4608
  ds_read_b64_tr_b16 a[222:223], v59 offset:5760
  v_mfma_f32_16x16x32_bf16 v[40:43], a[248:251], v[216:219], v[40:43]
  ds_read_b64_tr_b16 a[244:245], v57 offset:4608
  s_add_u32 m0, s80, 1792
  s_nop 0
  buffer_load_dwordx4 v176, s[72:75], s76 offen offset:256 nt lds
  v_mfma_f32_16x16x32_bf16 v[44:47], a[248:251], a[96:99], v[44:47]
  ds_read_b64_tr_b16 a[246:247], v57 offset:5760
  ds_read_b128 a[120:123], v19 offset:4096
  v_mfma_f32_16x16x32_bf16 v[48:51], a[248:251], a[100:103], v[48:51]
  ds_read_b128 a[124:127], v20 offset:4096
  v_mfma_f32_16x16x32_bf16 v[52:55], a[248:251], a[104:107], v[52:55]
  ds_read_b128 a[128:131], v21 offset:4096
  s_waitcnt lgkmcnt(7)
  v_mfma_f32_16x16x32_bf16 v[72:75], a[216:219], v[220:223], v[72:75]
  ds_read_b64_tr_b16 a[224:225], v59 offset:9216
  ds_read_b64_tr_b16 a[226:227], v59 offset:10368
  v_mfma_f32_16x16x32_bf16 v[40:43], a[240:243], v[220:223], v[40:43]
  ds_read_b64_tr_b16 a[248:249], v57 offset:9216
  s_add_u32 m0, s80, 3072
  s_nop 0
  buffer_load_dwordx4 v176, s[72:75], s81 offen offset:0 nt lds
  v_mfma_f32_16x16x32_bf16 v[44:47], a[240:243], a[108:111], v[44:47]
  ds_read_b64_tr_b16 a[250:251], v57 offset:10368
  ds_read_b128 a[132:135], v19 offset:8192
  v_mfma_f32_16x16x32_bf16 v[48:51], a[240:243], a[112:115], v[48:51]
  ds_read_b128 a[136:139], v20 offset:8192
  v_mfma_f32_16x16x32_bf16 v[52:55], a[240:243], a[116:119], v[52:55]
  ds_read_b128 a[140:143], v21 offset:8192
  s_waitcnt lgkmcnt(7)
  v_mfma_f32_16x16x32_bf16 v[72:75], a[220:223], v[224:227], v[72:75]
  ds_read_b64_tr_b16 a[216:217], v59 offset:13824
  ds_read_b64_tr_b16 a[218:219], v59 offset:14976
  v_mfma_f32_16x16x32_bf16 v[40:43], a[244:247], v[224:227], v[40:43]
  ds_read_b64_tr_b16 a[240:241], v57 offset:13824
  s_add_u32 m0, s80, 3968
  s_nop 0
  buffer_load_dwordx4 v176, s[72:75], s81 offen offset:128 nt lds
  v_mfma_f32_16x16x32_bf16 v[44:47], a[244:247], a[120:123], v[44:47]
  ds_read_b64_tr_b16 a[242:243], v57 offset:14976
  ds_read_b128 a[144:147], v19 offset:12288
  v_mfma_f32_16x16x32_bf16 v[48:51], a[244:247], a[124:127], v[48:51]
  ds_read_b128 a[148:151], v20 offset:12288
  v_mfma_f32_16x16x32_bf16 v[52:55], a[244:247], a[128:131], v[52:55]
  ds_read_b128 a[152:155], v21 offset:12288
  s_waitcnt lgkmcnt(7)
  v_mfma_f32_16x16x32_bf16 v[72:75], a[224:227], v[228:231], v[72:75]
  ds_read_b64_tr_b16 a[220:221], v59 offset:18432
  ds_read_b64_tr_b16 a[222:223], v59 offset:19584
  v_mfma_f32_16x16x32_bf16 v[40:43], a[248:251], v[228:231], v[40:43]
  ds_read_b64_tr_b16 a[244:245], v57 offset:18432
  s_add_u32 m0, s80, 4864
  s_nop 0
  buffer_load_dwordx4 v176, s[72:75], s81 offen offset:256 nt lds
  v_mfma_f32_16x16x32_bf16 v[44:47], a[248:251], a[132:135], v[44:47]
  ds_read_b64_tr_b16 a[246:247], v57 offset:19584
  ds_read_b128 a[156:159], v19 offset:16384
  v_mfma_f32_16x16x32_bf16 v[48:51], a[248:251], a[136:139], v[48:51]
  ds_read_b128 a[160:163], v20 offset:16384
  v_mfma_f32_16x16x32_bf16 v[52:55], a[248:251], a[140:143], v[52:55]
  ds_read_b128 a[164:167], v21 offset:16384
  s_waitcnt lgkmcnt(7)
  v_mfma_f32_16x16x32_bf16 v[72:75], a[216:219], v[232:235], v[72:75]
  ds_read_b64_tr_b16 a[224:225], v59 offset:23040
  ds_read_b64_tr_b16 a[226:227], v59 offset:24192
  v_mfma_f32_16x16x32_bf16 v[40:43], a[240:243], v[232:235], v[40:43]
  ds_read_b64_tr_b16 a[248:249], v57 offset:23040
  v_mfma_f32_16x16x32_bf16 v[44:47], a[240:243], a[144:147], v[44:47]
  ds_read_b64_tr_b16 a[250:251], v57 offset:24192
  ds_read_b128 a[168:171], v19 offset:20480
  v_mfma_f32_16x16x32_bf16 v[48:51], a[240:243], a[148:151], v[48:51]
  ds_read_b128 a[172:175], v20 offset:20480
  v_mfma_f32_16x16x32_bf16 v[52:55], a[240:243], a[152:155], v[52:55]
  ds_read_b128 a[176:179], v21 offset:20480
  v_bfe_u32 v26, v14, 1, 9
  s_waitcnt lgkmcnt(7)
  v_mfma_f32_16x16x32_bf16 v[72:75], a[220:223], v[236:239], v[72:75]
  ds_read_b64_tr_b16 a[216:217], v59 offset:27648
  ds_read_b64_tr_b16 a[218:219], v59 offset:28800
  v_add_u32 v26, 156672, v26
  v_mfma_f32_16x16x32_bf16 v[40:43], a[244:247], v[236:239], v[40:43]
  ds_read_b64_tr_b16 a[240:241], v57 offset:27648
  s_waitcnt vmcnt(7)
  v_cmp_gt_u32 vcc, 1, v12
  s_mov_b32 s58, 0
  s_nop 3
  s_cbranch_vccz L_ok6
L_sp7:
  s_sleep 8
  s_mov_b32 s57, 2048
  buffer_load_dword v12, v11, s[12:15], s57 offen sc1
  s_add_u32 s58, s58, 1
  s_cmp_gt_u32 s58, 400000
  s_cbranch_scc1 L_ok6
  s_waitcnt vmcnt(0)
  v_cmp_gt_u32 vcc, 1, v12
  s_nop 4
  s_cbranch_vccnz L_sp7
L_ok6:
  s_barrier
  s_add_u32 s56, s28, 0
  buffer_load_dwordx4 v[88:91], v3, s[12:15], s56 offen offset:0 sc1
  ds_read_b32 v76, v26 offset:0
  v_mfma_f32_16x16x32_bf16 v[44:47], a[244:247], a[156:159], v[44:47]
  ds_read_b64_tr_b16 a[242:243], v57 offset:28800
  ds_read_b128 a[180:183], v19 offset:24576
  ds_read_b32 v80, v26 offset:4
  v_mfma_f32_16x16x32_bf16 v[48:51], a[244:247], a[160:163], v[48:51]
  ds_read_b128 a[184:187], v20 offset:24576
  v_add_u32 v26, s33, v22
  v_mfma_f32_16x16x32_bf16 v[52:55], a[244:247], a[164:167], v[52:55]
  ds_read_b128 a[188:191], v21 offset:24576
  ds_read_b64 a[228:229], v26
  s_waitcnt lgkmcnt(10)
  v_mfma_f32_16x16x32_bf16 v[72:75], a[224:227], v[240:243], v[72:75]
  s_waitcnt vmcnt(7)
  s_barrier
  ds_read_b64_tr_b16 a[220:221], v59 offset:32256
  ds_read_b64_tr_b16 a[222:223], v59 offset:33408
  v_bfe_u32 v26, v15, 1, 9
  v_mfma_f32_16x16x32_bf16 v[40:43], a[248:251], v[240:243], v[40:43]
  ds_read_b64_tr_b16 a[244:245], v57 offset:32256
  buffer_load_dwordx4 v[92:95], v3, s[12:15], s56 offen offset:1024 sc1
  v_add_u32 v26, 156672, v26
  v_mfma_f32_16x16x32_bf16 v[44:47], a[248:251], a[168:171], v[44:47]
  ds_read_b64_tr_b16 a[246:247], v57 offset:33408
  ds_read_b128 a[192:195], v19 offset:28672
  ds_read_b32 v77, v26 offset:0
  v_mfma_f32_16x16x32_bf16 v[48:51], a[248:251], a[172:175], v[48:51]
  ds_read_b128 a[196:199], v20 offset:28672
  ds_read_b32 v81, v26 offset:4
  v_mfma_f32_16x16x32_bf16 v[52:55], a[248:251], a[176:179], v[52:55]
  ds_read_b128 a[200:203], v21 offset:28672
  v_add_u32 v26, s33, v23
  s_waitcnt lgkmcnt(10)
  v_mfma_f32_16x16x32_bf16 v[72:75], a[216:219], v[244:247], v[72:75]
  ds_read_b64_tr_b16 a[224:225], v59 offset:36864
  ds_read_b64_tr_b16 a[226:227], v59 offset:38016
  ds_read_b64 a[230:231], v26
  v_mfma_f32_16x16x32_bf16 v[40:43], a[240:243], v[244:247], v[40:43]
PAD_2:
  s_cbranch_execz WRET_0
  ds_read_b64_tr_b16 a[248:249], v57 offset:36864
  buffer_load_dwordx4 v[96:99], v3, s[12:15], s56 offen offset:2048 sc1
  v_bfe_u32 v26, v16, 1, 9
  v_mfma_f32_16x16x32_bf16 v[44:47], a[240:243], a[180:183], v[44:47]
  ds_read_b64_tr_b16 a[250:251], v57 offset:38016
  ds_read_b128 a[204:207], v19 offset:32768
  v_add_u32 v26, 156672, v26
  v_mfma_f32_16x16x32_bf16 v[48:51], a[240:243], a[184:187], v[48:51]
  ds_read_b128 a[208:211], v20 offset:32768
  buffer_load_dwordx4 v[100:103], v3, s[12:15], s56 offen offset:3072 sc1
  ds_read_b32 v78, v26 offset:0
  v_mfma_f32_16x16x32_bf16 v[52:55], a[240:243], a[188:191], v[52:55]
  ds_read_b128 a[212:215], v21 offset:32768
  ds_read_b32 v82, v26 offset:4
  s_waitcnt lgkmcnt(10)
  v_mfma_f32_16x16x32_bf16 v[72:75], a[220:223], v[248:251], v[72:75]
  v_add_u32 v26, s33, v24
  v_mfma_f32_16x16x32_bf16 v[40:43], a[244:247], v[248:251], v[40:43]
  s_add_u32 s56, s28, 4096
  buffer_load_dwordx4 v[104:107], v3, s[12:15], s56 offen offset:0 sc1
  ds_read_b64 a[232:233], v26
  v_mfma_f32_16x16x32_bf16 v[44:47], a[244:247], a[192:195], v[44:47]
  v_bfe_u32 v26, v17, 1, 9
  v_mfma_f32_16x16x32_bf16 v[48:51], a[244:247], a[196:199], v[48:51]
  v_add_u32 v26, 156672, v26
  v_mfma_f32_16x16x32_bf16 v[52:55], a[244:247], a[200:203], v[52:55]
  ds_read_b32 v79, v26 offset:0
  s_waitcnt lgkmcnt(3)
  v_mfma_f32_16x16x32_bf16 v[72:75], a[224:227], v[252:255], v[72:75]
  ds_read_b32 v83, v26 offset:4
  v_mfma_f32_16x16x32_bf16 v[40:43], a[248:251], v[252:255], v[40:43]
  buffer_load_dwordx4 v[108:111], v3, s[12:15], s56 offen offset:1024 sc1
  v_add_u32 v26, s33, v25
  v_mfma_f32_16x16x32_bf16 v[44:47], a[248:251], a[204:207], v[44:47]
  ds_read_b64 a[234:235], v26
  v_mfma_f32_16x16x32_bf16 v[48:51], a[248:251], a[208:211], v[48:51]
  ds_read_b64 a[236:237], v8
  v_mfma_f32_16x16x32_bf16 v[52:55], a[248:251], a[212:215], v[52:55]
  s_mov_b32 s60, 0x409d30fc
  s_mov_b32 s61, s60
  s_mov_b32 s62, 1.0
  s_mov_b32 s63, 1.0
  s_add_u32 s59, s31, 15204352
  v_pk_mul_f32 v[40:41], v[40:41], v[76:77] op_sel:[0,0] op_sel_hi:[1,0]
  v_pk_mul_f32 v[42:43], v[42:43], v[76:77] op_sel:[0,0] op_sel_hi:[1,0]
  v_pk_fma_f32 v[26:27], v[40:41], v[40:41], s[60:61]
  v_pk_fma_f32 v[28:29], v[42:43], v[42:43], s[60:61]
  v_pk_mul_f32 v[26:27], v[26:27], v[40:41]
  v_pk_mul_f32 v[28:29], v[28:29], v[42:43]
  v_exp_f32 v26, v26
  v_exp_f32 v27, v27
  v_exp_f32 v28, v28
  v_exp_f32 v29, v29
  v_pk_add_f32 v[26:27], v[26:27], s[62:63]
  v_pk_add_f32 v[28:29], v[28:29], s[62:63]
  v_rcp_f32 v26, v26
  v_rcp_f32 v27, v27
  v_rcp_f32 v28, v28
  v_rcp_f32 v29, v29
  v_pk_mul_f32 v[26:27], v[26:27], v[40:41]
  v_pk_mul_f32 v[28:29], v[28:29], v[42:43]
  v_cvt_pk_bf16_f32 v32, v26, v27
  v_cvt_pk_bf16_f32 v33, v28, v29
  buffer_load_dwordx4 v[112:115], v3, s[12:15], s56 offen offset:2048 sc1
  v_pk_mul_f32 v[44:45], v[44:45], v[76:77] op_sel:[0,1] op_sel_hi:[1,1]
  v_pk_mul_f32 v[46:47], v[46:47], v[76:77] op_sel:[0,1] op_sel_hi:[1,1]
  v_pk_fma_f32 v[26:27], v[44:45], v[44:45], s[60:61]
  v_pk_fma_f32 v[28:29], v[46:47], v[46:47], s[60:61]
  v_pk_mul_f32 v[26:27], v[26:27], v[44:45]
  v_pk_mul_f32 v[28:29], v[28:29], v[46:47]
  v_exp_f32 v26, v26
  v_exp_f32 v27, v27
  v_exp_f32 v28, v28
  v_exp_f32 v29, v29
  v_pk_add_f32 v[26:27], v[26:27], s[62:63]
  v_pk_add_f32 v[28:29], v[28:29], s[62:63]
  v_rcp_f32 v26, v26
  v_rcp_f32 v27, v27
  v_rcp_f32 v28, v28
  v_rcp_f32 v29, v29
  v_pk_mul_f32 v[26:27], v[26:27], v[44:45]
  v_pk_mul_f32 v[28:29], v[28:29], v[46:47]
  v_cvt_pk_bf16_f32 v34, v26, v27
  v_cvt_pk_bf16_f32 v35, v28, v29
  buffer_load_dwordx4 v[116:119], v3, s[12:15], s56 offen offset:3072 sc1
  v_permlane16_swap_b32 v32, v34
  v_permlane16_swap_b32 v33, v35
  buffer_store_dwordx4 v[32:35], v9, s[12:15], s59 offen sc1
  s_waitcnt lgkmcnt(3)
  v_pk_mul_f32 v[48:49], v[48:49], v[78:79] op_sel:[0,0] op_sel_hi:[1,0]
  v_pk_mul_f32 v[50:51], v[50:51], v[78:79] op_sel:[0,0] op_sel_hi:[1,0]
  v_pk_fma_f32 v[26:27], v[48:49], v[48:49], s[60:61]
  v_pk_fma_f32 v[28:29], v[50:51], v[50:51], s[60:61]
  v_pk_mul_f32 v[26:27], v[26:27], v[48:49]
  v_pk_mul_f32 v[28:29], v[28:29], v[50:51]
  v_exp_f32 v26, v26
  v_exp_f32 v27, v27
  v_exp_f32 v28, v28
  v_exp_f32 v29, v29
  v_pk_add_f32 v[26:27], v[26:27], s[62:63]
  v_pk_add_f32 v[28:29], v[28:29], s[62:63]
  v_rcp_f32 v26, v26
  v_rcp_f32 v27, v27
  v_rcp_f32 v28, v28
  v_rcp_f32 v29, v29
  v_pk_mul_f32 v[26:27], v[26:27], v[48:49]
  v_pk_mul_f32 v[28:29], v[28:29], v[50:51]
  v_cvt_pk_bf16_f32 v36, v26, v27
  v_cvt_pk_bf16_f32 v37, v28, v29
  s_add_u32 s56, s28, 8192
  buffer_load_dwordx4 v[120:123], v3, s[12:15], s56 offen offset:0 sc1
  v_pk_mul_f32 v[52:53], v[52:53], v[78:79] op_sel:[0,1] op_sel_hi:[1,1]
  v_pk_mul_f32 v[54:55], v[54:55], v[78:79] op_sel:[0,1] op_sel_hi:[1,1]
  v_pk_fma_f32 v[26:27], v[52:53], v[52:53], s[60:61]
  v_pk_fma_f32 v[28:29], v[54:55], v[54:55], s[60:61]
  v_pk_mul_f32 v[26:27], v[26:27], v[52:53]
  v_pk_mul_f32 v[28:29], v[28:29], v[54:55]
  v_exp_f32 v26, v26
  v_exp_f32 v27, v27
  v_exp_f32 v28, v28
  v_exp_f32 v29, v29
  v_pk_add_f32 v[26:27], v[26:27], s[62:63]
  v_pk_add_f32 v[28:29], v[28:29], s[62:63]
  v_rcp_f32 v26, v26
  v_rcp_f32 v27, v27
  v_rcp_f32 v28, v28
  v_rcp_f32 v29, v29
  v_pk_mul_f32 v[26:27], v[26:27], v[52:53]
  v_pk_mul_f32 v[28:29], v[28:29], v[54:55]
  v_cvt_pk_bf16_f32 v38, v26, v27
  v_cvt_pk_bf16_f32 v39, v28, v29
  buffer_load_dwordx4 v[124:127], v3, s[12:15], s56 offen offset:1024 sc1
  v_permlane16_swap_b32 v36, v38
  v_permlane16_swap_b32 v37, v39
  buffer_store_dwordx4 v[36:39], v10, s[12:15], s59 offen sc1
  v_pk_mul_f32 v[72:73], v[72:73], v[76:77] op_sel:[0,0] op_sel_hi:[1,0]
  v_pk_mul_f32 v[74:75], v[74:75], v[76:77] op_sel:[0,0] op_sel_hi:[1,0]
  v_pk_fma_f32 v[26:27], v[72:73], v[72:73], s[60:61]
  v_pk_fma_f32 v[28:29], v[74:75], v[74:75], s[60:61]
  v_pk_mul_f32 v[26:27], v[26:27], v[72:73]
  v_pk_mul_f32 v[28:29], v[28:29], v[74:75]
  v_exp_f32 v26, v26
  v_exp_f32 v27, v27
  v_exp_f32 v28, v28
  v_exp_f32 v29, v29
  v_pk_add_f32 v[26:27], v[26:27], s[62:63]
  v_pk_add_f32 v[28:29], v[28:29], s[62:63]
  v_rcp_f32 v26, v26
  v_rcp_f32 v27, v27
  v_rcp_f32 v28, v28
  v_rcp_f32 v29, v29
  v_pk_mul_f32 v[26:27], v[26:27], v[72:73]
  v_pk_mul_f32 v[28:29], v[28:29], v[74:75]
  v_cvt_pk_bf16_f32 v72, v26, v27
  v_cvt_pk_bf16_f32 v73, v28, v29
  s_nop 0
  v_permlane16_swap_b32 v72, v74
  v_permlane16_swap_b32 v73, v75
  s_mov_b64 exec, 0xffff
  buffer_store_dwordx4 v[72:75], v8, s[12:15], s59 offen sc1
  s_mov_b64 exec, -1
  s_mul_i32 s20, s24, 5
  s_min_u32 s20, s20, 13
  s_lshl_b32 s20, s20, 10
  s_add_u32 s21, s20, s27
  s_waitcnt vmcnt(10)
  v_mfma_f32_16x16x32_bf16 v[56:59], v[88:91], v[184:187], 0
  s_barrier
  buffer_load_dwordx4 v[128:131], v3, s[12:15], s56 offen offset:2048 sc1
  s_mul_i32 s84, s25, 663552
  s_add_u32 s84, s84, 3702784
  v_mfma_f32_16x16x32_bf16 v[56:59], v[92:95], v[188:191], v[56:59]
  s_mul_i32 s3, s24, 18432
  s_add_u32 s84, s84, s3
  v_mfma_f32_16x16x32_bf16 v[56:59], v[96:99], v[192:195], v[56:59]
  s_mul_i32 s30, s25, 774144
  s_add_u32 s30, s30, 9011200
  v_mfma_f32_16x16x32_bf16 v[60:63], v[88:91], a[0:3], 0
  s_mul_i32 s3, s24, 21504
  s_add_u32 s30, s30, s3
  v_mfma_f32_16x16x32_bf16 v[60:63], v[92:95], a[12:15], v[60:63]
  buffer_load_dwordx4 v[132:135], v3, s[12:15], s56 offen offset:3072 sc1
  s_mov_b32 s16, s52
  s_mov_b32 s17, s53
  v_mfma_f32_16x16x32_bf16 v[60:63], v[96:99], a[24:27], v[60:63]
  s_mov_b32 s18, 2359296
  s_mov_b32 s19, 0x20000
  v_mfma_f32_16x16x32_bf16 v[64:67], v[88:91], a[4:7], 0
  s_add_u32 m0, s20, 92160
  s_add_u32 s57, s21, 294912
  buffer_load_dwordx4 v3, s[12:15], s57 offen sc1 lds
  s_mul_i32 s29, s26, 1
  s_add_u32 s29, s25, s29
  s_and_b32 s29, s29, 7
  v_mfma_f32_16x16x32_bf16 v[64:67], v[92:95], a[16:19], v[64:67]
  s_mul_i32 s32, s26, 589824
  s_add_u32 s32, s32, 22020096
  v_mfma_f32_16x16x32_bf16 v[64:67], v[96:99], a[28:31], v[64:67]
  s_add_u32 s56, s28, 12288
  buffer_load_dwordx4 v[136:139], v3, s[12:15], s56 offen offset:0 sc1
  s_add_u32 s85, s29, 1
  s_and_b32 s85, s85, 7
  v_mfma_f32_16x16x32_bf16 v[68:71], v[88:91], a[8:11], 0
  s_mul_i32 s85, s85, 86016
  s_add_u32 s85, s85, s30
  v_mfma_f32_16x16x32_bf16 v[68:71], v[92:95], a[20:23], v[68:71]
  s_add_u32 m0, s20, 93184
  s_add_u32 s57, s21, 295936
  buffer_load_dwordx4 v3, s[12:15], s57 offen sc1 lds
  s_add_u32 s86, s29, 2
  s_and_b32 s86, s86, 7
  v_mfma_f32_16x16x32_bf16 v[68:71], v[96:99], a[32:35], v[68:71]
  s_mul_i32 s86, s86, 86016
  s_add_u32 s86, s86, s30
  s_waitcnt vmcnt(12)
  v_mfma_f32_16x16x32_bf16 v[56:59], v[100:103], v[196:199], v[56:59]
  buffer_load_dwordx4 v[140:143], v3, s[12:15], s56 offen offset:1024 sc1
  s_add_u32 s87, s29, 3
  s_and_b32 s87, s87, 7
  v_mfma_f32_16x16x32_bf16 v[56:59], v[104:107], v[200:203], v[56:59]
  s_mul_i32 s87, s87, 86016
  s_add_u32 s87, s87, s30
  v_mfma_f32_16x16x32_bf16 v[56:59], v[108:111], v[204:207], v[56:59]
  s_add_u32 m0, s20, 94208
  s_add_u32 s57, s21, 296960
  buffer_load_dwordx4 v3, s[12:15], s57 offen sc1 lds
  s_add_u32 s88, s29, 4
  s_and_b32 s88, s88, 7
  v_mfma_f32_16x16x32_bf16 v[60:63], v[100:103], a[36:39], v[60:63]
  s_mul_i32 s88, s88, 86016
  s_add_u32 s88, s88, s30
  v_mfma_f32_16x16x32_bf16 v[60:63], v[104:107], a[48:51], v[60:63]
  buffer_load_dwordx4 v[144:147], v3, s[12:15], s56 offen offset:2048 sc1
  s_add_u32 s89, s29, 5
  s_and_b32 s89, s89, 7
  v_mfma_f32_16x16x32_bf16 v[60:63], v[108:111], a[60:63], v[60:63]
  s_mul_i32 s89, s89, 86016
  s_add_u32 s89, s89, s30
  v_mfma_f32_16x16x32_bf16 v[64:67], v[100:103], a[40:43], v[64:67]
  s_add_u32 s90, s29, 6
  s_and_b32 s90, s90, 7
  v_mfma_f32_16x16x32_bf16 v[64:67], v[104:107], a[52:55], v[64:67]
  s_mul_i32 s90, s90, 86016
  s_add_u32 s90, s90, s30
  v_mfma_f32_16x16x32_bf16 v[64:67], v[108:111], a[64:67], v[64:67]
  buffer_load_dwordx4 v[148:151], v3, s[12:15], s56 offen offset:3072 sc1
  s_add_u32 s91, s29, 7
  s_and_b32 s91, s91, 7
  v_mfma_f32_16x16x32_bf16 v[68:71], v[100:103], a[44:47], v[68:71]
  s_mul_i32 s91, s91, 86016
  s_add_u32 s91, s91, s30
  v_mfma_f32_16x16x32_bf16 v[68:71], v[104:107], a[56:59], v[68:71]
  s_add_u32 s92, s29, 8
  s_and_b32 s92, s92, 7
  v_mfma_f32_16x16x32_bf16 v[68:71], v[108:111], a[68:71], v[68:71]
  s_mul_i32 s92, s92, 86016
  s_add_u32 s92, s92, s30
  s_waitcnt vmcnt(12)
  v_mfma_f32_16x16x32_bf16 v[56:59], v[112:115], v[208:211], v[56:59]
  s_add_u32 s56, s28, 16384
  buffer_load_dwordx4 v[152:155], v3, s[12:15], s56 offen offset:0 sc1
  s_mul_i32 s93, s24, 14336
  s_add_u32 s93, s93, 104448
  v_mfma_f32_16x16x32_bf16 v[56:59], v[116:119], v[212:215], v[56:59]
  s_lshl_b32 s3, s25, 13
  s_add_u32 s35, s3, s32
  v_mfma_f32_16x16x32_bf16 v[56:59], v[120:123], v[216:219], v[56:59]
  s_lshl_b32 s3, s24, 11
  s_add_u32 s35, s35, s3
  v_mfma_f32_16x16x32_bf16 v[60:63], v[112:115], a[72:75], v[60:63]
  s_mul_i32 s48, s24, 6144
  s_add_u32 s48, s48, 0
  v_mfma_f32_16x16x32_bf16 v[60:63], v[116:119], a[84:87], v[60:63]
  buffer_load_dwordx4 v[156:159], v3, s[12:15], s56 offen offset:1024 sc1
  s_cmp_eq_u32 s24, 3
  s_cselect_b32 s48, 157696, s48
  v_mfma_f32_16x16x32_bf16 v[60:63], v[120:123], a[96:99], v[60:63]
  s_mov_b32 s40, s50
  s_mov_b32 s41, s51
  v_mfma_f32_16x16x32_bf16 v[64:67], v[112:115], a[76:79], v[64:67]
  s_mov_b32 s42, 5308416
  s_mov_b32 s43, 0x20000
  v_mfma_f32_16x16x32_bf16 v[64:67], v[116:119], a[88:91], v[64:67]
  s_lshl_b32 s67, s2, 2
  s_add_u32 s67, s67, s24
  v_mfma_f32_16x16x32_bf16 v[64:67], v[120:123], a[100:103], v[64:67]
  s_mov_b64 exec, 0
  s_cmp_eq_u32 s24, 0
  s_cbranch_scc1 PAD_5
  s_cmp_eq_u32 s24, 1
  s_cbranch_scc1 PAD_6
  s_cmp_eq_u32 s24, 2
  s_cbranch_scc1 PAD_7
  s_branch PAD_8
WRET_1:
  s_mov_b64 exec, -1
  s_waitcnt vmcnt(11)
  s_barrier
  s_cmp_lg_u32 s24, 0
  s_cbranch_scc1 L_fs8
  s_mul_i32 s57, s99, 1152
  s_add_u32 s57, s57, 458752
  s_mov_b64 exec, 1
  buffer_store_dword v5, v6, s[12:15], s57 offen sc1
  s_mov_b64 exec, -1
L_fs8:
  ds_read_b64_tr_b16 a[216:217], v182 offset:0
  ds_read_b64_tr_b16 a[218:219], v182 offset:512
  ds_read_b64_tr_b16 a[220:221], v182 offset:1024
  ds_read_b64_tr_b16 a[222:223], v182 offset:1536
  ds_read_b64_tr_b16 a[224:225], v182 offset:2048
  ds_read_b64_tr_b16 a[226:227], v182 offset:2560
  ds_read_b64_tr_b16 a[240:241], v182 offset:3072
  ds_read_b64_tr_b16 a[242:243], v182 offset:3584
  ds_read_b64_tr_b16 a[244:245], v182 offset:4096
  ds_read_b64_tr_b16 a[246:247], v182 offset:4608
  ds_read_b64_tr_b16 a[248:249], v182 offset:5120
  ds_read_b64_tr_b16 a[250:251], v182 offset:5632
  s_add_u32 s56, s28, 73728
  buffer_load_dwordx4 v[160:163], v3, s[12:15], s56 offen offset:0 sc1
  s_lshl_b32 s67, s67, 1
  s_mul_i32 s68, s67, 21846
  v_mfma_f32_16x16x32_bf16 v[68:71], v[112:115], a[80:83], v[68:71]
  s_lshr_b32 s68, s68, 16
  s_mul_i32 s69, s68, 3
  v_mfma_f32_16x16x32_bf16 v[68:71], v[116:119], a[92:95], v[68:71]
  s_add_u32 m0, s20, 95232
  s_add_u32 s57, s21, 297984
  buffer_load_dwordx4 v3, s[12:15], s57 offen sc1 lds
  s_sub_u32 s69, s67, s69
  s_mul_i32 s44, s68, 9216
  v_mfma_f32_16x16x32_bf16 v[68:71], v[120:123], a[104:107], v[68:71]
  s_mul_i32 s1, s69, 384
  s_add_u32 s44, s44, s1
  s_waitcnt vmcnt(11)
  v_mfma_f32_16x16x32_bf16 v[56:59], v[124:127], v[220:223], v[56:59]
  buffer_load_dwordx4 v[164:167], v3, s[12:15], s56 offen offset:1024 sc1
  s_mul_i32 s46, s68, 911
  s_lshr_b32 s46, s46, 16
  v_mfma_f32_16x16x32_bf16 v[56:59], v[128:131], v[224:227], v[56:59]
  s_mul_i32 s46, s46, 755712
  s_lshl_b32 s1, s68, 8
  v_mfma_f32_16x16x32_bf16 v[56:59], v[132:135], v[228:231], v[56:59]
  s_add_u32 m0, s20, 96256
  s_add_u32 s57, s21, 299008
  buffer_load_dwordx4 v3, s[12:15], s57 offen sc1 lds
  s_add_u32 s46, s46, s1
  s_mul_i32 s1, s69, 258048
  v_mfma_f32_16x16x32_bf16 v[60:63], v[124:127], a[108:111], v[60:63]
  s_add_u32 s46, s46, s1
  s_add_u32 s46, s46, 9014272
  v_mfma_f32_16x16x32_bf16 v[60:63], v[128:131], a[120:123], v[60:63]
  buffer_load_dwordx4 v[168:171], v3, s[12:15], s56 offen offset:2048 sc1
  s_cmp_ge_u32 s67, 1728
  s_cselect_b32 s46, 536870912, s46
  v_mfma_f32_16x16x32_bf16 v[60:63], v[132:135], a[132:135], v[60:63]
  s_add_u32 s67, s67, 1
  s_mul_i32 s68, s67, 21846
  v_mfma_f32_16x16x32_bf16 v[64:67], v[124:127], a[112:115], v[64:67]
  buffer_load_dwordx4 v[172:175], v3, s[12:15], s56 offen offset:3072 sc1
  s_lshr_b32 s68, s68, 16
  s_mul_i32 s69, s68, 3
  v_mfma_f32_16x16x32_bf16 v[64:67], v[128:131], a[124:127], v[64:67]
  s_sub_u32 s69, s67, s69
  s_mul_i32 s45, s68, 9216
  v_mfma_f32_16x16x32_bf16 v[64:67], v[132:135], a[136:139], v[64:67]
  s_add_u32 s56, s28, 77824
  buffer_load_dwordx4 v[88:91], v3, s[12:15], s56 offen offset:0 sc1
  s_mul_i32 s1, s69, 384
  s_add_u32 s45, s45, s1
  v_mfma_f32_16x16x32_bf16 v[68:71], v[124:127], a[116:119], v[68:71]
  s_mul_i32 s47, s68, 911
  s_lshr_b32 s47, s47, 16
  v_mfma_f32_16x16x32_bf16 v[68:71], v[128:131], a[128:131], v[68:71]
  buffer_load_dwordx4 v[92:95], v3, s[12:15], s56 offen offset:1024 sc1
  s_mul_i32 s47, s47, 755712
  s_lshl_b32 s1, s68, 8
  v_mfma_f32_16x16x32_bf16 v[68:71], v[132:135], a[140:143], v[68:71]
  s_add_u32 s47, s47, s1
  s_mul_i32 s1, s69, 258048
  s_waitcnt vmcnt(11)
  v_mfma_f32_16x16x32_bf16 v[56:59], v[136:139], v[232:235], v[56:59]
  buffer_load_dwordx4 v[96:99], v3, s[12:15], s56 offen offset:2048 sc1
  s_add_u32 s47, s47, s1
  s_add_u32 s47, s47, 9014272
  v_mfma_f32_16x16x32_bf16 v[56:59], v[140:143], v[236:239], v[56:59]
  s_cmp_ge_u32 s67, 1728
  s_cselect_b32 s47, 536870912, s47
  v_mfma_f32_16x16x32_bf16 v[56:59], v[144:147], v[240:243], v[56:59]
  s_waitcnt lgkmcnt(10)
  buffer_store_dwordx4 a[216:219], v183, s[12:15], s98 offen sc1
  s_add_u32 s98, s98, s83
  v_mfma_f32_16x16x32_bf16 v[60:63], v[136:139], a[144:147], v[60:63]
  v_mfma_f32_16x16x32_bf16 v[60:63], v[140:143], a[156:159], v[60:63]
  s_and_b32 s3, s24, 1
  s_lshl_b32 s3, s3, 1
  s_add_u32 s3, s3, s26
  s_sub_u32 s3, s3, 1
  s_cmp_lt_u32 s3, 32
  s_cselect_b32 s3, s3, s26
  v_mov_b32 v11, s26
  v_mov_b32 v12, s3
  v_and_b32 v87, 2, v0
  v_cmp_eq_u32 vcc, 0, v87
  s_nop 1
  v_cndmask_b32 v11, v12, v11, vcc
  v_and_b32 v12, 1, v0
  v_lshl_add_u32 v11, v11, 3, v12
  s_lshl_b32 s3, s24, 1
  v_add_u32 v11, s3, v11
  v_mul_u32_u24 v11, 1152, v11
  s_mov_b32 s57, 458752
  buffer_load_dword v12, v11, s[12:15], s57 offen sc1
  s_lshr_b32 s3, s24, 1
  s_add_u32 s3, s3, 1
  s_sub_u32 s58, 0, s3
  s_bitcmp1_b32 s24, 0
  s_cselect_b32 s3, s3, s58
  s_lshl_b32 s58, s26, 6
  s_add_u32 s3, s3, s58
  v_add_u32 v84, s3, v0
  v_cmp_gt_u32 vcc, 2048, v84
  v_lshrrev_b32 v85, 6, v84
  v_mul_u32_u24 v85, 73728, v85
  v_and_b32 v84, 63, v84
  v_lshl_add_u32 v84, v84, 4, v85
  v_mov_b32 v85, 2147483648
  v_cndmask_b32 v84, v85, v84, vcc
  s_mul_i32 s60, s24, 18432
  buffer_load_dwordx4 v[100:103], v3, s[12:15], s56 offen offset:3072 sc1
  v_mfma_f32_16x16x32_bf16 v[60:63], v[144:147], a[168:171], v[60:63]
  v_mfma_f32_16x16x32_bf16 v[64:67], v[136:139], a[148:151], v[64:67]
  s_waitcnt lgkmcnt(8)
  buffer_store_dwordx4 a[220:223], v183, s[12:15], s98 offen sc1
  s_add_u32 s98, s98, s83
  v_mfma_f32_16x16x32_bf16 v[64:67], v[140:143], a[160:163], v[64:67]
  v_mfma_f32_16x16x32_bf16 v[64:67], v[144:147], a[172:175], v[64:67]
  s_add_u32 s56, s28, 81920
  buffer_load_dwordx4 v[104:107], v3, s[12:15], s56 offen offset:0 sc1
  v_mfma_f32_16x16x32_bf16 v[68:71], v[136:139], a[152:155], v[68:71]
  v_mfma_f32_16x16x32_bf16 v[68:71], v[140:143], a[164:167], v[68:71]
  s_waitcnt lgkmcnt(6)
  buffer_store_dwordx4 a[224:227], v183, s[12:15], s98 offen sc1
  v_mfma_f32_16x16x32_bf16 v[68:71], v[144:147], a[176:179], v[68:71]
  s_waitcnt vmcnt(15)
  v_mfma_f32_16x16x32_bf16 v[56:59], v[148:151], v[244:247], v[56:59]
  s_waitcnt vmcnt(11)
  s_waitcnt lgkmcnt(0)
  s_barrier
  buffer_load_dwordx4 v[108:111], v3, s[12:15], s56 offen offset:1024 sc1
  v_mfma_f32_16x16x32_bf16 v[56:59], v[152:155], v[248:251], v[56:59]
  v_mfma_f32_16x16x32_bf16 v[56:59], v[156:159], v[252:255], v[56:59]
  s_add_u32 m0, s20, 73728
  s_add_u32 s57, s21, 313344
  buffer_load_dwordx4 v3, s[12:15], s57 offen sc1 lds
  v_mfma_f32_16x16x32_bf16 v[60:63], v[148:151], a[180:183], v[60:63]
  v_mfma_f32_16x16x32_bf16 v[60:63], v[152:155], a[192:195], v[60:63]
  buffer_load_dwordx4 v[112:115], v3, s[12:15], s56 offen offset:2048 sc1
  v_mfma_f32_16x16x32_bf16 v[60:63], v[156:159], a[204:207], v[60:63]
  v_mfma_f32_16x16x32_bf16 v[64:67], v[148:151], a[184:187], v[64:67]
  s_add_u32 m0, s20, 74752
  s_add_u32 s57, s21, 314368
  buffer_load_dwordx4 v3, s[12:15], s57 offen sc1 lds
  v_mfma_f32_16x16x32_bf16 v[64:67], v[152:155], a[196:199], v[64:67]
  v_mfma_f32_16x16x32_bf16 v[64:67], v[156:159], a[208:211], v[64:67]
  buffer_load_dwordx4 v[116:119], v3, s[12:15], s56 offen offset:3072 sc1
  v_mfma_f32_16x16x32_bf16 v[68:71], v[148:151], a[188:191], v[68:71]
  v_mfma_f32_16x16x32_bf16 v[68:71], v[152:155], a[200:203], v[68:71]
  s_add_u32 m0, s20, 75776
  s_add_u32 s57, s21, 315392
  buffer_load_dwordx4 v3, s[12:15], s57 offen sc1 lds
  v_mfma_f32_16x16x32_bf16 v[68:71], v[156:159], a[212:215], v[68:71]
  ds_read_b128 a[216:219], v7 offset:18432
  ds_read_b128 a[220:223], v7 offset:19456
  s_waitcnt lgkmcnt(1)
  v_mfma_f32_16x16x32_bf16 v[72:75], a[216:219], v[184:187], 0
  ds_read_b128 a[224:227], v7 offset:20480
  v_mfma_f32_16x16x32_bf16 v[40:43], v[160:163], v[184:187], 0
  s_add_u32 s56, s28, 86016
  buffer_load_dwordx4 v[120:123], v3, s[12:15], s56 offen offset:0 sc1
  v_mfma_f32_16x16x32_bf16 v[44:47], v[160:163], a[0:3], 0
  buffer_load_dwordx4 v[124:127], v3, s[12:15], s56 offen offset:1024 sc1
  v_mfma_f32_16x16x32_bf16 v[48:51], v[160:163], a[4:7], 0
  s_add_u32 m0, s20, 76800
  s_add_u32 s57, s21, 316416
  buffer_load_dwordx4 v3, s[12:15], s57 offen sc1 lds
  s_lshl_b32 s3, s24, 2
  v_add_u32 v26, s3, v2
  v_mul_u32_u24 v26, 640, v26
  v_mfma_f32_16x16x32_bf16 v[52:55], v[160:163], a[8:11], 0
  v_add_u32 v26, 110720, v26
  s_waitcnt lgkmcnt(1)
  v_mfma_f32_16x16x32_bf16 v[72:75], a[220:223], v[188:191], v[72:75]
  ds_read_b128 a[216:219], v7 offset:21504
  v_bfe_u32 v27, v14, 1, 9
  v_add_u32 v27, v26, v27
  v_mfma_f32_16x16x32_bf16 v[40:43], v[164:167], v[188:191], v[40:43]
  buffer_load_dwordx4 v[128:131], v3, s[12:15], s56 offen offset:2048 sc1
  v_mul_f32 v56, v80, v56
  v_mul_f32 v57, v80, v57
  v_mfma_f32_16x16x32_bf16 v[44:47], v[164:167], a[12:15], v[44:47]
  buffer_load_dwordx4 v[132:135], v3, s[12:15], s56 offen offset:3072 sc1
  v_mul_f32 v58, v80, v58
  v_mul_f32 v59, v80, v59
  v_mfma_f32_16x16x32_bf16 v[48:51], v[164:167], a[16:19], v[48:51]
  s_add_u32 m0, s20, 77824
  s_add_u32 s57, s21, 317440
  buffer_load_dwordx4 v3, s[12:15], s57 offen sc1 lds
  v_cvt_pk_bf16_f32 v32, v56, v57
  v_cvt_pk_bf16_f32 v33, v58, v59
  v_mfma_f32_16x16x32_bf16 v[52:55], v[164:167], a[20:23], v[52:55]
  ds_write_b64 v27, v[32:33]
  s_waitcnt vmcnt(22) lgkmcnt(2)
  v_mfma_f32_16x16x32_bf16 v[72:75], a[224:227], v[192:195], v[72:75]
  ds_read_b128 a[220:223], v7 offset:22528
  v_bfe_u32 v27, v15, 1, 9
  v_add_u32 v27, v26, v27
  v_mfma_f32_16x16x32_bf16 v[40:43], v[168:171], v[192:195], v[40:43]
  s_waitcnt vmcnt(16)
  v_cmp_gt_u32 vcc, 1, v12
  s_mov_b32 s58, 0
  s_nop 3
  s_cbranch_vccz L_ok9
L_sp10:
  s_sleep 2
  s_mov_b32 s57, 458752
  buffer_load_dword v12, v11, s[12:15], s57 offen sc1
  s_add_u32 s58, s58, 1
  s_cmp_gt_u32 s58, 400000
  s_cbranch_scc1 L_ok9
  s_waitcnt vmcnt(0)
  v_cmp_gt_u32 vcc, 1, v12
  s_nop 4
  s_cbranch_vccnz L_sp10
L_ok9:
  s_add_u32 s56, s28, 90112
  buffer_load_dwordx4 v[136:139], v3, s[12:15], s56 offen offset:0 sc1
  v_mul_f32 v60, v81, v60
  v_mul_f32 v61, v81, v61
  v_mfma_f32_16x16x32_bf16 v[44:47], v[168:171], a[24:27], v[44:47]
  buffer_load_dwordx4 v[140:143], v3, s[12:15], s56 offen offset:1024 sc1
  v_mul_f32 v62, v81, v62
  v_mul_f32 v63, v81, v63
  v_mfma_f32_16x16x32_bf16 v[48:51], v[168:171], a[28:31], v[48:51]
  s_add_u32 m0, s60, 0
  s_add_u32 s57, s60, 15204352
  buffer_load_dwordx4 v84, s[12:15], s57 offen sc1 lds
  v_cvt_pk_bf16_f32 v34, v60, v61
  v_cvt_pk_bf16_f32 v35, v62, v63
  v_mfma_f32_16x16x32_bf16 v[52:55], v[168:171], a[32:35], v[52:55]
  ds_write_b64 v27, v[34:35]
  s_waitcnt lgkmcnt(3)
  v_mfma_f32_16x16x32_bf16 v[72:75], a[216:219], v[196:199], v[72:75]
  ds_read_b128 a[224:227], v7 offset:23552
  v_bfe_u32 v27, v16, 1, 9
  v_add_u32 v27, v26, v27
  v_mfma_f32_16x16x32_bf16 v[40:43], v[172:175], v[196:199], v[40:43]
  s_add_u32 m0, s60, 1024
  s_add_u32 s57, s60, 15205376
  buffer_load_dwordx4 v84, s[12:15], s57 offen sc1 lds
  v_mul_f32 v64, v82, v64
  v_mul_f32 v65, v82, v65
  v_mfma_f32_16x16x32_bf16 v[44:47], v[172:175], a[36:39], v[44:47]
  s_add_u32 m0, s60, 2048
  s_add_u32 s57, s60, 15206400
  buffer_load_dwordx4 v84, s[12:15], s57 offen sc1 lds
  v_mul_f32 v66, v82, v66
  v_mul_f32 v67, v82, v67
  v_mfma_f32_16x16x32_bf16 v[48:51], v[172:175], a[40:43], v[48:51]
  s_add_u32 m0, s60, 3072
  s_add_u32 s57, s60, 15207424
  buffer_load_dwordx4 v84, s[12:15], s57 offen sc1 lds
  v_cvt_pk_bf16_f32 v36, v64, v65
  v_cvt_pk_bf16_f32 v37, v66, v67
  v_mfma_f32_16x16x32_bf16 v[52:55], v[172:175], a[44:47], v[52:55]
  ds_write_b64 v27, v[36:37]
  s_waitcnt lgkmcnt(3)
  v_mfma_f32_16x16x32_bf16 v[72:75], a[220:223], v[200:203], v[72:75]
  ds_read_b128 a[216:219], v7 offset:24576
  v_bfe_u32 v27, v17, 1, 9
  v_add_u32 v27, v26, v27
  v_mfma_f32_16x16x32_bf16 v[40:43], v[88:91], v[200:203], v[40:43]
  s_add_u32 m0, s60, 4096
  s_add_u32 s57, s60, 15208448
  buffer_load_dwordx4 v84, s[12:15], s57 offen sc1 lds
  v_mul_f32 v68, v83, v68
  v_mul_f32 v69, v83, v69
  v_mfma_f32_16x16x32_bf16 v[44:47], v[88:91], a[48:51], v[44:47]
  s_add_u32 m0, s60, 5120
  s_add_u32 s57, s60, 15209472
  buffer_load_dwordx4 v84, s[12:15], s57 offen sc1 lds
  v_mul_f32 v70, v83, v70
  v_mul_f32 v71, v83, v71
  v_mfma_f32_16x16x32_bf16 v[48:51], v[88:91], a[52:55], v[48:51]
  s_add_u32 m0, s60, 6144
  s_add_u32 s57, s60, 15210496
  buffer_load_dwordx4 v84, s[12:15], s57 offen sc1 lds
  v_cvt_pk_bf16_f32 v38, v68, v69
  v_cvt_pk_bf16_f32 v39, v70, v71
  v_mfma_f32_16x16x32_bf16 v[52:55], v[88:91], a[56:59], v[52:55]
  ds_write_b64 v27, v[38:39]
  s_waitcnt lgkmcnt(3)
  v_mfma_f32_16x16x32_bf16 v[72:75], a[224:227], v[204:207], v[72:75]
  ds_read_b128 a[220:223], v7 offset:25600
  v_accvgpr_read_b32 v57, a228
  v_mfma_f32_16x16x32_bf16 v[40:43], v[92:95], v[204:207], v[40:43]
  s_add_u32 m0, s60, 7168
  s_add_u32 s57, s60, 15211520
  buffer_load_dwordx4 v84, s[12:15], s57 offen sc1 lds
  v_lshlrev_b32 v56, 16, v57
  v_and_b32 v57, 0xffff0000, v57
  v_mfma_f32_16x16x32_bf16 v[44:47], v[92:95], a[60:63], v[44:47]
  s_add_u32 m0, s60, 8192
  s_add_u32 s57, s60, 15212544
  buffer_load_dwordx4 v84, s[12:15], s57 offen sc1 lds
  v_mul_f32 v56, v80, v56
  v_mul_f32 v57, v80, v57
  v_mfma_f32_16x16x32_bf16 v[48:51], v[92:95], a[64:67], v[48:51]
  s_add_u32 m0, s60, 9216
  s_add_u32 s57, s60, 15213568
  buffer_load_dwordx4 v84, s[12:15], s57 offen sc1 lds
  v_accvgpr_read_b32 v59, a229
  v_mfma_f32_16x16x32_bf16 v[52:55], v[92:95], a[68:71], v[52:55]
  v_lshlrev_b32 v58, 16, v59
  v_and_b32 v59, 0xffff0000, v59
PAD_3:
  s_cbranch_execz WRET_0
  s_waitcnt lgkmcnt(2)
  v_mfma_f32_16x16x32_bf16 v[72:75], a[216:219], v[208:211], v[72:75]
  ds_read_b128 a[224:227], v7 offset:26624
  v_mul_f32 v58, v80, v58
  v_mul_f32 v59, v80, v59
  v_mfma_f32_16x16x32_bf16 v[40:43], v[96:99], v[208:211], v[40:43]
  s_add_u32 m0, s60, 10240
  s_add_u32 s57, s60, 15214592
  buffer_load_dwordx4 v84, s[12:15], s57 offen sc1 lds
  v_accvgpr_read_b32 v61, a230
  v_mfma_f32_16x16x32_bf16 v[44:47], v[96:99], a[72:75], v[44:47]
  v_lshlrev_b32 v60, 16, v61
  v_and_b32 v61, 0xffff0000, v61
  v_mfma_f32_16x16x32_bf16 v[48:51], v[96:99], a[76:79], v[48:51]
  v_mul_f32 v60, v81, v60
  v_mul_f32 v61, v81, v61
  v_mfma_f32_16x16x32_bf16 v[52:55], v[96:99], a[80:83], v[52:55]
  v_accvgpr_read_b32 v63, a231
  s_waitcnt vmcnt(28) lgkmcnt(1)
  v_mfma_f32_16x16x32_bf16 v[72:75], a[220:223], v[212:215], v[72:75]
  ds_read_b128 a[216:219], v7 offset:27648
  v_lshlrev_b32 v62, 16, v63
  v_and_b32 v63, 0xffff0000, v63
  v_mfma_f32_16x16x32_bf16 v[40:43], v[100:103], v[212:215], v[40:43]
  v_mul_f32 v62, v81, v62
  v_mul_f32 v63, v81, v63
  v_mfma_f32_16x16x32_bf16 v[44:47], v[100:103], a[84:87], v[44:47]
  v_accvgpr_read_b32 v65, a232
  v_mfma_f32_16x16x32_bf16 v[48:51], v[100:103], a[88:91], v[48:51]
  v_lshlrev_b32 v64, 16, v65
  v_and_b32 v65, 0xffff0000, v65
  v_mfma_f32_16x16x32_bf16 v[52:55], v[100:103], a[92:95], v[52:55]
  v_mul_f32 v64, v82, v64
  v_mul_f32 v65, v82, v65
  s_waitcnt vmcnt(26) lgkmcnt(1)
  v_mfma_f32_16x16x32_bf16 v[72:75], a[224:227], v[216:219], v[72:75]
  ds_read_b128 a[220:223], v7 offset:28672
  v_accvgpr_read_b32 v67, a233
  v_mfma_f32_16x16x32_bf16 v[40:43], v[104:107], v[216:219], v[40:43]
  v_lshlrev_b32 v66, 16, v67
  v_and_b32 v67, 0xffff0000, v67
  v_mfma_f32_16x16x32_bf16 v[44:47], v[104:107], a[96:99], v[44:47]
  v_mul_f32 v66, v82, v66
  v_mul_f32 v67, v82, v67
  v_mfma_f32_16x16x32_bf16 v[48:51], v[104:107], a[100:103], v[48:51]
  v_accvgpr_read_b32 v69, a234
  v_mfma_f32_16x16x32_bf16 v[52:55], v[104:107], a[104:107], v[52:55]
  v_lshlrev_b32 v68, 16, v69
  v_and_b32 v69, 0xffff0000, v69
  s_waitcnt vmcnt(24) lgkmcnt(1)
  v_mfma_f32_16x16x32_bf16 v[72:75], a[216:219], v[220:223], v[72:75]
  ds_read_b128 a[224:227], v7 offset:29696
  v_mul_f32 v68, v83, v68
  v_mul_f32 v69, v83, v69
  v_mfma_f32_16x16x32_bf16 v[40:43], v[108:111], v[220:223], v[40:43]
  v_accvgpr_read_b32 v71, a235
  v_mfma_f32_16x16x32_bf16 v[44:47], v[108:111], a[108:111], v[44:47]
  v_lshlrev_b32 v70, 16, v71
  v_and_b32 v71, 0xffff0000, v71
  v_mfma_f32_16x16x32_bf16 v[48:51], v[108:111], a[112:115], v[48:51]
  v_mul_f32 v70, v83, v70
  v_mul_f32 v71, v83, v71
  v_mfma_f32_16x16x32_bf16 v[52:55], v[108:111], a[116:119], v[52:55]
  v_accvgpr_read_b32 v77, a236
  s_waitcnt vmcnt(22) lgkmcnt(1)
  v_mfma_f32_16x16x32_bf16 v[72:75], a[220:223], v[224:227], v[72:75]
  ds_read_b128 a[216:219], v7 offset:30720
  v_lshlrev_b32 v76, 16, v77
  v_and_b32 v77, 0xffff0000, v77
  v_mfma_f32_16x16x32_bf16 v[40:43], v[112:115], v[224:227], v[40:43]
  v_mul_f32 v76, v80, v76
  v_mul_f32 v77, v80, v77
  v_mfma_f32_16x16x32_bf16 v[44:47], v[112:115], a[120:123], v[44:47]
  v_accvgpr_read_b32 v79, a237
  v_mfma_f32_16x16x32_bf16 v[48:51], v[112:115], a[124:127], v[48:51]
  v_lshlrev_b32 v78, 16, v79
  v_and_b32 v79, 0xffff0000, v79
  v_mfma_f32_16x16x32_bf16 v[52:55], v[112:115], a[128:131], v[52:55]
  v_mul_f32 v78, v80, v78
  v_mul_f32 v79, v80, v79
  s_waitcnt vmcnt(20) lgkmcnt(1)
  v_mfma_f32_16x16x32_bf16 v[72:75], a[224:227], v[228:231], v[72:75]
  ds_read_b128 a[220:223], v7 offset:31744
  v_lshrrev_b32 v28, 4, v4
  v_mul_u32_u24 v28, 1280, v28
  v_mfma_f32_16x16x32_bf16 v[40:43], v[116:119], v[228:231], v[40:43]
  v_lshl_add_u32 v28, v1, 4, v28
  v_add_u32 v178, 131328, v28
  v_mfma_f32_16x16x32_bf16 v[44:47], v[116:119], a[132:135], v[44:47]
  v_subrev_u32 v29, 32, v4
  v_lshrrev_b32 v28, 3, v29
  v_mfma_f32_16x16x32_bf16 v[48:51], v[116:119], a[136:139], v[48:51]
  v_mul_u32_u24 v28, 640, v28
  v_and_b32 v29, 7, v29
  v_mfma_f32_16x16x32_bf16 v[52:55], v[116:119], a[140:143], v[52:55]
  v_lshl_add_u32 v28, v29, 4, v28
  v_add_u32 v28, 110592, v28
  s_waitcnt vmcnt(18) lgkmcnt(1)
  v_mfma_f32_16x16x32_bf16 v[72:75], a[216:219], v[232:235], v[72:75]
  ds_read_b128 a[224:227], v7 offset:32768
  v_add_u32 v29, 20480, v178
  v_cmp_gt_u32 s[0:1], 32, v4
  v_mfma_f32_16x16x32_bf16 v[40:43], v[120:123], v[232:235], v[40:43]
  s_add_u32 m0, s60, 11264
  s_add_u32 s57, s60, 15215616
  buffer_load_dwordx4 v84, s[12:15], s57 offen sc1 lds
  v_lshlrev_b32 v86, 4, v4
  v_cndmask_b32 v179, v28, v29, s[0:1]
  v_mfma_f32_16x16x32_bf16 v[44:47], v[120:123], a[144:147], v[44:47]
  v_mov_b32 v29, 512
  v_mov_b32 v28, 1024
  v_mfma_f32_16x16x32_bf16 v[48:51], v[120:123], a[148:151], v[48:51]
  s_add_u32 m0, s60, 12288
  s_add_u32 s57, s60, 15216640
  buffer_load_dwordx4 v84, s[12:15], s57 offen sc1 lds
  v_cndmask_b32 v29, v29, v28, s[0:1]
  v_mov_b32 v28, 176
  v_mfma_f32_16x16x32_bf16 v[52:55], v[120:123], a[152:155], v[52:55]
  v_cmp_gt_u32 s[0:1], v28, v4
  v_mov_b32 v28, 157184
  s_waitcnt vmcnt(19) lgkmcnt(1)
  v_mfma_f32_16x16x32_bf16 v[72:75], a[220:223], v[236:239], v[72:75]
  ds_read_b128 a[216:219], v7 offset:33792
  v_cndmask_b32 v179, v28, v179, s[0:1]
  v_cndmask_b32 v29, 0, v29, s[0:1]
  v_mfma_f32_16x16x32_bf16 v[40:43], v[124:127], v[236:239], v[40:43]
  s_add_u32 m0, s60, 13312
  s_add_u32 s57, s60, 15217664
  buffer_load_dwordx4 v84, s[12:15], s57 offen sc1 lds
  v_add_u32 v29, v29, v179
  s_or_b64 s[100:101], s[0:1], 0xff
  v_mfma_f32_16x16x32_bf16 v[44:47], v[124:127], a[156:159], v[44:47]
  v_lshrrev_b32 v87, 3, v0
  v_mul_u32_u24 v176, 1152, v87
  v_mfma_f32_16x16x32_bf16 v[48:51], v[124:127], a[160:163], v[48:51]
  s_add_u32 m0, s60, 14336
  s_add_u32 s57, s60, 15218688
  buffer_load_dwordx4 v84, s[12:15], s57 offen sc1 lds
  v_lshrrev_b32 v87, 2, v0
  v_and_b32 v87, 4, v87
  v_mfma_f32_16x16x32_bf16 v[52:55], v[124:127], a[164:167], v[52:55]
  v_xor_b32 v87, v87, v0
  v_and_b32 v87, 7, v87
  s_waitcnt vmcnt(19) lgkmcnt(1)
  v_mfma_f32_16x16x32_bf16 v[72:75], a[224:227], v[240:243], v[72:75]
  ds_read_b128 a[220:223], v7 offset:34816
  v_lshl_add_u32 v176, v87, 4, v176
  v_bfe_u32 v87, v0, 2, 2
  v_mfma_f32_16x16x32_bf16 v[40:43], v[128:131], v[240:243], v[40:43]
  s_add_u32 m0, s60, 15360
  s_add_u32 s57, s60, 15219712
  buffer_load_dwordx4 v84, s[12:15], s57 offen sc1 lds
  v_lshl_add_u32 v177, v87, 7, s48
  v_and_b32 v87, 2, v87
  v_mfma_f32_16x16x32_bf16 v[44:47], v[128:131], a[168:171], v[44:47]
  v_xor_b32 v87, v87, v2
  v_lshl_add_u32 v177, v87, 5, v177
  v_mfma_f32_16x16x32_bf16 v[48:51], v[128:131], a[172:175], v[48:51]
  s_add_u32 m0, s60, 16384
  s_add_u32 s57, s60, 15220736
  buffer_load_dwordx4 v84, s[12:15], s57 offen sc1 lds
  v_and_b32 v87, 3, v0
  v_lshl_add_u32 v177, v87, 3, v177
  v_mfma_f32_16x16x32_bf16 v[52:55], v[128:131], a[176:179], v[52:55]
  s_waitcnt vmcnt(20) lgkmcnt(1)
  v_mfma_f32_16x16x32_bf16 v[72:75], a[216:219], v[244:247], v[72:75]
  ds_read_b128 a[224:227], v7 offset:35840
  v_mfma_f32_16x16x32_bf16 v[40:43], v[132:135], v[244:247], v[40:43]
  s_add_u32 m0, s60, 17408
  s_add_u32 s57, s60, 15221760
  buffer_load_dwordx4 v84, s[12:15], s57 offen sc1 lds
  v_mfma_f32_16x16x32_bf16 v[44:47], v[132:135], a[180:183], v[44:47]
  v_mfma_f32_16x16x32_bf16 v[48:51], v[132:135], a[184:187], v[48:51]
  buffer_store_dwordx4 a[240:243], v183, s[12:15], s82 offen sc1
  s_add_u32 s82, s82, s83
  v_mfma_f32_16x16x32_bf16 v[52:55], v[132:135], a[188:191], v[52:55]
  s_waitcnt vmcnt(20) lgkmcnt(1)
  v_mfma_f32_16x16x32_bf16 v[72:75], a[220:223], v[248:251], v[72:75]
  v_mfma_f32_16x16x32_bf16 v[40:43], v[136:139], v[248:251], v[40:43]
  s_add_u32 s56, s28, 147456
  buffer_load_dwordx4 v[144:147], v3, s[12:15], s56 offen offset:0 sc1
  v_mfma_f32_16x16x32_bf16 v[44:47], v[136:139], a[192:195], v[44:47]
  v_mfma_f32_16x16x32_bf16 v[48:51], v[136:139], a[196:199], v[48:51]
  buffer_store_dwordx4 a[244:247], v183, s[12:15], s82 offen sc1
  s_add_u32 s82, s82, s83
  v_mfma_f32_16x16x32_bf16 v[52:55], v[136:139], a[200:203], v[52:55]
  s_waitcnt vmcnt(21) lgkmcnt(0)
  v_mfma_f32_16x16x32_bf16 v[72:75], a[224:227], v[252:255], v[72:75]
  v_mfma_f32_16x16x32_bf16 v[40:43], v[140:143], v[252:255], v[40:43]
  buffer_load_dwordx4 v[148:151], v3, s[12:15], s56 offen offset:1024 sc1
  v_mfma_f32_16x16x32_bf16 v[44:47], v[140:143], a[204:207], v[44:47]
  v_mfma_f32_16x16x32_bf16 v[48:51], v[140:143], a[208:211], v[48:51]
  buffer_store_dwordx4 a[248:251], v183, s[12:15], s82 offen sc1
  v_mfma_f32_16x16x32_bf16 v[52:55], v[140:143], a[212:215], v[52:55]
  s_mul_i32 s3, s24, 5120
  s_add_u32 s3, s3, 131584
  v_lshl_add_u32 v26, v2, 8, s3
  v_pk_mul_f32 v[40:41], v[40:41], v[80:81] op_sel:[0,0] op_sel_hi:[1,0]
  v_pk_mul_f32 v[42:43], v[42:43], v[80:81] op_sel:[0,0] op_sel_hi:[1,0]
  v_add_u32 v27, v26, v14
  ds_write_b128 v27, v[40:43]
  v_pk_mul_f32 v[44:45], v[44:45], v[80:81] op_sel:[0,1] op_sel_hi:[1,1]
  v_pk_mul_f32 v[46:47], v[46:47], v[80:81] op_sel:[0,1] op_sel_hi:[1,1]
  v_add_u32 v27, v26, v15
  ds_write_b128 v27, v[44:47]
  v_pk_mul_f32 v[48:49], v[48:49], v[82:83] op_sel:[0,0] op_sel_hi:[1,0]
  v_pk_mul_f32 v[50:51], v[50:51], v[82:83] op_sel:[0,0] op_sel_hi:[1,0]
  v_add_u32 v27, v26, v16
  ds_write_b128 v27, v[48:51]
  v_pk_mul_f32 v[52:53], v[52:53], v[82:83] op_sel:[0,1] op_sel_hi:[1,1]
  v_pk_mul_f32 v[54:55], v[54:55], v[82:83] op_sel:[0,1] op_sel_hi:[1,1]
  v_add_u32 v27, v26, v17
  ds_write_b128 v27, v[52:55]
  v_pk_mul_f32 v[72:73], v[72:73], v[80:81] op_sel:[0,0] op_sel_hi:[1,0]
  v_pk_mul_f32 v[74:75], v[74:75], v[80:81] op_sel:[0,0] op_sel_hi:[1,0]
  v_cvt_pk_bf16_f32 v32, v72, v73
  v_cvt_pk_bf16_f32 v33, v74, v75
  v_lshl_add_u32 v26, v2, 8, v14
  v_lshrrev_b32 v27, 1, v26
  v_add_u32 v27, 120960, v27
  v_add_u32 v26, 149504, v26
  s_mov_b32 exec_hi, 0
  ds_write_b64 v27, v[32:33]
  s_mov_b32 exec_hi, -1
  s_mov_b32 exec_lo, 0
  ds_write_b128 v26, v[72:75]
  s_mov_b32 exec_lo, -1
  v_mov_b32 v84, v178
  v_mov_b32 v85, v179
  s_mov_b64 exec, 0
  s_cmp_eq_u32 s24, 0
  s_cbranch_scc1 PAD_9
  s_cmp_eq_u32 s24, 1
  s_cbranch_scc1 PAD_10
  s_cmp_eq_u32 s24, 2
  s_cbranch_scc1 PAD_11
  s_branch PAD_12
WRET_2:
  s_mov_b64 exec, -1
  buffer_load_dwordx4 v[152:155], v3, s[12:15], s56 offen offset:2048 sc1
  buffer_load_dwordx4 v[156:159], v3, s[12:15], s56 offen offset:3072 sc1
  s_add_u32 s56, s28, 151552
  buffer_load_dwordx4 v[160:163], v3, s[12:15], s56 offen offset:0 sc1
  buffer_load_dwordx4 v[164:167], v3, s[12:15], s56 offen offset:1024 sc1
  buffer_load_dwordx4 v[168:171], v3, s[12:15], s56 offen offset:2048 sc1
  buffer_load_dwordx4 v[172:175], v3, s[12:15], s56 offen offset:3072 sc1
  s_waitcnt vmcnt(11)
  s_waitcnt lgkmcnt(0)
  s_barrier
  ds_read_b128 a[216:219], v7 offset:0
  ds_read_b128 a[228:231], v14 offset:0
  ds_read_b128 a[232:235], v15 offset:0
  ds_read_b128 a[236:239], v16 offset:0
  ds_read_b128 a[240:243], v17 offset:0
  ds_read_b128 a[220:223], v7 offset:1024
  ds_read_b128 a[244:247], v14 offset:4096
  ds_read_b128 a[248:251], v15 offset:4096
  ds_read_b128 a[252:255], v16 offset:4096
  ds_read_b128 v[80:83], v17 offset:4096
  ds_read_b128 v[32:35], v14 offset:8192
  s_waitcnt vmcnt(9) lgkmcnt(6)
  v_mfma_f32_16x16x32_bf16 v[72:75], a[216:219], a[228:231], 0
  ds_read_b128 a[224:227], v7 offset:2048
  v_mfma_f32_16x16x32_bf16 v[40:43], v[144:147], a[228:231], 0
  ds_read_b128 v[36:39], v15 offset:8192
  ds_read_b128 v[180:183], v84 offset:1024
  ds_read_b128 v[26:29], v29
  s_add_u32 s56, s28, 155648
  buffer_load_dwordx4 v[88:91], v3, s[12:15], s56 offen offset:0 sc1
  v_mfma_f32_16x16x32_bf16 v[44:47], v[144:147], a[232:235], 0
  ds_read_b128 a[228:231], v16 offset:8192
  v_mfma_f32_16x16x32_bf16 v[48:51], v[144:147], a[236:239], 0
  ds_read_b128 a[232:235], v17 offset:8192
  v_mfma_f32_16x16x32_bf16 v[52:55], v[144:147], a[240:243], 0
  ds_read_b128 a[236:239], v14 offset:12288
  s_waitcnt vmcnt(8) lgkmcnt(8)
  v_mfma_f32_16x16x32_bf16 v[72:75], a[220:223], a[244:247], v[72:75]
  ds_read_b128 a[216:219], v7 offset:3072
  v_mfma_f32_16x16x32_bf16 v[40:43], v[148:151], a[244:247], v[40:43]
  ds_read_b128 a[240:243], v15 offset:12288
  buffer_load_dwordx4 v[92:95], v3, s[12:15], s56 offen offset:1024 sc1
  v_mfma_f32_16x16x32_bf16 v[44:47], v[148:151], a[248:251], v[44:47]
  ds_read_b128 a[244:247], v16 offset:12288
  v_mfma_f32_16x16x32_bf16 v[48:51], v[148:151], a[252:255], v[48:51]
  ds_read_b128 a[248:251], v17 offset:12288
  v_mfma_f32_16x16x32_bf16 v[52:55], v[148:151], v[80:83], v[52:55]
  ds_read_b128 a[252:255], v14 offset:16384
  s_waitcnt vmcnt(7) lgkmcnt(6)
  v_mfma_f32_16x16x32_bf16 v[72:75], a[224:227], v[32:35], v[72:75]
  ds_read_b128 a[220:223], v7 offset:4096
  v_mfma_f32_16x16x32_bf16 v[40:43], v[152:155], v[32:35], v[40:43]
  ds_read_b128 v[80:83], v15 offset:16384
  s_add_u32 s57, s36, 4096
  buffer_store_dwordx4 v[180:183], v86, s[12:15], s36 offen sc1
  s_mov_b64 exec, s[100:101]
  buffer_store_dwordx4 v[26:29], v86, s[12:15], s57 offen sc1
  s_mov_b64 exec, -1
  v_mfma_f32_16x16x32_bf16 v[44:47], v[152:155], v[36:39], v[44:47]
  ds_read_b128 v[32:35], v16 offset:16384
  v_mfma_f32_16x16x32_bf16 v[48:51], v[152:155], a[228:231], v[48:51]
  ds_read_b128 v[36:39], v17 offset:16384
  buffer_load_dwordx4 v[96:99], v3, s[12:15], s56 offen offset:2048 sc1
  v_mfma_f32_16x16x32_bf16 v[52:55], v[152:155], a[232:235], v[52:55]
  ds_read_b128 a[228:231], v14 offset:20480
  s_waitcnt vmcnt(9) lgkmcnt(6)
  v_mfma_f32_16x16x32_bf16 v[72:75], a[216:219], a[236:239], v[72:75]
  ds_read_b128 a[224:227], v7 offset:5120
  v_mfma_f32_16x16x32_bf16 v[40:43], v[156:159], a[236:239], v[40:43]
  ds_read_b128 a[232:235], v15 offset:20480
  buffer_load_dwordx4 v[100:103], v3, s[12:15], s56 offen offset:3072 sc1
  v_mfma_f32_16x16x32_bf16 v[44:47], v[156:159], a[240:243], v[44:47]
  ds_read_b128 a[236:239], v16 offset:20480
  v_mfma_f32_16x16x32_bf16 v[48:51], v[156:159], a[244:247], v[48:51]
  ds_read_b128 a[240:243], v17 offset:20480
  v_mfma_f32_16x16x32_bf16 v[52:55], v[156:159], a[248:251], v[52:55]
  ds_read_b128 a[244:247], v14 offset:24576
  s_waitcnt vmcnt(9) lgkmcnt(6)
  v_mfma_f32_16x16x32_bf16 v[72:75], a[220:223], a[252:255], v[72:75]
  ds_read_b128 a[216:219], v7 offset:6144
  v_mfma_f32_16x16x32_bf16 v[40:43], v[160:163], a[252:255], v[40:43]
  ds_read_b128 a[248:251], v15 offset:24576
  s_add_u32 s56, s28, 159744
  buffer_load_dwordx4 v[104:107], v3, s[12:15], s56 offen offset:0 sc1
  v_mfma_f32_16x16x32_bf16 v[44:47], v[160:163], v[80:83], v[44:47]
  ds_read_b128 a[252:255], v16 offset:24576
  v_mfma_f32_16x16x32_bf16 v[48:51], v[160:163], v[32:35], v[48:51]
  ds_read_b128 v[80:83], v17 offset:24576
  v_mfma_f32_16x16x32_bf16 v[52:55], v[160:163], v[36:39], v[52:55]
  ds_read_b128 v[32:35], v14 offset:28672
  s_waitcnt vmcnt(9) lgkmcnt(6)
  v_mfma_f32_16x16x32_bf16 v[72:75], a[224:227], a[228:231], v[72:75]
  ds_read_b128 a[220:223], v7 offset:7168
  v_mfma_f32_16x16x32_bf16 v[40:43], v[164:167], a[228:231], v[40:43]
  ds_read_b128 v[36:39], v15 offset:28672
  buffer_load_dwordx4 v[108:111], v3, s[12:15], s56 offen offset:1024 sc1
  v_mfma_f32_16x16x32_bf16 v[44:47], v[164:167], a[232:235], v[44:47]
  ds_read_b128 a[228:231], v16 offset:28672
  v_mfma_f32_16x16x32_bf16 v[48:51], v[164:167], a[236:239], v[48:51]
  ds_read_b128 a[232:235], v17 offset:28672
  v_mfma_f32_16x16x32_bf16 v[52:55], v[164:167], a[240:243], v[52:55]
  ds_read_b128 a[236:239], v14 offset:32768
  s_waitcnt vmcnt(9) lgkmcnt(6)
  v_mfma_f32_16x16x32_bf16 v[72:75], a[216:219], a[244:247], v[72:75]
  ds_read_b128 a[224:227], v7 offset:8192
  v_mfma_f32_16x16x32_bf16 v[40:43], v[168:171], a[244:247], v[40:43]
  ds_read_b128 a[240:243], v15 offset:32768
  buffer_load_dwordx4 v[112:115], v3, s[12:15], s56 offen offset:2048 sc1
  v_mfma_f32_16x16x32_bf16 v[44:47], v[168:171], a[248:251], v[44:47]
  ds_read_b128 a[244:247], v16 offset:32768
  v_mfma_f32_16x16x32_bf16 v[48:51], v[168:171], a[252:255], v[48:51]
  ds_read_b128 a[248:251], v17 offset:32768
  v_mfma_f32_16x16x32_bf16 v[52:55], v[168:171], v[80:83], v[52:55]
  ds_read_b128 a[252:255], v18 offset:0
  s_waitcnt vmcnt(9) lgkmcnt(6)
  v_mfma_f32_16x16x32_bf16 v[72:75], a[220:223], v[32:35], v[72:75]
  ds_read_b128 a[216:219], v7 offset:9216
  v_mfma_f32_16x16x32_bf16 v[40:43], v[172:175], v[32:35], v[40:43]
  ds_read_b128 v[80:83], v19 offset:0
  buffer_load_dwordx4 v[116:119], v3, s[12:15], s56 offen offset:3072 sc1
  v_mfma_f32_16x16x32_bf16 v[44:47], v[172:175], v[36:39], v[44:47]
  ds_read_b128 v[32:35], v20 offset:0
  v_mfma_f32_16x16x32_bf16 v[48:51], v[172:175], a[228:231], v[48:51]
  ds_read_b128 v[36:39], v21 offset:0
  v_mfma_f32_16x16x32_bf16 v[52:55], v[172:175], a[232:235], v[52:55]
  ds_read_b128 a[228:231], v18 offset:4096
  s_waitcnt vmcnt(9) lgkmcnt(6)
  v_mfma_f32_16x16x32_bf16 v[72:75], a[224:227], a[236:239], v[72:75]
  ds_read_b128 a[220:223], v7 offset:10240
  v_mfma_f32_16x16x32_bf16 v[40:43], v[88:91], a[236:239], v[40:43]
  ds_read_b128 a[232:235], v19 offset:4096
  s_add_u32 s56, s28, 163840
  buffer_load_dwordx4 v[120:123], v3, s[12:15], s56 offen offset:0 sc1
  v_mfma_f32_16x16x32_bf16 v[44:47], v[88:91], a[240:243], v[44:47]
  ds_read_b128 a[236:239], v20 offset:4096
  v_mfma_f32_16x16x32_bf16 v[48:51], v[88:91], a[244:247], v[48:51]
  ds_read_b128 a[240:243], v21 offset:4096
  v_mfma_f32_16x16x32_bf16 v[52:55], v[88:91], a[248:251], v[52:55]
  ds_read_b128 a[244:247], v18 offset:8192
  s_waitcnt vmcnt(9) lgkmcnt(6)
  v_mfma_f32_16x16x32_bf16 v[72:75], a[216:219], a[252:255], v[72:75]
  ds_read_b128 a[224:227], v7 offset:11264
  v_mfma_f32_16x16x32_bf16 v[40:43], v[92:95], a[252:255], v[40:43]
  ds_read_b128 a[248:251], v19 offset:8192
  buffer_load_dwordx4 v[124:127], v3, s[12:15], s56 offen offset:1024 sc1
  v_mfma_f32_16x16x32_bf16 v[44:47], v[92:95], v[80:83], v[44:47]
  ds_read_b128 a[252:255], v20 offset:8192
  v_mfma_f32_16x16x32_bf16 v[48:51], v[92:95], v[32:35], v[48:51]
  ds_read_b128 v[80:83], v21 offset:8192
  v_mfma_f32_16x16x32_bf16 v[52:55], v[92:95], v[36:39], v[52:55]
  ds_read_b128 v[32:35], v18 offset:12288
  s_waitcnt vmcnt(7) lgkmcnt(6)
  v_mfma_f32_16x16x32_bf16 v[72:75], a[220:223], a[228:231], v[72:75]
  ds_read_b128 a[216:219], v7 offset:12288
  v_mfma_f32_16x16x32_bf16 v[40:43], v[96:99], a[228:231], v[40:43]
  ds_read_b128 v[36:39], v19 offset:12288
  s_add_u32 s56, s28, 221184
  buffer_load_dwordx4 v[128:131], v3, s[12:15], s56 offen offset:0 sc1
  v_mfma_f32_16x16x32_bf16 v[44:47], v[96:99], a[232:235], v[44:47]
  ds_read_b128 a[228:231], v20 offset:12288
  v_mfma_f32_16x16x32_bf16 v[48:51], v[96:99], a[236:239], v[48:51]
  ds_read_b128 a[232:235], v21 offset:12288
  v_mfma_f32_16x16x32_bf16 v[52:55], v[96:99], a[240:243], v[52:55]
  ds_read_b128 a[236:239], v18 offset:16384
  s_waitcnt vmcnt(7) lgkmcnt(6)
  v_mfma_f32_16x16x32_bf16 v[72:75], a[224:227], a[244:247], v[72:75]
  ds_read_b128 a[220:223], v7 offset:13312
  v_mfma_f32_16x16x32_bf16 v[40:43], v[100:103], a[244:247], v[40:43]
  ds_read_b128 a[240:243], v19 offset:16384
  buffer_load_dwordx4 v[132:135], v3, s[12:15], s56 offen offset:1024 sc1
  v_mfma_f32_16x16x32_bf16 v[44:47], v[100:103], a[248:251], v[44:47]
  ds_read_b128 a[244:247], v20 offset:16384
  v_mfma_f32_16x16x32_bf16 v[48:51], v[100:103], a[252:255], v[48:51]
  ds_read_b128 a[248:251], v21 offset:16384
  v_mfma_f32_16x16x32_bf16 v[52:55], v[100:103], v[80:83], v[52:55]
  ds_read_b128 a[252:255], v18 offset:20480
  s_waitcnt vmcnt(7) lgkmcnt(6)
  v_mfma_f32_16x16x32_bf16 v[72:75], a[216:219], v[32:35], v[72:75]
  ds_read_b128 a[224:227], v7 offset:14336
  v_mfma_f32_16x16x32_bf16 v[40:43], v[104:107], v[32:35], v[40:43]
  ds_read_b128 v[80:83], v19 offset:20480
  buffer_load_dwordx4 v[136:139], v3, s[12:15], s56 offen offset:2048 sc1
  v_mfma_f32_16x16x32_bf16 v[44:47], v[104:107], v[36:39], v[44:47]
  ds_read_b128 v[32:35], v20 offset:20480
  v_mfma_f32_16x16x32_bf16 v[48:51], v[104:107], a[228:231], v[48:51]
  ds_read_b128 v[36:39], v21 offset:20480
  v_mfma_f32_16x16x32_bf16 v[52:55], v[104:107], a[232:235], v[52:55]
  ds_read_b128 a[228:231], v18 offset:24576
  s_waitcnt vmcnt(7) lgkmcnt(6)
  v_mfma_f32_16x16x32_bf16 v[72:75], a[220:223], a[236:239], v[72:75]
  ds_read_b128 a[216:219], v7 offset:15360
  v_mfma_f32_16x16x32_bf16 v[40:43], v[108:111], a[236:239], v[40:43]
  ds_read_b128 a[232:235], v19 offset:24576
  buffer_load_dwordx4 v[140:143], v3, s[12:15], s56 offen offset:3072 sc1
  v_mfma_f32_16x16x32_bf16 v[44:47], v[108:111], a[240:243], v[44:47]
  ds_read_b128 a[236:239], v20 offset:24576
  v_mfma_f32_16x16x32_bf16 v[48:51], v[108:111], a[244:247], v[48:51]
  ds_read_b128 a[240:243], v21 offset:24576
  v_mfma_f32_16x16x32_bf16 v[52:55], v[108:111], a[248:251], v[52:55]
  ds_read_b128 a[244:247], v18 offset:28672
  s_waitcnt vmcnt(7) lgkmcnt(6)
  v_mfma_f32_16x16x32_bf16 v[72:75], a[224:227], a[252:255], v[72:75]
  ds_read_b128 a[220:223], v7 offset:16384
  v_mfma_f32_16x16x32_bf16 v[40:43], v[112:115], a[252:255], v[40:43]
  ds_read_b128 a[248:251], v19 offset:28672
  s_barrier
  s_cmp_lg_u32 s24, 0
  s_cbranch_scc1 L_fs11
  s_mul_i32 s57, s99, 1152
  s_add_u32 s57, s57, 458880
  s_mov_b64 exec, 1
  buffer_store_dword v5, v6, s[12:15], s57 offen sc1
  s_mov_b64 exec, -1
L_fs11:
  s_cmp_lg_u32 s24, 0
  s_cbranch_scc1 L_fs12
  s_mul_i32 s57, s99, 4
  s_add_u32 s57, s57, 0
  s_mov_b64 exec, 1
  buffer_store_dword v5, v6, s[12:15], s57 offen sc1
  s_mov_b64 exec, -1
L_fs12:
  s_add_u32 s56, s28, 225280
  buffer_load_dwordx4 v[144:147], v3, s[12:15], s56 offen offset:0 sc1
  v_mfma_f32_16x16x32_bf16 v[44:47], v[112:115], v[80:83], v[44:47]
  ds_read_b128 a[252:255], v20 offset:28672
  v_mfma_f32_16x16x32_bf16 v[48:51], v[112:115], v[32:35], v[48:51]
  ds_read_b128 v[80:83], v21 offset:28672
  v_mfma_f32_16x16x32_bf16 v[52:55], v[112:115], v[36:39], v[52:55]
  ds_read_b128 v[32:35], v18 offset:32768
  s_waitcnt vmcnt(7) lgkmcnt(6)
  v_mfma_f32_16x16x32_bf16 v[72:75], a[216:219], a[228:231], v[72:75]
  ds_read_b128 a[224:227], v7 offset:17408
  v_mfma_f32_16x16x32_bf16 v[40:43], v[116:119], a[228:231], v[40:43]
  ds_read_b128 v[36:39], v19 offset:32768
  v_mfma_f32_16x16x32_bf16 v[44:47], v[116:119], a[232:235], v[44:47]
  ds_read_b128 a[228:231], v20 offset:32768
  v_mfma_f32_16x16x32_bf16 v[48:51], v[116:119], a[236:239], v[48:51]
  ds_read_b128 a[232:235], v21 offset:32768
  v_mfma_f32_16x16x32_bf16 v[52:55], v[116:119], a[240:243], v[52:55]
  buffer_load_dwordx4 v[148:151], v3, s[12:15], s56 offen offset:1024 sc1
  s_waitcnt vmcnt(7) lgkmcnt(5)
  v_mfma_f32_16x16x32_bf16 v[72:75], a[220:223], a[244:247], v[72:75]
  v_mfma_f32_16x16x32_bf16 v[40:43], v[120:123], a[244:247], v[40:43]
  buffer_load_dwordx4 v[152:155], v3, s[12:15], s56 offen offset:2048 sc1
  v_mfma_f32_16x16x32_bf16 v[44:47], v[120:123], a[248:251], v[44:47]
  v_mfma_f32_16x16x32_bf16 v[48:51], v[120:123], a[252:255], v[48:51]
  v_mfma_f32_16x16x32_bf16 v[52:55], v[120:123], v[80:83], v[52:55]
  s_waitcnt vmcnt(7) lgkmcnt(0)
  v_mfma_f32_16x16x32_bf16 v[72:75], a[224:227], v[32:35], v[72:75]
  v_mfma_f32_16x16x32_bf16 v[40:43], v[124:127], v[32:35], v[40:43]
  buffer_load_dwordx4 v[156:159], v3, s[12:15], s56 offen offset:3072 sc1
  v_mfma_f32_16x16x32_bf16 v[44:47], v[124:127], v[36:39], v[44:47]
  v_mfma_f32_16x16x32_bf16 v[48:51], v[124:127], a[228:231], v[48:51]
  v_mfma_f32_16x16x32_bf16 v[52:55], v[124:127], a[232:235], v[52:55]
  s_mov_b32 s60, 0xc0088e99
  s_mov_b32 s61, s60
  s_add_u32 s59, s31, 17563648
  s_nop 0
  v_pk_fma_f32 v[56:57], v[40:41], s[60:61], v[56:57]
  v_pk_fma_f32 v[58:59], v[42:43], s[60:61], v[58:59]
  v_cvt_pk_bf16_f32 v32, v56, v57
  v_cvt_pk_bf16_f32 v33, v58, v59
  v_pk_fma_f32 v[60:61], v[44:45], s[60:61], v[60:61]
  v_pk_fma_f32 v[62:63], v[46:47], s[60:61], v[62:63]
  v_cvt_pk_bf16_f32 v34, v60, v61
  v_cvt_pk_bf16_f32 v35, v62, v63
  s_nop 0
  v_permlane16_swap_b32 v32, v34
  v_permlane16_swap_b32 v33, v35
  buffer_store_dwordx4 v[32:35], v9, s[12:15], s59 offen sc1
  v_pk_fma_f32 v[64:65], v[48:49], s[60:61], v[64:65]
  v_pk_fma_f32 v[66:67], v[50:51], s[60:61], v[66:67]
  v_cvt_pk_bf16_f32 v36, v64, v65
  v_cvt_pk_bf16_f32 v37, v66, v67
  v_pk_fma_f32 v[68:69], v[52:53], s[60:61], v[68:69]
  v_pk_fma_f32 v[70:71], v[54:55], s[60:61], v[70:71]
  v_cvt_pk_bf16_f32 v38, v68, v69
  v_cvt_pk_bf16_f32 v39, v70, v71
  s_nop 0
  v_permlane16_swap_b32 v36, v38
  v_permlane16_swap_b32 v37, v39
  buffer_store_dwordx4 v[36:39], v10, s[12:15], s59 offen sc1
  v_pk_fma_f32 v[76:77], v[72:73], s[60:61], v[76:77]
  v_pk_fma_f32 v[78:79], v[74:75], s[60:61], v[78:79]
  v_cvt_pk_bf16_f32 v26, v76, v77
  v_cvt_pk_bf16_f32 v27, v78, v79
  s_nop 0
  v_permlane16_swap_b32 v26, v28
  v_permlane16_swap_b32 v27, v29
  s_mov_b64 exec, 0xffff
  buffer_store_dwordx4 v[26:29], v8, s[12:15], s59 offen sc1
  s_mov_b64 exec, -1
  ds_read_b128 a[216:219], v7 offset:0
  ds_read_b128 a[220:223], v7 offset:1024
  s_waitcnt vmcnt(10) lgkmcnt(1)
  v_mfma_f32_16x16x32_bf16 v[72:75], a[216:219], v[184:187], 0
  ds_read_b128 a[224:227], v7 offset:2048
  v_mul_u32_u24 v8, 21504, v2
  v_lshl_add_u32 v8, v1, 4, v8
  v_mfma_f32_16x16x32_bf16 v[56:59], v[128:131], v[184:187], 0
  s_add_u32 s56, s28, 229376
  buffer_load_dwordx4 v[160:163], v3, s[12:15], s56 offen offset:0 sc1
  v_bfe_u32 v26, v14, 1, 9
  v_add_u32 v26, 156672, v26
  v_mfma_f32_16x16x32_bf16 v[60:63], v[128:131], a[0:3], 0
  ds_read_b32 v180, v26 offset:4
  v_bfe_u32 v26, v15, 1, 9
  v_add_u32 v26, 156672, v26
  v_mfma_f32_16x16x32_bf16 v[64:67], v[128:131], a[4:7], 0
  buffer_load_dwordx4 v[164:167], v3, s[12:15], s56 offen offset:1024 sc1
  ds_read_b32 v181, v26 offset:4
  v_bfe_u32 v26, v16, 1, 9
  v_add_u32 v26, 156672, v26
  v_mfma_f32_16x16x32_bf16 v[68:71], v[128:131], a[8:11], 0
  ds_read_b32 v182, v26 offset:4
  v_bfe_u32 v26, v17, 1, 9
  v_add_u32 v26, 156672, v26
  s_waitcnt vmcnt(11) lgkmcnt(4)
  v_mfma_f32_16x16x32_bf16 v[72:75], a[220:223], v[188:191], v[72:75]
  ds_read_b128 a[216:219], v7 offset:3072
  ds_read_b32 v183, v26 offset:4
  s_lshr_b32 s67, s24, 1
  s_mul_i32 s67, s67, 9
  v_mfma_f32_16x16x32_bf16 v[56:59], v[132:135], v[188:191], v[56:59]
  buffer_load_dwordx4 v[168:171], v3, s[12:15], s56 offen offset:2048 sc1
  s_and_b32 s0, s24, 1
  s_mul_i32 s68, s0, 5
  v_mfma_f32_16x16x32_bf16 v[60:63], v[132:135], a[12:15], v[60:63]
  s_add_u32 s68, s67, s68
  s_add_u32 s69, s67, 4
  v_mfma_f32_16x16x32_bf16 v[64:67], v[132:135], a[16:19], v[64:67]
  buffer_load_dwordx4 v[172:175], v3, s[12:15], s56 offen offset:3072 sc1
  s_lshl_b32 s67, s0, 2
  v_lshlrev_b32 v51, 3, v0
  v_mfma_f32_16x16x32_bf16 v[68:71], v[132:135], a[20:23], v[68:71]
  s_lshl_b32 s0, s68, 9
  s_waitcnt vmcnt(12) lgkmcnt(5)
  v_mfma_f32_16x16x32_bf16 v[72:75], a[224:227], v[192:195], v[72:75]
  ds_read_b128 a[220:223], v7 offset:4096
  s_add_u32 s0, s0, 122112
  v_add_u32 v40, s0, v51
PAD_4:
  s_cbranch_execz WRET_0
  v_mfma_f32_16x16x32_bf16 v[56:59], v[136:139], v[192:195], v[56:59]
  s_sub_u32 s3, s26, 1
  s_max_i32 s3, s3, 0
  s_lshl_b32 s3, s3, 3
  s_add_u32 s3, s3, s25
  s_mul_i32 s3, s3, 1152
  v_mov_b32 v11, s3
  s_mov_b32 s57, 458880
  buffer_load_dword v12, v11, s[12:15], s57 offen sc1
  s_add_u32 s56, s28, 233472
  buffer_load_dwordx4 v[88:91], v3, s[12:15], s56 offen offset:0 sc1
  s_mul_i32 s0, s68, 640
  v_mfma_f32_16x16x32_bf16 v[60:63], v[136:139], a[24:27], v[60:63]
  s_add_u32 s1, s0, 110608
  v_add_u32 v42, s1, v51
  v_mfma_f32_16x16x32_bf16 v[64:67], v[136:139], a[28:31], v[64:67]
  s_lshl_b32 s0, s0, 1
  v_mfma_f32_16x16x32_bf16 v[68:71], v[136:139], a[32:35], v[68:71]
  s_add_u32 s0, s0, 131360
  v_add_u32 v44, s0, v3
  s_waitcnt vmcnt(13) lgkmcnt(2)
  v_mfma_f32_16x16x32_bf16 v[72:75], a[216:219], v[196:199], v[72:75]
  ds_read_b128 a[224:227], v7 offset:5120
  s_lshl_b32 s0, s69, 9
  s_add_u32 s0, s0, s67
  v_mfma_f32_16x16x32_bf16 v[56:59], v[140:143], v[196:199], v[56:59]
  buffer_load_dwordx4 v[92:95], v3, s[12:15], s56 offen offset:1024 sc1
  s_add_u32 s0, s0, 122112
  v_add_u32 v41, s0, v51
  v_mfma_f32_16x16x32_bf16 v[60:63], v[140:143], a[36:39], v[60:63]
  s_mul_i32 s0, s69, 640
  s_add_u32 s0, s0, s67
  v_mfma_f32_16x16x32_bf16 v[64:67], v[140:143], a[40:43], v[64:67]
  s_add_u32 s1, s0, 110608
  v_add_u32 v43, s1, v51
  v_mfma_f32_16x16x32_bf16 v[68:71], v[140:143], a[44:47], v[68:71]
  s_lshl_b32 s0, s0, 1
  s_waitcnt vmcnt(13) lgkmcnt(1)
  v_mfma_f32_16x16x32_bf16 v[72:75], a[220:223], v[200:203], v[72:75]
  ds_read_b128 a[216:219], v7 offset:6144
  s_add_u32 s0, s0, 131360
  v_add_u32 v45, s0, v3
  v_mfma_f32_16x16x32_bf16 v[56:59], v[144:147], v[200:203], v[56:59]
  buffer_load_dwordx4 v[96:99], v3, s[12:15], s56 offen offset:2048 sc1
  s_add_u32 s0, s68, 0
  v_mfma_f32_16x16x32_bf16 v[60:63], v[144:147], a[48:51], v[60:63]
  s_lshr_b32 s1, s0, 1
  s_lshl_b32 s1, s1, 10
  v_mfma_f32_16x16x32_bf16 v[64:67], v[144:147], a[52:55], v[64:67]
  s_and_b32 s0, s0, 1
  s_lshl_b32 s0, s0, 3
  v_mfma_f32_16x16x32_bf16 v[68:71], v[144:147], a[56:59], v[68:71]
  s_add_u32 s0, s0, s1
  s_add_u32 s0, s0, 92160
  s_waitcnt vmcnt(13) lgkmcnt(1)
  v_mfma_f32_16x16x32_bf16 v[72:75], a[224:227], v[204:207], v[72:75]
  ds_read_b128 a[220:223], v7 offset:7168
  v_add_u32 v46, s0, v3
  v_mfma_f32_16x16x32_bf16 v[56:59], v[148:151], v[204:207], v[56:59]
  buffer_load_dwordx4 v[100:103], v3, s[12:15], s56 offen offset:3072 sc1
  s_add_u32 s0, s68, 1
  v_mfma_f32_16x16x32_bf16 v[60:63], v[148:151], a[60:63], v[60:63]
  s_lshr_b32 s1, s0, 1
  s_lshl_b32 s1, s1, 10
  v_mfma_f32_16x16x32_bf16 v[64:67], v[148:151], a[64:67], v[64:67]
  s_and_b32 s0, s0, 1
  s_lshl_b32 s0, s0, 3
  v_mfma_f32_16x16x32_bf16 v[68:71], v[148:151], a[68:71], v[68:71]
  s_add_u32 s0, s0, s1
  s_add_u32 s0, s0, 92160
  s_waitcnt vmcnt(13) lgkmcnt(1)
  v_mfma_f32_16x16x32_bf16 v[72:75], a[216:219], v[208:211], v[72:75]
  ds_read_b128 a[224:227], v7 offset:8192
  v_add_u32 v47, s0, v3
  v_mfma_f32_16x16x32_bf16 v[56:59], v[152:155], v[208:211], v[56:59]
  s_add_u32 s56, s28, 237568
  buffer_load_dwordx4 v[104:107], v3, s[12:15], s56 offen offset:0 sc1
  s_add_u32 s0, s68, 2
  v_mfma_f32_16x16x32_bf16 v[60:63], v[152:155], a[72:75], v[60:63]
  s_lshr_b32 s1, s0, 1
  s_lshl_b32 s1, s1, 10
  v_mfma_f32_16x16x32_bf16 v[64:67], v[152:155], a[76:79], v[64:67]
  s_and_b32 s0, s0, 1
  s_lshl_b32 s0, s0, 3
  v_mfma_f32_16x16x32_bf16 v[68:71], v[152:155], a[80:83], v[68:71]
  s_add_u32 s0, s0, s1
  s_add_u32 s0, s0, 92160
  s_waitcnt vmcnt(13) lgkmcnt(1)
  v_mfma_f32_16x16x32_bf16 v[72:75], a[220:223], v[212:215], v[72:75]
  ds_read_b128 a[216:219], v7 offset:9216
  v_add_u32 v48, s0, v3
  v_mfma_f32_16x16x32_bf16 v[56:59], v[156:159], v[212:215], v[56:59]
  buffer_load_dwordx4 v[108:111], v3, s[12:15], s56 offen offset:1024 sc1
  s_add_u32 s0, s68, 3
  v_mfma_f32_16x16x32_bf16 v[60:63], v[156:159], a[84:87], v[60:63]
  s_lshr_b32 s1, s0, 1
  s_lshl_b32 s1, s1, 10
  v_mfma_f32_16x16x32_bf16 v[64:67], v[156:159], a[88:91], v[64:67]
  s_and_b32 s0, s0, 1
  s_lshl_b32 s0, s0, 3
  v_mfma_f32_16x16x32_bf16 v[68:71], v[156:159], a[92:95], v[68:71]
  s_add_u32 s0, s0, s1
  s_add_u32 s0, s0, 92160
  s_waitcnt vmcnt(10) lgkmcnt(1)
  v_mfma_f32_16x16x32_bf16 v[72:75], a[224:227], v[216:219], v[72:75]
  ds_read_b128 a[220:223], v7 offset:10240
  v_add_u32 v49, s0, v3
  v_mfma_f32_16x16x32_bf16 v[56:59], v[160:163], v[216:219], v[56:59]
  s_barrier
  s_cmp_lg_u32 s24, 0
  s_cbranch_scc1 L_fs13
  s_mul_i32 s57, s99, 1152
  s_add_u32 s57, s57, 459008
  s_mov_b64 exec, 1
  buffer_store_dword v5, v6, s[12:15], s57 offen sc1
  s_mov_b64 exec, -1
L_fs13:
  s_waitcnt vmcnt(6)
  v_cmp_gt_u32 vcc, 1, v12
  s_mov_b32 s58, 0
  s_nop 3
  s_cbranch_vccz L_ok14
L_sp15:
  s_sleep 2
  s_mov_b32 s57, 458880
  buffer_load_dword v12, v11, s[12:15], s57 offen sc1
  s_add_u32 s58, s58, 1
  s_cmp_gt_u32 s58, 400000
  s_cbranch_scc1 L_ok14
  s_waitcnt vmcnt(0)
  v_cmp_gt_u32 vcc, 1, v12
  s_nop 4
  s_cbranch_vccnz L_sp15
L_ok14:
  s_cmp_eq_u32 s26, 0
  s_cselect_b32 s3, 2147483648, 0
  v_add_u32 v86, s3, v86
  s_sub_u32 s36, s36, 65536
  s_add_u32 s57, s36, 4096
  buffer_load_dwordx4 v[76:79], v86, s[12:15], s36 offen sc1
  s_mov_b64 exec, s[100:101]
  buffer_load_dwordx4 v[80:83], v86, s[12:15], s57 offen sc1
  s_mov_b64 exec, -1
  s_mov_b32 s0, s69
  v_mfma_f32_16x16x32_bf16 v[60:63], v[160:163], a[96:99], v[60:63]
  s_lshr_b32 s1, s0, 1
  s_lshl_b32 s1, s1, 10
  v_mfma_f32_16x16x32_bf16 v[64:67], v[160:163], a[100:103], v[64:67]
  s_and_b32 s0, s0, 1
  s_lshl_b32 s0, s0, 3
  v_mfma_f32_16x16x32_bf16 v[68:71], v[160:163], a[104:107], v[68:71]
  s_add_u32 s0, s0, s1
  s_add_u32 s0, s0, 92160
  s_waitcnt lgkmcnt(1)
  v_mfma_f32_16x16x32_bf16 v[72:75], a[216:219], v[220:223], v[72:75]
  ds_read_b128 a[224:227], v7 offset:11264
  s_add_u32 s0, s0, s67
  v_add_u32 v50, s0, v3
  v_mfma_f32_16x16x32_bf16 v[56:59], v[164:167], v[220:223], v[56:59]
  s_add_u32 m0, s48, 0
  s_nop 0
  buffer_load_dwordx4 v176, s[40:43], s44 offen offset:0 nt lds
  v_lshrrev_b32 v26, 3, v0
  v_mul_u32_u24 v26, 1152, v26
  v_mfma_f32_16x16x32_bf16 v[60:63], v[164:167], a[108:111], v[60:63]
  v_xor_b32 v27, v2, v0
  v_and_b32 v27, 7, v27
  v_mfma_f32_16x16x32_bf16 v[64:67], v[164:167], a[112:115], v[64:67]
  v_lshl_add_u32 v52, v27, 4, v26
  v_xor_b32 v53, 64, v52
  v_mfma_f32_16x16x32_bf16 v[68:71], v[164:167], a[116:119], v[68:71]
  s_lshr_b32 s64, s25, 1
  s_and_b32 s63, s25, 1
  s_waitcnt lgkmcnt(1)
  v_mfma_f32_16x16x32_bf16 v[72:75], a[220:223], v[224:227], v[72:75]
  ds_read_b128 a[216:219], v7 offset:12288
  s_lshl_b32 s63, s63, 1
  s_xor_b32 s63, s63, s64
  v_mfma_f32_16x16x32_bf16 v[56:59], v[168:171], v[224:227], v[56:59]
  s_add_u32 m0, s48, 896
  s_nop 0
  buffer_load_dwordx4 v176, s[40:43], s44 offen offset:128 nt lds
  s_lshl_b32 s62, s29, 7
  s_add_u32 s62, s62, s31
  v_mfma_f32_16x16x32_bf16 v[60:63], v[168:171], a[120:123], v[60:63]
  s_mul_i32 s1, s24, 18432
  s_add_u32 s67, s62, s1
  v_mfma_f32_16x16x32_bf16 v[64:67], v[168:171], a[124:127], v[64:67]
  s_lshl_b32 s1, s24, 5
  s_add_u32 s62, s62, s1
  v_mfma_f32_16x16x32_bf16 v[68:71], v[168:171], a[128:131], v[68:71]
  s_lshl_b32 s60, s24, 11
  s_lshl_b32 s68, s29, 13
  s_waitcnt lgkmcnt(1)
  v_mfma_f32_16x16x32_bf16 v[72:75], a[224:227], v[228:231], v[72:75]
  ds_read_b128 a[220:223], v7 offset:13312
  s_add_u32 s68, s68, s31
  s_add_u32 s68, s68, s60
  v_mfma_f32_16x16x32_bf16 v[56:59], v[172:175], v[228:231], v[56:59]
  s_add_u32 m0, s48, 1792
  s_nop 0
  buffer_load_dwordx4 v176, s[40:43], s44 offen offset:256 nt lds
  s_add_u32 s68, s68, 17563648
  v_lshrrev_b32 v26, 3, v0
  v_mfma_f32_16x16x32_bf16 v[60:63], v[172:175], a[132:135], v[60:63]
  v_lshl_add_u32 v54, v26, 10, v3
  v_mul_u32_u24 v26, 896, v26
  v_mfma_f32_16x16x32_bf16 v[64:67], v[172:175], a[136:139], v[64:67]
  v_add_u32 v55, v26, v3
  s_add_u32 s61, s33, s31
  v_mfma_f32_16x16x32_bf16 v[68:71], v[172:175], a[140:143], v[68:71]
  s_add_u32 s61, s61, 1024
  s_lshl_b32 s1, s24, 5
  s_waitcnt vmcnt(10) lgkmcnt(1)
  v_mfma_f32_16x16x32_bf16 v[72:75], a[216:219], v[232:235], v[72:75]
  ds_read_b128 a[224:227], v7 offset:14336
  s_add_u32 s65, s61, s1
  s_lshl_b32 s69, s25, 7
  v_mfma_f32_16x16x32_bf16 v[56:59], v[88:91], v[232:235], v[56:59]
  s_add_u32 m0, s48, 3072
  s_nop 0
  buffer_load_dwordx4 v176, s[40:43], s45 offen offset:0 nt lds
  s_add_u32 s69, s69, s31
  s_add_u32 s69, s69, 17629184
  v_mfma_f32_16x16x32_bf16 v[60:63], v[88:91], a[144:147], v[60:63]
  s_lshl_b32 s66, s29, 16
  s_add_u32 s66, s66, s60
  v_mfma_f32_16x16x32_bf16 v[64:67], v[88:91], a[148:151], v[64:67]
  s_add_u32 s66, s66, s32
  v_mfma_f32_16x16x32_bf16 v[68:71], v[88:91], a[152:155], v[68:71]
  s_waitcnt vmcnt(10) lgkmcnt(1)
  v_mfma_f32_16x16x32_bf16 v[72:75], a[220:223], v[236:239], v[72:75]
  ds_read_b128 a[216:219], v7 offset:15360
  v_mfma_f32_16x16x32_bf16 v[56:59], v[92:95], v[236:239], v[56:59]
  s_add_u32 m0, s48, 3968
  s_nop 0
  buffer_load_dwordx4 v176, s[40:43], s45 offen offset:128 nt lds
  v_mfma_f32_16x16x32_bf16 v[60:63], v[92:95], a[156:159], v[60:63]
  v_mfma_f32_16x16x32_bf16 v[64:67], v[92:95], a[160:163], v[64:67]
  v_mfma_f32_16x16x32_bf16 v[68:71], v[92:95], a[164:167], v[68:71]
  s_waitcnt vmcnt(10) lgkmcnt(1)
  v_mfma_f32_16x16x32_bf16 v[72:75], a[224:227], v[240:243], v[72:75]
  ds_read_b128 a[220:223], v7 offset:16384
  v_mfma_f32_16x16x32_bf16 v[56:59], v[96:99], v[240:243], v[56:59]
  s_add_u32 m0, s48, 4864
  s_nop 0
  buffer_load_dwordx4 v176, s[40:43], s45 offen offset:256 nt lds
  v_mfma_f32_16x16x32_bf16 v[60:63], v[96:99], a[168:171], v[60:63]
  v_mfma_f32_16x16x32_bf16 v[64:67], v[96:99], a[172:175], v[64:67]
  v_mfma_f32_16x16x32_bf16 v[68:71], v[96:99], a[176:179], v[68:71]
  s_waitcnt vmcnt(10) lgkmcnt(1)
  v_mfma_f32_16x16x32_bf16 v[72:75], a[216:219], v[244:247], v[72:75]
  ds_read_b128 a[224:227], v7 offset:17408
  v_mfma_f32_16x16x32_bf16 v[56:59], v[100:103], v[244:247], v[56:59]
  v_and_b32 v9, 7, v0
  s_lshl_b32 s3, s26, 3
  v_add_u32 v9, s3, v9
  v_mul_u32_u24 v9, 1152, v9
  s_mov_b32 s57, 459008
  buffer_load_dword v10, v9, s[12:15], s57 offen sc1
  v_mfma_f32_16x16x32_bf16 v[60:63], v[100:103], a[180:183], v[60:63]
  v_mfma_f32_16x16x32_bf16 v[64:67], v[100:103], a[184:187], v[64:67]
  v_mfma_f32_16x16x32_bf16 v[68:71], v[100:103], a[188:191], v[68:71]
  s_waitcnt vmcnt(10) lgkmcnt(1)
  v_mfma_f32_16x16x32_bf16 v[72:75], a[220:223], v[248:251], v[72:75]
  v_mfma_f32_16x16x32_bf16 v[56:59], v[104:107], v[248:251], v[56:59]
  v_mfma_f32_16x16x32_bf16 v[60:63], v[104:107], a[192:195], v[60:63]
  v_mfma_f32_16x16x32_bf16 v[64:67], v[104:107], a[196:199], v[64:67]
  v_mfma_f32_16x16x32_bf16 v[68:71], v[104:107], a[200:203], v[68:71]
  s_waitcnt vmcnt(9) lgkmcnt(0)
  v_mfma_f32_16x16x32_bf16 v[72:75], a[224:227], v[252:255], v[72:75]
  v_mfma_f32_16x16x32_bf16 v[56:59], v[108:111], v[252:255], v[56:59]
  v_mfma_f32_16x16x32_bf16 v[60:63], v[108:111], a[204:207], v[60:63]
  v_mfma_f32_16x16x32_bf16 v[64:67], v[108:111], a[208:211], v[64:67]
  v_mfma_f32_16x16x32_bf16 v[68:71], v[108:111], a[212:215], v[68:71]
  s_lshl_b32 s3, s24, 2
  v_add_u32 v26, s3, v2
  v_mul_u32_u24 v26, 512, v26
  v_add_u32 v26, 122112, v26
  v_bfe_u32 v27, v14, 1, 9
  v_add_u32 v27, v26, v27
  v_pk_mul_f32 v[56:57], v[56:57], v[180:181] op_sel:[0,0] op_sel_hi:[1,0]
  v_pk_mul_f32 v[58:59], v[58:59], v[180:181] op_sel:[0,0] op_sel_hi:[1,0]
  v_cvt_pk_bf16_f32 v32, v56, v57
  v_cvt_pk_bf16_f32 v33, v58, v59
  ds_write_b64 v27, v[32:33]
  v_bfe_u32 v27, v15, 1, 9
  v_add_u32 v27, v26, v27
  v_pk_mul_f32 v[60:61], v[60:61], v[180:181] op_sel:[0,1] op_sel_hi:[1,1]
  v_pk_mul_f32 v[62:63], v[62:63], v[180:181] op_sel:[0,1] op_sel_hi:[1,1]
  v_cvt_pk_bf16_f32 v34, v60, v61
  v_cvt_pk_bf16_f32 v35, v62, v63
  ds_write_b64 v27, v[34:35]
  v_bfe_u32 v27, v16, 1, 9
  v_add_u32 v27, v26, v27
  v_pk_mul_f32 v[64:65], v[64:65], v[182:183] op_sel:[0,0] op_sel_hi:[1,0]
  v_pk_mul_f32 v[66:67], v[66:67], v[182:183] op_sel:[0,0] op_sel_hi:[1,0]
  v_cvt_pk_bf16_f32 v36, v64, v65
  v_cvt_pk_bf16_f32 v37, v66, v67
  ds_write_b64 v27, v[36:37]
  v_bfe_u32 v27, v17, 1, 9
  v_add_u32 v27, v26, v27
  v_pk_mul_f32 v[68:69], v[68:69], v[182:183] op_sel:[0,1] op_sel_hi:[1,1]
  v_pk_mul_f32 v[70:71], v[70:71], v[182:183] op_sel:[0,1] op_sel_hi:[1,1]
  v_cvt_pk_bf16_f32 v38, v68, v69
  v_cvt_pk_bf16_f32 v39, v70, v71
  ds_write_b64 v27, v[38:39]
  v_pk_mul_f32 v[72:73], v[72:73], v[180:181] op_sel:[0,0] op_sel_hi:[1,0]
  v_pk_mul_f32 v[74:75], v[74:75], v[180:181] op_sel:[0,0] op_sel_hi:[1,0]
  v_cvt_pk_bf16_f32 v28, v72, v73
  v_cvt_pk_bf16_f32 v29, v74, v75
  v_lshrrev_b32 v27, 1, v14
  v_add_u32 v27, 129280, v27
  s_mov_b32 exec_lo, 0
  ds_write_b64 v27, v[28:29]
  s_mov_b32 exec_lo, -1
  s_waitcnt vmcnt(8)
  ds_write_b128 v84, v[76:79]
  s_waitcnt vmcnt(7)
  ds_write_b128 v85, v[80:83]
  s_waitcnt lgkmcnt(0)
  s_barrier
  ds_read_b64 v[88:89], v40 offset:0
  ds_read_b64 v[90:91], v40 offset:512
  ds_read_b64 v[92:93], v40 offset:1024
  ds_read_b64 v[94:95], v40 offset:1536
  ds_read_b32 v96, v41
  ds_read_b64 v[98:99], v42 offset:112
  ds_read_b64 v[100:101], v42 offset:752
  ds_read_b64 v[102:103], v42 offset:1392
  ds_read_b64 v[104:105], v42 offset:2032
  ds_read_b32 v106, v43 offset:112
  ds_read_b64 v[108:109], v42 offset:96
  ds_read_b64 v[110:111], v42 offset:736
  ds_read_b64 v[112:113], v42 offset:1376
  ds_read_b64 v[114:115], v42 offset:2016
  ds_read_b32 v116, v43 offset:96
  s_add_u32 m0, s60, 73728
  s_nop 0
  buffer_load_dwordx4 v52, s[8:11], s67 offen lds
  s_waitcnt lgkmcnt(5)
  ds_read_b64 v[118:119], v42 offset:80
  ds_read_b64 v[120:121], v42 offset:720
  ds_read_b64 v[122:123], v42 offset:1360
  ds_read_b64 v[124:125], v42 offset:2000
  ds_read_b32 v126, v43 offset:80
  v_dot2_f32_bf16 v32, v88, v98, 0
  v_dot2_f32_bf16 v32, v89, v99, v32
  v_dot2_f32_bf16 v32, v90, v100, v32
  v_dot2_f32_bf16 v32, v91, v101, v32
  v_dot2_f32_bf16 v32, v92, v102, v32
  v_dot2_f32_bf16 v32, v93, v103, v32
  v_dot2_f32_bf16 v32, v94, v104, v32
  v_dot2_f32_bf16 v32, v95, v105, v32
  v_dot2_f32_bf16 v32, v96, v106, v32
  s_add_u32 m0, s60, 74752
  s_add_u32 s67, s67, 9216
  buffer_load_dwordx4 v53, s[8:11], s67 offen lds
  s_waitcnt lgkmcnt(5)
  ds_read_b64 v[98:99], v42 offset:64
  ds_read_b64 v[100:101], v42 offset:704
  ds_read_b64 v[102:103], v42 offset:1344
  ds_read_b64 v[104:105], v42 offset:1984
  ds_read_b32 v106, v43 offset:64
  v_dot2_f32_bf16 v33, v88, v108, 0
  v_dot2_f32_bf16 v33, v89, v109, v33
  v_dot2_f32_bf16 v33, v90, v110, v33
  v_dot2_f32_bf16 v33, v91, v111, v33
  v_dot2_f32_bf16 v33, v92, v112, v33
  v_dot2_f32_bf16 v33, v93, v113, v33
  v_dot2_f32_bf16 v33, v94, v114, v33
  v_dot2_f32_bf16 v33, v95, v115, v33
  v_dot2_f32_bf16 v33, v96, v116, v33
  s_waitcnt vmcnt(2)
  v_cmp_gt_u32 vcc, 1, v10
  s_mov_b32 s58, 0
  s_nop 3
  s_cbranch_vccz L_ok16
L_sp17:
  s_sleep 2
  s_mov_b32 s57, 459008
  buffer_load_dword v10, v9, s[12:15], s57 offen sc1
  s_add_u32 s58, s58, 1
  s_cmp_gt_u32 s58, 400000
  s_cbranch_scc1 L_ok16
  s_waitcnt vmcnt(0)
  v_cmp_gt_u32 vcc, 1, v10
  s_nop 4
  s_cbranch_vccnz L_sp17
L_ok16:
  s_add_u32 s57, s31, 17563648
  buffer_load_dwordx4 v[184:187], v14, s[12:15], s57 offen sc1
  s_add_u32 s57, s31, 17567744
  buffer_load_dwordx4 v[188:191], v14, s[12:15], s57 offen sc1
  s_waitcnt lgkmcnt(5)
  ds_read_b64 v[108:109], v42 offset:48
  ds_read_b64 v[110:111], v42 offset:688
  ds_read_b64 v[112:113], v42 offset:1328
  ds_read_b64 v[114:115], v42 offset:1968
  ds_read_b32 v116, v43 offset:48
  v_dot2_f32_bf16 v34, v88, v118, 0
  v_dot2_f32_bf16 v34, v89, v119, v34
  v_dot2_f32_bf16 v34, v90, v120, v34
  v_dot2_f32_bf16 v34, v91, v121, v34
  v_dot2_f32_bf16 v34, v92, v122, v34
  v_dot2_f32_bf16 v34, v93, v123, v34
  v_dot2_f32_bf16 v34, v94, v124, v34
  v_dot2_f32_bf16 v34, v95, v125, v34
  v_dot2_f32_bf16 v34, v96, v126, v34
  s_add_u32 s57, s31, 17571840
  buffer_load_dwordx4 v[192:195], v14, s[12:15], s57 offen sc1
  s_add_u32 s57, s31, 17575936
  buffer_load_dwordx4 v[196:199], v14, s[12:15], s57 offen sc1
  s_waitcnt lgkmcnt(5)
  ds_read_b64 v[118:119], v42 offset:32
  ds_read_b64 v[120:121], v42 offset:672
  ds_read_b64 v[122:123], v42 offset:1312
  ds_read_b64 v[124:125], v42 offset:1952
  ds_read_b32 v126, v43 offset:32
  v_dot2_f32_bf16 v35, v88, v98, 0
  v_dot2_f32_bf16 v35, v89, v99, v35
  v_dot2_f32_bf16 v35, v90, v100, v35
  v_dot2_f32_bf16 v35, v91, v101, v35
  v_dot2_f32_bf16 v35, v92, v102, v35
  v_dot2_f32_bf16 v35, v93, v103, v35
  v_dot2_f32_bf16 v35, v94, v104, v35
  v_dot2_f32_bf16 v35, v95, v105, v35
  v_dot2_f32_bf16 v35, v96, v106, v35
  s_add_u32 s57, s31, 17580032
  buffer_load_dwordx4 v[200:203], v14, s[12:15], s57 offen sc1
  s_add_u32 s57, s31, 17584128
  buffer_load_dwordx4 v[204:207], v14, s[12:15], s57 offen sc1
  s_waitcnt lgkmcnt(5)
  ds_read_b64 v[98:99], v42 offset:16
  ds_read_b64 v[100:101], v42 offset:656
  ds_read_b64 v[102:103], v42 offset:1296
  ds_read_b64 v[104:105], v42 offset:1936
  ds_read_b32 v106, v43 offset:16
  v_dot2_f32_bf16 v36, v88, v108, 0
  v_dot2_f32_bf16 v36, v89, v109, v36
  v_dot2_f32_bf16 v36, v90, v110, v36
  v_dot2_f32_bf16 v36, v91, v111, v36
  v_dot2_f32_bf16 v36, v92, v112, v36
  v_dot2_f32_bf16 v36, v93, v113, v36
  v_dot2_f32_bf16 v36, v94, v114, v36
  v_dot2_f32_bf16 v36, v95, v115, v36
  v_dot2_f32_bf16 v36, v96, v116, v36
  s_add_u32 s57, s31, 17588224
  buffer_load_dwordx4 v[208:211], v14, s[12:15], s57 offen sc1
  s_add_u32 s57, s31, 17592320
  buffer_load_dwordx4 v[212:215], v14, s[12:15], s57 offen sc1
  s_waitcnt lgkmcnt(5)
  ds_read_b64 v[108:109], v42 offset:0
  ds_read_b64 v[110:111], v42 offset:640
  ds_read_b64 v[112:113], v42 offset:1280
  ds_read_b64 v[114:115], v42 offset:1920
  ds_read_b32 v116, v43 offset:0
  v_dot2_f32_bf16 v37, v88, v118, 0
  v_dot2_f32_bf16 v37, v89, v119, v37
  v_dot2_f32_bf16 v37, v90, v120, v37
  v_dot2_f32_bf16 v37, v91, v121, v37
  v_dot2_f32_bf16 v37, v92, v122, v37
  v_dot2_f32_bf16 v37, v93, v123, v37
  v_dot2_f32_bf16 v37, v94, v124, v37
  v_dot2_f32_bf16 v37, v95, v125, v37
  v_dot2_f32_bf16 v37, v96, v126, v37
  s_add_u32 s57, s31, 17596416
  buffer_load_dwordx4 v[216:219], v14, s[12:15], s57 offen sc1
  s_add_u32 s57, s31, 17600512
  buffer_load_dwordx4 v[220:223], v14, s[12:15], s57 offen sc1
  s_waitcnt lgkmcnt(5)
  ds_read_b128 v[128:131], v44 offset:224
  ds_read_b128 v[132:135], v44 offset:1504
  ds_read_b128 v[136:139], v44 offset:2784
  ds_read_b128 v[140:143], v44 offset:4064
  ds_read_b64 v[144:145], v45 offset:224
  v_dot2_f32_bf16 v38, v88, v98, 0
  v_dot2_f32_bf16 v38, v89, v99, v38
  v_dot2_f32_bf16 v38, v90, v100, v38
  v_dot2_f32_bf16 v38, v91, v101, v38
  v_dot2_f32_bf16 v38, v92, v102, v38
  v_dot2_f32_bf16 v38, v93, v103, v38
  v_dot2_f32_bf16 v38, v94, v104, v38
  v_dot2_f32_bf16 v38, v95, v105, v38
  v_dot2_f32_bf16 v38, v96, v106, v38
  s_add_u32 s57, s31, 17604608
  buffer_load_dwordx4 v[224:227], v14, s[12:15], s57 offen sc1
  s_add_u32 s57, s31, 17608704
  buffer_load_dwordx4 v[228:231], v14, s[12:15], s57 offen sc1
  s_waitcnt lgkmcnt(5)
  ds_read_b128 v[146:149], v44 offset:192
  ds_read_b128 v[150:153], v44 offset:1472
  ds_read_b128 v[154:157], v44 offset:2752
  ds_read_b128 v[158:161], v44 offset:4032
  ds_read_b64 v[162:163], v45 offset:192
  v_dot2_f32_bf16 v39, v88, v108, 0
  v_dot2_f32_bf16 v39, v89, v109, v39
  v_dot2_f32_bf16 v39, v90, v110, v39
  v_dot2_f32_bf16 v39, v91, v111, v39
  v_dot2_f32_bf16 v39, v92, v112, v39
  v_dot2_f32_bf16 v39, v93, v113, v39
  v_dot2_f32_bf16 v39, v94, v114, v39
  v_dot2_f32_bf16 v39, v95, v115, v39
  v_dot2_f32_bf16 v39, v96, v116, v39
  s_add_u32 s57, s31, 17612800
  buffer_load_dwordx4 v[232:235], v14, s[12:15], s57 offen sc1
  s_nop 0
  s_cmp_lg_u32 s26, 0
  s_cbranch_scc1 L_nm18
  v_mov_b32 v27, 0xcf7ce18f
  v_cmp_gt_u32 vcc, 2, v0
  s_nop 1
  v_cndmask_b32 v33, v33, v27, vcc
  v_cmp_gt_u32 vcc, 4, v0
  s_nop 1
  v_cndmask_b32 v34, v34, v27, vcc
  v_cmp_gt_u32 vcc, 6, v0
  s_nop 1
  v_cndmask_b32 v35, v35, v27, vcc
  v_cmp_gt_u32 vcc, 8, v0
  s_nop 1
  v_cndmask_b32 v36, v36, v27, vcc
  v_cmp_gt_u32 vcc, 10, v0
  s_nop 1
  v_cndmask_b32 v37, v37, v27, vcc
  v_cmp_gt_u32 vcc, 12, v0
  s_nop 1
  v_cndmask_b32 v38, v38, v27, vcc
  v_cmp_gt_u32 vcc, 14, v0
  s_nop 1
  v_cndmask_b32 v39, v39, v27, vcc
L_nm18:
  v_max3_f32 v26, v32, v33, v34
  v_max3_f32 v27, v35, v36, v37
  v_max3_f32 v26, v26, v38, v39
  v_max_f32 v26, v26, v27
  v_mov_b32 v27, 0x3eae1a93
  v_pk_add_f32 v[32:33], v[32:33], v[26:27] op_sel_hi:[1,0] neg_lo:[0,1] neg_hi:[0,1]
  v_pk_add_f32 v[34:35], v[34:35], v[26:27] op_sel_hi:[1,0] neg_lo:[0,1] neg_hi:[0,1]
  v_pk_add_f32 v[36:37], v[36:37], v[26:27] op_sel_hi:[1,0] neg_lo:[0,1] neg_hi:[0,1]
  v_pk_add_f32 v[38:39], v[38:39], v[26:27] op_sel_hi:[1,0] neg_lo:[0,1] neg_hi:[0,1]
  v_pk_mul_f32 v[32:33], v[32:33], v[26:27] op_sel:[0,1]
  v_pk_mul_f32 v[34:35], v[34:35], v[26:27] op_sel:[0,1]
  v_pk_mul_f32 v[36:37], v[36:37], v[26:27] op_sel:[0,1]
  v_pk_mul_f32 v[38:39], v[38:39], v[26:27] op_sel:[0,1]
  v_exp_f32 v32, v32
  v_exp_f32 v33, v33
  v_exp_f32 v34, v34
  v_exp_f32 v35, v35
  v_exp_f32 v36, v36
  v_exp_f32 v37, v37
  v_exp_f32 v38, v38
  v_exp_f32 v39, v39
  v_pk_add_f32 v[26:27], v[32:33], v[34:35]
  v_pk_add_f32 v[28:29], v[36:37], v[38:39]
  v_pk_add_f32 v[26:27], v[26:27], v[28:29]
  v_add_f32 v26, v26, v27
  v_rcp_f32 v26, v26
  s_nop 0
  v_mul_f32 v26, 0xbeeff558, v26
  v_pk_mul_f32 v[32:33], v[32:33], v[26:27] op_sel_hi:[1,0]
  v_pk_mul_f32 v[34:35], v[34:35], v[26:27] op_sel_hi:[1,0]
  v_pk_mul_f32 v[36:37], v[36:37], v[26:27] op_sel_hi:[1,0]
  v_pk_mul_f32 v[38:39], v[38:39], v[26:27] op_sel_hi:[1,0]
  s_add_u32 s57, s31, 17616896
  buffer_load_dwordx4 v[236:239], v14, s[12:15], s57 offen sc1
  s_waitcnt lgkmcnt(5)
  ds_read_b128 v[98:101], v44 offset:160
  ds_read_b128 v[102:105], v44 offset:1440
  ds_read_b128 v[106:109], v44 offset:2720
  ds_read_b128 v[110:113], v44 offset:4000
  ds_read_b64 v[114:115], v45 offset:160
  v_pk_mul_f32 v[56:57], v[128:129], v[32:33] op_sel_hi:[1,0]
  v_pk_mul_f32 v[58:59], v[130:131], v[32:33] op_sel_hi:[1,0]
  v_pk_mul_f32 v[60:61], v[132:133], v[32:33] op_sel_hi:[1,0]
  v_pk_mul_f32 v[62:63], v[134:135], v[32:33] op_sel_hi:[1,0]
  v_pk_mul_f32 v[64:65], v[136:137], v[32:33] op_sel_hi:[1,0]
  v_pk_mul_f32 v[66:67], v[138:139], v[32:33] op_sel_hi:[1,0]
  v_pk_mul_f32 v[68:69], v[140:141], v[32:33] op_sel_hi:[1,0]
  v_pk_mul_f32 v[70:71], v[142:143], v[32:33] op_sel_hi:[1,0]
  v_pk_mul_f32 v[164:165], v[144:145], v[32:33] op_sel_hi:[1,0]
  s_add_u32 s57, s31, 17620992
  buffer_load_dwordx4 v[240:243], v14, s[12:15], s57 offen sc1
  s_waitcnt lgkmcnt(5)
  ds_read_b128 v[128:131], v44 offset:128
  ds_read_b128 v[132:135], v44 offset:1408
  ds_read_b128 v[136:139], v44 offset:2688
  ds_read_b128 v[140:143], v44 offset:3968
  ds_read_b64 v[144:145], v45 offset:128
  v_pk_fma_f32 v[56:57], v[146:147], v[32:33], v[56:57] op_sel:[0,1,0] op_sel_hi:[1,1,1]
  v_pk_fma_f32 v[58:59], v[148:149], v[32:33], v[58:59] op_sel:[0,1,0] op_sel_hi:[1,1,1]
  v_pk_fma_f32 v[60:61], v[150:151], v[32:33], v[60:61] op_sel:[0,1,0] op_sel_hi:[1,1,1]
  v_pk_fma_f32 v[62:63], v[152:153], v[32:33], v[62:63] op_sel:[0,1,0] op_sel_hi:[1,1,1]
  v_pk_fma_f32 v[64:65], v[154:155], v[32:33], v[64:65] op_sel:[0,1,0] op_sel_hi:[1,1,1]
  v_pk_fma_f32 v[66:67], v[156:157], v[32:33], v[66:67] op_sel:[0,1,0] op_sel_hi:[1,1,1]
  v_pk_fma_f32 v[68:69], v[158:159], v[32:33], v[68:69] op_sel:[0,1,0] op_sel_hi:[1,1,1]
  v_pk_fma_f32 v[70:71], v[160:161], v[32:33], v[70:71] op_sel:[0,1,0] op_sel_hi:[1,1,1]
  v_pk_fma_f32 v[164:165], v[162:163], v[32:33], v[164:165] op_sel:[0,1,0] op_sel_hi:[1,1,1]
  s_add_u32 s57, s31, 17625088
  buffer_load_dwordx4 v[244:247], v14, s[12:15], s57 offen sc1
  s_waitcnt lgkmcnt(5)
  ds_read_b128 v[146:149], v44 offset:96
  ds_read_b128 v[150:153], v44 offset:1376
  ds_read_b128 v[154:157], v44 offset:2656
  ds_read_b128 v[158:161], v44 offset:3936
  ds_read_b64 v[162:163], v45 offset:96
  v_pk_fma_f32 v[56:57], v[98:99], v[34:35], v[56:57] op_sel:[0,0,0] op_sel_hi:[1,0,1]
  v_pk_fma_f32 v[58:59], v[100:101], v[34:35], v[58:59] op_sel:[0,0,0] op_sel_hi:[1,0,1]
  v_pk_fma_f32 v[60:61], v[102:103], v[34:35], v[60:61] op_sel:[0,0,0] op_sel_hi:[1,0,1]
  v_pk_fma_f32 v[62:63], v[104:105], v[34:35], v[62:63] op_sel:[0,0,0] op_sel_hi:[1,0,1]
  v_pk_fma_f32 v[64:65], v[106:107], v[34:35], v[64:65] op_sel:[0,0,0] op_sel_hi:[1,0,1]
  v_pk_fma_f32 v[66:67], v[108:109], v[34:35], v[66:67] op_sel:[0,0,0] op_sel_hi:[1,0,1]
  v_pk_fma_f32 v[68:69], v[110:111], v[34:35], v[68:69] op_sel:[0,0,0] op_sel_hi:[1,0,1]
  v_pk_fma_f32 v[70:71], v[112:113], v[34:35], v[70:71] op_sel:[0,0,0] op_sel_hi:[1,0,1]
  v_pk_fma_f32 v[164:165], v[114:115], v[34:35], v[164:165] op_sel:[0,0,0] op_sel_hi:[1,0,1]
  s_add_u32 s57, s31, 17629184
PAD_5:
  s_cbranch_execz WRET_1
  buffer_load_dwordx4 v[248:251], v14, s[12:15], s57 offen sc1
  s_waitcnt lgkmcnt(5)
  ds_read_b128 v[98:101], v44 offset:64
  ds_read_b128 v[102:105], v44 offset:1344
  ds_read_b128 v[106:109], v44 offset:2624
  ds_read_b128 v[110:113], v44 offset:3904
  ds_read_b64 v[114:115], v45 offset:64
  v_pk_fma_f32 v[56:57], v[128:129], v[34:35], v[56:57] op_sel:[0,1,0] op_sel_hi:[1,1,1]
  v_pk_fma_f32 v[58:59], v[130:131], v[34:35], v[58:59] op_sel:[0,1,0] op_sel_hi:[1,1,1]
  v_pk_fma_f32 v[60:61], v[132:133], v[34:35], v[60:61] op_sel:[0,1,0] op_sel_hi:[1,1,1]
  v_pk_fma_f32 v[62:63], v[134:135], v[34:35], v[62:63] op_sel:[0,1,0] op_sel_hi:[1,1,1]
  v_pk_fma_f32 v[64:65], v[136:137], v[34:35], v[64:65] op_sel:[0,1,0] op_sel_hi:[1,1,1]
  v_pk_fma_f32 v[66:67], v[138:139], v[34:35], v[66:67] op_sel:[0,1,0] op_sel_hi:[1,1,1]
  v_pk_fma_f32 v[68:69], v[140:141], v[34:35], v[68:69] op_sel:[0,1,0] op_sel_hi:[1,1,1]
  v_pk_fma_f32 v[70:71], v[142:143], v[34:35], v[70:71] op_sel:[0,1,0] op_sel_hi:[1,1,1]
  v_pk_fma_f32 v[164:165], v[144:145], v[34:35], v[164:165] op_sel:[0,1,0] op_sel_hi:[1,1,1]
  s_add_u32 s57, s31, 17633280
  buffer_load_dwordx4 v[252:255], v14, s[12:15], s57 offen sc1
  s_waitcnt lgkmcnt(5)
  ds_read_b128 v[128:131], v44 offset:32
  ds_read_b128 v[132:135], v44 offset:1312
  ds_read_b128 v[136:139], v44 offset:2592
  ds_read_b128 v[140:143], v44 offset:3872
  ds_read_b64 v[144:145], v45 offset:32
  v_pk_fma_f32 v[56:57], v[146:147], v[36:37], v[56:57] op_sel:[0,0,0] op_sel_hi:[1,0,1]
  v_pk_fma_f32 v[58:59], v[148:149], v[36:37], v[58:59] op_sel:[0,0,0] op_sel_hi:[1,0,1]
  v_pk_fma_f32 v[60:61], v[150:151], v[36:37], v[60:61] op_sel:[0,0,0] op_sel_hi:[1,0,1]
  v_pk_fma_f32 v[62:63], v[152:153], v[36:37], v[62:63] op_sel:[0,0,0] op_sel_hi:[1,0,1]
  v_pk_fma_f32 v[64:65], v[154:155], v[36:37], v[64:65] op_sel:[0,0,0] op_sel_hi:[1,0,1]
  v_pk_fma_f32 v[66:67], v[156:157], v[36:37], v[66:67] op_sel:[0,0,0] op_sel_hi:[1,0,1]
  v_pk_fma_f32 v[68:69], v[158:159], v[36:37], v[68:69] op_sel:[0,0,0] op_sel_hi:[1,0,1]
  v_pk_fma_f32 v[70:71], v[160:161], v[36:37], v[70:71] op_sel:[0,0,0] op_sel_hi:[1,0,1]
  v_pk_fma_f32 v[164:165], v[162:163], v[36:37], v[164:165] op_sel:[0,0,0] op_sel_hi:[1,0,1]
  s_mov_b32 s57, 0
  buffer_load_dwordx4 v[72:75], v3, s[12:15], s57 offen sc1
  s_waitcnt lgkmcnt(5)
  ds_read_b128 v[146:149], v44 offset:0
  ds_read_b128 v[150:153], v44 offset:1280
  ds_read_b128 v[154:157], v44 offset:2560
  ds_read_b128 v[158:161], v44 offset:3840
  ds_read_b64 v[162:163], v45 offset:0
  v_pk_fma_f32 v[56:57], v[98:99], v[36:37], v[56:57] op_sel:[0,1,0] op_sel_hi:[1,1,1]
  v_pk_fma_f32 v[58:59], v[100:101], v[36:37], v[58:59] op_sel:[0,1,0] op_sel_hi:[1,1,1]
  v_pk_fma_f32 v[60:61], v[102:103], v[36:37], v[60:61] op_sel:[0,1,0] op_sel_hi:[1,1,1]
  v_pk_fma_f32 v[62:63], v[104:105], v[36:37], v[62:63] op_sel:[0,1,0] op_sel_hi:[1,1,1]
  v_pk_fma_f32 v[64:65], v[106:107], v[36:37], v[64:65] op_sel:[0,1,0] op_sel_hi:[1,1,1]
  v_pk_fma_f32 v[66:67], v[108:109], v[36:37], v[66:67] op_sel:[0,1,0] op_sel_hi:[1,1,1]
  v_pk_fma_f32 v[68:69], v[110:111], v[36:37], v[68:69] op_sel:[0,1,0] op_sel_hi:[1,1,1]
  v_pk_fma_f32 v[70:71], v[112:113], v[36:37], v[70:71] op_sel:[0,1,0] op_sel_hi:[1,1,1]
  v_pk_fma_f32 v[164:165], v[114:115], v[36:37], v[164:165] op_sel:[0,1,0] op_sel_hi:[1,1,1]
  s_cmp_lg_u32 s24, 0
  s_cbranch_scc1 L_r0
  s_mov_b32 m0, 90112
  s_nop 0
  buffer_load_dwordx4 v54, s[8:11], s61 offen lds
L_r0:
  s_cmp_lg_u32 s24, 1
  s_cbranch_scc1 L_r1
  s_mov_b32 m0, 91136
  s_nop 0
  buffer_load_dwordx4 v55, s[12:15], s69 offen sc1 lds
L_r1:
  s_waitcnt lgkmcnt(5)
  v_pk_fma_f32 v[56:57], v[128:129], v[38:39], v[56:57] op_sel:[0,0,0] op_sel_hi:[1,0,1]
  v_pk_fma_f32 v[58:59], v[130:131], v[38:39], v[58:59] op_sel:[0,0,0] op_sel_hi:[1,0,1]
  v_pk_fma_f32 v[60:61], v[132:133], v[38:39], v[60:61] op_sel:[0,0,0] op_sel_hi:[1,0,1]
  v_pk_fma_f32 v[62:63], v[134:135], v[38:39], v[62:63] op_sel:[0,0,0] op_sel_hi:[1,0,1]
  v_pk_fma_f32 v[64:65], v[136:137], v[38:39], v[64:65] op_sel:[0,0,0] op_sel_hi:[1,0,1]
  v_pk_fma_f32 v[66:67], v[138:139], v[38:39], v[66:67] op_sel:[0,0,0] op_sel_hi:[1,0,1]
  v_pk_fma_f32 v[68:69], v[140:141], v[38:39], v[68:69] op_sel:[0,0,0] op_sel_hi:[1,0,1]
  v_pk_fma_f32 v[70:71], v[142:143], v[38:39], v[70:71] op_sel:[0,0,0] op_sel_hi:[1,0,1]
  v_pk_fma_f32 v[164:165], v[144:145], v[38:39], v[164:165] op_sel:[0,0,0] op_sel_hi:[1,0,1]
  s_waitcnt lgkmcnt(0)
  v_pk_fma_f32 v[56:57], v[146:147], v[38:39], v[56:57] op_sel:[0,1,0] op_sel_hi:[1,1,1]
  v_pk_fma_f32 v[58:59], v[148:149], v[38:39], v[58:59] op_sel:[0,1,0] op_sel_hi:[1,1,1]
  v_pk_fma_f32 v[60:61], v[150:151], v[38:39], v[60:61] op_sel:[0,1,0] op_sel_hi:[1,1,1]
  v_pk_fma_f32 v[62:63], v[152:153], v[38:39], v[62:63] op_sel:[0,1,0] op_sel_hi:[1,1,1]
  v_pk_fma_f32 v[64:65], v[154:155], v[38:39], v[64:65] op_sel:[0,1,0] op_sel_hi:[1,1,1]
  v_pk_fma_f32 v[66:67], v[156:157], v[38:39], v[66:67] op_sel:[0,1,0] op_sel_hi:[1,1,1]
  v_pk_fma_f32 v[68:69], v[158:159], v[38:39], v[68:69] op_sel:[0,1,0] op_sel_hi:[1,1,1]
  v_pk_fma_f32 v[70:71], v[160:161], v[38:39], v[70:71] op_sel:[0,1,0] op_sel_hi:[1,1,1]
  v_pk_fma_f32 v[164:165], v[162:163], v[38:39], v[164:165] op_sel:[0,1,0] op_sel_hi:[1,1,1]
  ds_read_b64_tr_b16 a[228:229], v177 offset:0
  ds_read_b64_tr_b16 a[230:231], v177 offset:512
  ds_read_b64_tr_b16 a[232:233], v177 offset:1024
  ds_read_b64_tr_b16 a[234:235], v177 offset:1536
  ds_read_b64_tr_b16 a[236:237], v177 offset:2048
  ds_read_b64_tr_b16 a[238:239], v177 offset:2560
  ds_read_b64_tr_b16 a[240:241], v177 offset:3072
  ds_read_b64_tr_b16 a[242:243], v177 offset:3584
  ds_read_b64_tr_b16 a[244:245], v177 offset:4096
  ds_read_b64_tr_b16 a[246:247], v177 offset:4608
  ds_read_b64_tr_b16 a[248:249], v177 offset:5120
  ds_read_b64_tr_b16 a[250:251], v177 offset:5632
  v_cvt_pk_bf16_f32 v88, v56, v57
  v_cvt_pk_bf16_f32 v89, v58, v59
  ds_write_b64 v46, v[88:89]
  v_cvt_pk_bf16_f32 v90, v60, v61
  v_cvt_pk_bf16_f32 v91, v62, v63
  ds_write_b64 v47, v[90:91]
  v_cvt_pk_bf16_f32 v92, v64, v65
  v_cvt_pk_bf16_f32 v93, v66, v67
  ds_write_b64 v48, v[92:93]
  v_cvt_pk_bf16_f32 v94, v68, v69
  v_cvt_pk_bf16_f32 v95, v70, v71
  ds_write_b64 v49, v[94:95]
  v_cvt_pk_bf16_f32 v96, v164, v165
  ds_write_b32 v50, v96
  s_min_u32 s3, s24, 2
  s_lshl_b32 s3, s3, 10
  s_add_u32 s3, s3, 101376
  v_add_u32 v26, s3, v3
  v_mov_b32 v28, 0
  v_mov_b32 v29, 0
  ds_write_b64 v26, v[28:29]
  ds_write_b64 v26, v[28:29] offset:8
  v_mov_b32 v32, 0x3f803f80
  v_mov_b32 v33, 0x3f803f80
  v_mov_b32 v34, 0x3f803f80
  v_mov_b32 v35, 0x3f803f80
  v_and_b32 v26, 1, v0
  v_cmp_eq_u32 s[0:1], 0, v26
  v_and_b32 v26, 2, v0
  v_cmp_eq_u32 s[94:95], 0, v26
  v_lshrrev_b32 v26, 2, v1
  v_cmp_eq_u32 s[96:97], v26, v2
  s_waitcnt vmcnt(18)
  v_mfma_f32_16x16x32_bf16 v[80:83], v[184:187], v[184:187], 0
  v_mfma_f32_16x16x32_bf16 v[76:79], v[32:35], v[184:187], 0
  s_add_u32 m0, s60, 81920
  s_nop 0
  buffer_load_dwordx4 v3, s[12:15], s68 offen offset:0 sc1 lds
  s_waitcnt vmcnt(18)
  v_mfma_f32_16x16x32_bf16 v[80:83], v[188:191], v[188:191], v[80:83]
  v_mfma_f32_16x16x32_bf16 v[76:79], v[32:35], v[188:191], v[76:79]
  s_add_u32 m0, s60, 81920
  s_nop 0
  buffer_load_dwordx4 v3, s[12:15], s68 offen offset:1024 sc1 lds
  s_waitcnt vmcnt(18)
  v_mfma_f32_16x16x32_bf16 v[80:83], v[192:195], v[192:195], v[80:83]
  v_mfma_f32_16x16x32_bf16 v[76:79], v[32:35], v[192:195], v[76:79]
  s_waitcnt vmcnt(17)
  v_mfma_f32_16x16x32_bf16 v[80:83], v[196:199], v[196:199], v[80:83]
  v_mfma_f32_16x16x32_bf16 v[76:79], v[32:35], v[196:199], v[76:79]
  s_waitcnt vmcnt(16)
  v_mfma_f32_16x16x32_bf16 v[80:83], v[200:203], v[200:203], v[80:83]
  v_mfma_f32_16x16x32_bf16 v[76:79], v[32:35], v[200:203], v[76:79]
  s_waitcnt vmcnt(2)
  v_min3_u32 v72, v72, v73, v74
  v_min_u32 v72, v72, v75
  v_cmp_eq_u32 vcc, 0, v72
  s_mov_b32 s58, 0
  s_nop 3
  s_cbranch_vccz L_ok19
L_sp20:
  s_sleep 8
  s_mov_b32 s57, 0
  buffer_load_dwordx4 v[72:75], v3, s[12:15], s57 offen sc1
  s_add_u32 s58, s58, 1
  s_cmp_gt_u32 s58, 400000
  s_cbranch_scc1 L_ok19
  s_waitcnt vmcnt(0)
  v_min3_u32 v72, v72, v73, v74
  v_min_u32 v72, v72, v75
  v_cmp_eq_u32 vcc, 0, v72
  s_nop 4
  s_cbranch_vccnz L_sp20
L_ok19:
  s_waitcnt lgkmcnt(0)
  s_barrier
  s_cmp_lg_u32 s2, 0
  s_cbranch_scc1 L_dz
  v_mov_b32 v72, 0
  v_lshlrev_b32 v73, 2, v4
  buffer_store_dword v72, v73, s[4:7], 0 offen sc1
L_dz:
  v_mfma_f32_16x16x32_bf16 v[80:83], v[204:207], v[204:207], v[80:83]
  v_mfma_f32_16x16x32_bf16 v[76:79], v[32:35], v[204:207], v[76:79]
  s_add_u32 s56, s84, 0
  buffer_load_dwordx4 v[88:91], v3, s[12:15], s56 offen offset:0 sc1
  v_mfma_f32_16x16x32_bf16 v[80:83], v[208:211], v[208:211], v[80:83]
  v_mfma_f32_16x16x32_bf16 v[76:79], v[32:35], v[208:211], v[76:79]
  v_mfma_f32_16x16x32_bf16 v[80:83], v[212:215], v[212:215], v[80:83]
  v_mfma_f32_16x16x32_bf16 v[76:79], v[32:35], v[212:215], v[76:79]
  buffer_load_dwordx4 v[92:95], v3, s[12:15], s56 offen offset:1024 sc1
  v_mfma_f32_16x16x32_bf16 v[80:83], v[216:219], v[216:219], v[80:83]
  v_mfma_f32_16x16x32_bf16 v[76:79], v[32:35], v[216:219], v[76:79]
  buffer_store_dwordx4 a[228:231], v8, s[12:15], s46 offen sc1
  s_add_u32 s46, s46, 86016
  v_mfma_f32_16x16x32_bf16 v[80:83], v[220:223], v[220:223], v[80:83]
  v_mfma_f32_16x16x32_bf16 v[76:79], v[32:35], v[220:223], v[76:79]
  buffer_load_dwordx4 v[96:99], v3, s[12:15], s56 offen offset:2048 sc1
  v_mfma_f32_16x16x32_bf16 v[80:83], v[224:227], v[224:227], v[80:83]
  v_mfma_f32_16x16x32_bf16 v[76:79], v[32:35], v[224:227], v[76:79]
  v_mfma_f32_16x16x32_bf16 v[80:83], v[228:231], v[228:231], v[80:83]
  v_mfma_f32_16x16x32_bf16 v[76:79], v[32:35], v[228:231], v[76:79]
  buffer_load_dwordx4 v[100:103], v3, s[12:15], s56 offen offset:3072 sc1
  v_mfma_f32_16x16x32_bf16 v[80:83], v[232:235], v[232:235], v[80:83]
  v_mfma_f32_16x16x32_bf16 v[76:79], v[32:35], v[232:235], v[76:79]
  buffer_store_dwordx4 a[232:235], v8, s[12:15], s46 offen sc1
  s_add_u32 s46, s46, 86016
  v_mfma_f32_16x16x32_bf16 v[80:83], v[236:239], v[236:239], v[80:83]
  v_mfma_f32_16x16x32_bf16 v[76:79], v[32:35], v[236:239], v[76:79]
  s_add_u32 s56, s84, 4096
  buffer_load_dwordx4 v[104:107], v3, s[12:15], s56 offen offset:0 sc1
  v_mfma_f32_16x16x32_bf16 v[80:83], v[240:243], v[240:243], v[80:83]
  v_mfma_f32_16x16x32_bf16 v[76:79], v[32:35], v[240:243], v[76:79]
  v_mfma_f32_16x16x32_bf16 v[80:83], v[244:247], v[244:247], v[80:83]
  v_mfma_f32_16x16x32_bf16 v[76:79], v[32:35], v[244:247], v[76:79]
  buffer_load_dwordx4 v[108:111], v3, s[12:15], s56 offen offset:1024 sc1
  v_mfma_f32_16x16x32_bf16 v[80:83], v[248:251], v[248:251], v[80:83]
  v_mfma_f32_16x16x32_bf16 v[76:79], v[32:35], v[248:251], v[76:79]
  buffer_store_dwordx4 a[236:239], v8, s[12:15], s46 offen sc1
  v_mfma_f32_16x16x32_bf16 v[80:83], v[252:255], v[252:255], v[80:83]
  v_mfma_f32_16x16x32_bf16 v[76:79], v[32:35], v[252:255], v[76:79]
  s_nop 6
  v_cndmask_b32 v80, v81, v80, s[0:1]
  v_cndmask_b32 v82, v83, v82, s[0:1]
  v_cndmask_b32 v26, v82, v80, s[94:95]
  v_cndmask_b32 v26, 0, v26, s[96:97]
  v_mul_f32 v76, 0x3ae38e39, v76
  v_mov_b32 v27, v26
  v_mul_f32 v77, v76, v76
  v_sub_f32 v77, 0x3727c5ac, v77
  v_permlane32_swap_b32 v26, v27
  v_add_f32 v26, v26, v27
  v_mov_b32 v27, v26
  s_nop 1
  v_permlane16_swap_b32 v26, v27
  v_add_f32 v26, v26, v27
  v_fmac_f32 v77, 0x3ae38e39, v26
  v_max_f32 v77, 0x3727c5ac, v77
  v_rsq_f32 v26, v77
  s_nop 0
  v_mul_f32 v26, 0xbeeff558, v26
  v_mul_f32 v27, v76, v26
  v_sub_f32 v27, 0, v27
  v_lshlrev_b32 v56, 16, v184
  v_and_b32 v57, 0xffff0000, v184
  v_lshlrev_b32 v58, 16, v185
  v_and_b32 v59, 0xffff0000, v185
  v_lshlrev_b32 v60, 16, v186
  v_and_b32 v61, 0xffff0000, v186
  v_lshlrev_b32 v62, 16, v187
  v_and_b32 v63, 0xffff0000, v187
  v_pk_fma_f32 v[56:57], v[56:57], v[26:27], v[26:27] op_sel:[0,0,1] op_sel_hi:[1,0,1]
  v_pk_fma_f32 v[58:59], v[58:59], v[26:27], v[26:27] op_sel:[0,0,1] op_sel_hi:[1,0,1]
  v_pk_fma_f32 v[60:61], v[60:61], v[26:27], v[26:27] op_sel:[0,0,1] op_sel_hi:[1,0,1]
  v_pk_fma_f32 v[62:63], v[62:63], v[26:27], v[26:27] op_sel:[0,0,1] op_sel_hi:[1,0,1]
  v_cvt_pk_bf16_f32 v184, v56, v57
  v_cvt_pk_bf16_f32 v185, v58, v59
  v_cvt_pk_bf16_f32 v186, v60, v61
  v_cvt_pk_bf16_f32 v187, v62, v63
  ds_write_b128 v14, v[184:187] offset:0
  buffer_store_dwordx4 a[240:243], v8, s[12:15], s47 offen sc1
  s_add_u32 s47, s47, 86016
  v_lshlrev_b32 v56, 16, v188
  v_and_b32 v57, 0xffff0000, v188
  v_lshlrev_b32 v58, 16, v189
  v_and_b32 v59, 0xffff0000, v189
  v_lshlrev_b32 v60, 16, v190
  v_and_b32 v61, 0xffff0000, v190
  v_lshlrev_b32 v62, 16, v191
  v_and_b32 v63, 0xffff0000, v191
  v_pk_fma_f32 v[56:57], v[56:57], v[26:27], v[26:27] op_sel:[0,0,1] op_sel_hi:[1,0,1]
  v_pk_fma_f32 v[58:59], v[58:59], v[26:27], v[26:27] op_sel:[0,0,1] op_sel_hi:[1,0,1]
  v_pk_fma_f32 v[60:61], v[60:61], v[26:27], v[26:27] op_sel:[0,0,1] op_sel_hi:[1,0,1]
  v_pk_fma_f32 v[62:63], v[62:63], v[26:27], v[26:27] op_sel:[0,0,1] op_sel_hi:[1,0,1]
  v_cvt_pk_bf16_f32 v188, v56, v57
  v_cvt_pk_bf16_f32 v189, v58, v59
  v_cvt_pk_bf16_f32 v190, v60, v61
  v_cvt_pk_bf16_f32 v191, v62, v63
  ds_write_b128 v14, v[188:191] offset:4096
  buffer_load_dwordx4 v[112:115], v3, s[12:15], s56 offen offset:2048 sc1
  v_lshlrev_b32 v56, 16, v192
  v_and_b32 v57, 0xffff0000, v192
  v_lshlrev_b32 v58, 16, v193
  v_and_b32 v59, 0xffff0000, v193
  v_lshlrev_b32 v60, 16, v194
  v_and_b32 v61, 0xffff0000, v194
  v_lshlrev_b32 v62, 16, v195
  v_and_b32 v63, 0xffff0000, v195
  v_pk_fma_f32 v[56:57], v[56:57], v[26:27], v[26:27] op_sel:[0,0,1] op_sel_hi:[1,0,1]
  v_pk_fma_f32 v[58:59], v[58:59], v[26:27], v[26:27] op_sel:[0,0,1] op_sel_hi:[1,0,1]
  v_pk_fma_f32 v[60:61], v[60:61], v[26:27], v[26:27] op_sel:[0,0,1] op_sel_hi:[1,0,1]
  v_pk_fma_f32 v[62:63], v[62:63], v[26:27], v[26:27] op_sel:[0,0,1] op_sel_hi:[1,0,1]
  v_cvt_pk_bf16_f32 v192, v56, v57
  v_cvt_pk_bf16_f32 v193, v58, v59
  v_cvt_pk_bf16_f32 v194, v60, v61
  v_cvt_pk_bf16_f32 v195, v62, v63
  ds_write_b128 v14, v[192:195] offset:8192
  buffer_load_dwordx4 v[116:119], v3, s[12:15], s56 offen offset:3072 sc1
  v_lshlrev_b32 v56, 16, v196
  v_and_b32 v57, 0xffff0000, v196
  v_lshlrev_b32 v58, 16, v197
  v_and_b32 v59, 0xffff0000, v197
  v_lshlrev_b32 v60, 16, v198
  v_and_b32 v61, 0xffff0000, v198
  v_lshlrev_b32 v62, 16, v199
  v_and_b32 v63, 0xffff0000, v199
  v_pk_fma_f32 v[56:57], v[56:57], v[26:27], v[26:27] op_sel:[0,0,1] op_sel_hi:[1,0,1]
  v_pk_fma_f32 v[58:59], v[58:59], v[26:27], v[26:27] op_sel:[0,0,1] op_sel_hi:[1,0,1]
  v_pk_fma_f32 v[60:61], v[60:61], v[26:27], v[26:27] op_sel:[0,0,1] op_sel_hi:[1,0,1]
  v_pk_fma_f32 v[62:63], v[62:63], v[26:27], v[26:27] op_sel:[0,0,1] op_sel_hi:[1,0,1]
  v_cvt_pk_bf16_f32 v196, v56, v57
  v_cvt_pk_bf16_f32 v197, v58, v59
  v_cvt_pk_bf16_f32 v198, v60, v61
  v_cvt_pk_bf16_f32 v199, v62, v63
  ds_write_b128 v14, v[196:199] offset:12288
  buffer_store_dwordx4 a[244:247], v8, s[12:15], s47 offen sc1
  s_add_u32 s47, s47, 86016
  v_lshlrev_b32 v56, 16, v200
  v_and_b32 v57, 0xffff0000, v200
  v_lshlrev_b32 v58, 16, v201
  v_and_b32 v59, 0xffff0000, v201
  v_lshlrev_b32 v60, 16, v202
  v_and_b32 v61, 0xffff0000, v202
  v_lshlrev_b32 v62, 16, v203
  v_and_b32 v63, 0xffff0000, v203
  v_pk_fma_f32 v[56:57], v[56:57], v[26:27], v[26:27] op_sel:[0,0,1] op_sel_hi:[1,0,1]
  v_pk_fma_f32 v[58:59], v[58:59], v[26:27], v[26:27] op_sel:[0,0,1] op_sel_hi:[1,0,1]
  v_pk_fma_f32 v[60:61], v[60:61], v[26:27], v[26:27] op_sel:[0,0,1] op_sel_hi:[1,0,1]
  v_pk_fma_f32 v[62:63], v[62:63], v[26:27], v[26:27] op_sel:[0,0,1] op_sel_hi:[1,0,1]
  v_cvt_pk_bf16_f32 v200, v56, v57
  v_cvt_pk_bf16_f32 v201, v58, v59
  v_cvt_pk_bf16_f32 v202, v60, v61
  v_cvt_pk_bf16_f32 v203, v62, v63
  ds_write_b128 v14, v[200:203] offset:16384
  s_add_u32 s56, s84, 8192
  buffer_load_dwordx4 v[120:123], v3, s[12:15], s56 offen offset:0 sc1
  v_lshlrev_b32 v56, 16, v204
  v_and_b32 v57, 0xffff0000, v204
  v_lshlrev_b32 v58, 16, v205
  v_and_b32 v59, 0xffff0000, v205
  v_lshlrev_b32 v60, 16, v206
  v_and_b32 v61, 0xffff0000, v206
  v_lshlrev_b32 v62, 16, v207
  v_and_b32 v63, 0xffff0000, v207
  v_pk_fma_f32 v[56:57], v[56:57], v[26:27], v[26:27] op_sel:[0,0,1] op_sel_hi:[1,0,1]
  v_pk_fma_f32 v[58:59], v[58:59], v[26:27], v[26:27] op_sel:[0,0,1] op_sel_hi:[1,0,1]
  v_pk_fma_f32 v[60:61], v[60:61], v[26:27], v[26:27] op_sel:[0,0,1] op_sel_hi:[1,0,1]
  v_pk_fma_f32 v[62:63], v[62:63], v[26:27], v[26:27] op_sel:[0,0,1] op_sel_hi:[1,0,1]
  v_cvt_pk_bf16_f32 v204, v56, v57
  v_cvt_pk_bf16_f32 v205, v58, v59
  v_cvt_pk_bf16_f32 v206, v60, v61
  v_cvt_pk_bf16_f32 v207, v62, v63
  ds_write_b128 v14, v[204:207] offset:20480
  buffer_load_dwordx4 v[124:127], v3, s[12:15], s56 offen offset:1024 sc1
  v_lshlrev_b32 v56, 16, v208
  v_and_b32 v57, 0xffff0000, v208
  v_lshlrev_b32 v58, 16, v209
  v_and_b32 v59, 0xffff0000, v209
  v_lshlrev_b32 v60, 16, v210
  v_and_b32 v61, 0xffff0000, v210
  v_lshlrev_b32 v62, 16, v211
  v_and_b32 v63, 0xffff0000, v211
  v_pk_fma_f32 v[56:57], v[56:57], v[26:27], v[26:27] op_sel:[0,0,1] op_sel_hi:[1,0,1]
  v_pk_fma_f32 v[58:59], v[58:59], v[26:27], v[26:27] op_sel:[0,0,1] op_sel_hi:[1,0,1]
  v_pk_fma_f32 v[60:61], v[60:61], v[26:27], v[26:27] op_sel:[0,0,1] op_sel_hi:[1,0,1]
  v_pk_fma_f32 v[62:63], v[62:63], v[26:27], v[26:27] op_sel:[0,0,1] op_sel_hi:[1,0,1]
  v_cvt_pk_bf16_f32 v208, v56, v57
  v_cvt_pk_bf16_f32 v209, v58, v59
  v_cvt_pk_bf16_f32 v210, v60, v61
  v_cvt_pk_bf16_f32 v211, v62, v63
  ds_write_b128 v14, v[208:211] offset:24576
  buffer_store_dwordx4 a[248:251], v8, s[12:15], s47 offen sc1
  v_lshlrev_b32 v56, 16, v212
  v_and_b32 v57, 0xffff0000, v212
  v_lshlrev_b32 v58, 16, v213
  v_and_b32 v59, 0xffff0000, v213
  v_lshlrev_b32 v60, 16, v214
  v_and_b32 v61, 0xffff0000, v214
  v_lshlrev_b32 v62, 16, v215
  v_and_b32 v63, 0xffff0000, v215
  v_pk_fma_f32 v[56:57], v[56:57], v[26:27], v[26:27] op_sel:[0,0,1] op_sel_hi:[1,0,1]
  v_pk_fma_f32 v[58:59], v[58:59], v[26:27], v[26:27] op_sel:[0,0,1] op_sel_hi:[1,0,1]
  v_pk_fma_f32 v[60:61], v[60:61], v[26:27], v[26:27] op_sel:[0,0,1] op_sel_hi:[1,0,1]
  v_pk_fma_f32 v[62:63], v[62:63], v[26:27], v[26:27] op_sel:[0,0,1] op_sel_hi:[1,0,1]
  v_cvt_pk_bf16_f32 v212, v56, v57
  v_cvt_pk_bf16_f32 v213, v58, v59
  v_cvt_pk_bf16_f32 v214, v60, v61
  v_cvt_pk_bf16_f32 v215, v62, v63
  ds_write_b128 v14, v[212:215] offset:28672
  buffer_load_dwordx4 v[128:131], v3, s[12:15], s56 offen offset:2048 sc1
  v_lshlrev_b32 v56, 16, v216
  v_and_b32 v57, 0xffff0000, v216
  v_lshlrev_b32 v58, 16, v217
  v_and_b32 v59, 0xffff0000, v217
  v_lshlrev_b32 v60, 16, v218
  v_and_b32 v61, 0xffff0000, v218
  v_lshlrev_b32 v62, 16, v219
  v_and_b32 v63, 0xffff0000, v219
  v_pk_fma_f32 v[56:57], v[56:57], v[26:27], v[26:27] op_sel:[0,0,1] op_sel_hi:[1,0,1]
  v_pk_fma_f32 v[58:59], v[58:59], v[26:27], v[26:27] op_sel:[0,0,1] op_sel_hi:[1,0,1]
  v_pk_fma_f32 v[60:61], v[60:61], v[26:27], v[26:27] op_sel:[0,0,1] op_sel_hi:[1,0,1]
  v_pk_fma_f32 v[62:63], v[62:63], v[26:27], v[26:27] op_sel:[0,0,1] op_sel_hi:[1,0,1]
  v_cvt_pk_bf16_f32 v216, v56, v57
  v_cvt_pk_bf16_f32 v217, v58, v59
  v_cvt_pk_bf16_f32 v218, v60, v61
  v_cvt_pk_bf16_f32 v219, v62, v63
  ds_write_b128 v14, v[216:219] offset:32768
  buffer_load_dwordx4 v[132:135], v3, s[12:15], s56 offen offset:3072 sc1
  v_lshlrev_b32 v56, 16, v220
  v_and_b32 v57, 0xffff0000, v220
  v_lshlrev_b32 v58, 16, v221
  v_and_b32 v59, 0xffff0000, v221
  v_lshlrev_b32 v60, 16, v222
  v_and_b32 v61, 0xffff0000, v222
  v_lshlrev_b32 v62, 16, v223
  v_and_b32 v63, 0xffff0000, v223
  v_pk_fma_f32 v[56:57], v[56:57], v[26:27], v[26:27] op_sel:[0,0,1] op_sel_hi:[1,0,1]
  v_pk_fma_f32 v[58:59], v[58:59], v[26:27], v[26:27] op_sel:[0,0,1] op_sel_hi:[1,0,1]
  v_pk_fma_f32 v[60:61], v[60:61], v[26:27], v[26:27] op_sel:[0,0,1] op_sel_hi:[1,0,1]
  v_pk_fma_f32 v[62:63], v[62:63], v[26:27], v[26:27] op_sel:[0,0,1] op_sel_hi:[1,0,1]
  v_cvt_pk_bf16_f32 v220, v56, v57
  v_cvt_pk_bf16_f32 v221, v58, v59
  v_cvt_pk_bf16_f32 v222, v60, v61
  v_cvt_pk_bf16_f32 v223, v62, v63
  ds_write_b128 v18, v[220:223] offset:0
  s_add_u32 s56, s84, 12288
  buffer_load_dwordx4 v[136:139], v3, s[12:15], s56 offen offset:0 sc1
  v_lshlrev_b32 v56, 16, v224
  v_and_b32 v57, 0xffff0000, v224
  v_lshlrev_b32 v58, 16, v225
  v_and_b32 v59, 0xffff0000, v225
  v_lshlrev_b32 v60, 16, v226
  v_and_b32 v61, 0xffff0000, v226
  v_lshlrev_b32 v62, 16, v227
  v_and_b32 v63, 0xffff0000, v227
  v_pk_fma_f32 v[56:57], v[56:57], v[26:27], v[26:27] op_sel:[0,0,1] op_sel_hi:[1,0,1]
  v_pk_fma_f32 v[58:59], v[58:59], v[26:27], v[26:27] op_sel:[0,0,1] op_sel_hi:[1,0,1]
  v_pk_fma_f32 v[60:61], v[60:61], v[26:27], v[26:27] op_sel:[0,0,1] op_sel_hi:[1,0,1]
  v_pk_fma_f32 v[62:63], v[62:63], v[26:27], v[26:27] op_sel:[0,0,1] op_sel_hi:[1,0,1]
  v_cvt_pk_bf16_f32 v224, v56, v57
  v_cvt_pk_bf16_f32 v225, v58, v59
  v_cvt_pk_bf16_f32 v226, v60, v61
  v_cvt_pk_bf16_f32 v227, v62, v63
  ds_write_b128 v18, v[224:227] offset:4096
  buffer_load_dwordx4 v[140:143], v3, s[12:15], s56 offen offset:1024 sc1
  v_lshlrev_b32 v56, 16, v228
  v_and_b32 v57, 0xffff0000, v228
  v_lshlrev_b32 v58, 16, v229
  v_and_b32 v59, 0xffff0000, v229
  v_lshlrev_b32 v60, 16, v230
  v_and_b32 v61, 0xffff0000, v230
  v_lshlrev_b32 v62, 16, v231
  v_and_b32 v63, 0xffff0000, v231
  v_pk_fma_f32 v[56:57], v[56:57], v[26:27], v[26:27] op_sel:[0,0,1] op_sel_hi:[1,0,1]
  v_pk_fma_f32 v[58:59], v[58:59], v[26:27], v[26:27] op_sel:[0,0,1] op_sel_hi:[1,0,1]
  v_pk_fma_f32 v[60:61], v[60:61], v[26:27], v[26:27] op_sel:[0,0,1] op_sel_hi:[1,0,1]
  v_pk_fma_f32 v[62:63], v[62:63], v[26:27], v[26:27] op_sel:[0,0,1] op_sel_hi:[1,0,1]
  v_cvt_pk_bf16_f32 v228, v56, v57
  v_cvt_pk_bf16_f32 v229, v58, v59
  v_cvt_pk_bf16_f32 v230, v60, v61
  v_cvt_pk_bf16_f32 v231, v62, v63
  ds_write_b128 v18, v[228:231] offset:8192
  buffer_load_dwordx4 v[144:147], v3, s[12:15], s56 offen offset:2048 sc1
  v_lshlrev_b32 v56, 16, v232
  v_and_b32 v57, 0xffff0000, v232
  v_lshlrev_b32 v58, 16, v233
  v_and_b32 v59, 0xffff0000, v233
  v_lshlrev_b32 v60, 16, v234
  v_and_b32 v61, 0xffff0000, v234
  v_lshlrev_b32 v62, 16, v235
  v_and_b32 v63, 0xffff0000, v235
  v_pk_fma_f32 v[56:57], v[56:57], v[26:27], v[26:27] op_sel:[0,0,1] op_sel_hi:[1,0,1]
  v_pk_fma_f32 v[58:59], v[58:59], v[26:27], v[26:27] op_sel:[0,0,1] op_sel_hi:[1,0,1]
  v_pk_fma_f32 v[60:61], v[60:61], v[26:27], v[26:27] op_sel:[0,0,1] op_sel_hi:[1,0,1]
  v_pk_fma_f32 v[62:63], v[62:63], v[26:27], v[26:27] op_sel:[0,0,1] op_sel_hi:[1,0,1]
  v_cvt_pk_bf16_f32 v232, v56, v57
  v_cvt_pk_bf16_f32 v233, v58, v59
  v_cvt_pk_bf16_f32 v234, v60, v61
  v_cvt_pk_bf16_f32 v235, v62, v63
  ds_write_b128 v18, v[232:235] offset:12288
  buffer_load_dwordx4 v[148:151], v3, s[12:15], s56 offen offset:3072 sc1
  v_lshlrev_b32 v56, 16, v236
  v_and_b32 v57, 0xffff0000, v236
  v_lshlrev_b32 v58, 16, v237
  v_and_b32 v59, 0xffff0000, v237
  v_lshlrev_b32 v60, 16, v238
  v_and_b32 v61, 0xffff0000, v238
  v_lshlrev_b32 v62, 16, v239
  v_and_b32 v63, 0xffff0000, v239
  v_pk_fma_f32 v[56:57], v[56:57], v[26:27], v[26:27] op_sel:[0,0,1] op_sel_hi:[1,0,1]
  v_pk_fma_f32 v[58:59], v[58:59], v[26:27], v[26:27] op_sel:[0,0,1] op_sel_hi:[1,0,1]
  v_pk_fma_f32 v[60:61], v[60:61], v[26:27], v[26:27] op_sel:[0,0,1] op_sel_hi:[1,0,1]
  v_pk_fma_f32 v[62:63], v[62:63], v[26:27], v[26:27] op_sel:[0,0,1] op_sel_hi:[1,0,1]
  v_cvt_pk_bf16_f32 v236, v56, v57
  v_cvt_pk_bf16_f32 v237, v58, v59
  v_cvt_pk_bf16_f32 v238, v60, v61
  v_cvt_pk_bf16_f32 v239, v62, v63
  ds_write_b128 v18, v[236:239] offset:16384
  s_add_u32 s56, s84, 16384
  buffer_load_dwordx4 v[152:155], v3, s[12:15], s56 offen offset:0 sc1
  v_lshlrev_b32 v56, 16, v240
  v_and_b32 v57, 0xffff0000, v240
  v_lshlrev_b32 v58, 16, v241
  v_and_b32 v59, 0xffff0000, v241
  v_lshlrev_b32 v60, 16, v242
  v_and_b32 v61, 0xffff0000, v242
  v_lshlrev_b32 v62, 16, v243
  v_and_b32 v63, 0xffff0000, v243
  v_pk_fma_f32 v[56:57], v[56:57], v[26:27], v[26:27] op_sel:[0,0,1] op_sel_hi:[1,0,1]
  v_pk_fma_f32 v[58:59], v[58:59], v[26:27], v[26:27] op_sel:[0,0,1] op_sel_hi:[1,0,1]
  v_pk_fma_f32 v[60:61], v[60:61], v[26:27], v[26:27] op_sel:[0,0,1] op_sel_hi:[1,0,1]
  v_pk_fma_f32 v[62:63], v[62:63], v[26:27], v[26:27] op_sel:[0,0,1] op_sel_hi:[1,0,1]
  v_cvt_pk_bf16_f32 v240, v56, v57
  v_cvt_pk_bf16_f32 v241, v58, v59
  v_cvt_pk_bf16_f32 v242, v60, v61
  v_cvt_pk_bf16_f32 v243, v62, v63
  ds_write_b128 v18, v[240:243] offset:20480
  buffer_load_dwordx4 v[156:159], v3, s[12:15], s56 offen offset:1024 sc1
  v_lshlrev_b32 v56, 16, v244
  v_and_b32 v57, 0xffff0000, v244
  v_lshlrev_b32 v58, 16, v245
  v_and_b32 v59, 0xffff0000, v245
  v_lshlrev_b32 v60, 16, v246
  v_and_b32 v61, 0xffff0000, v246
  v_lshlrev_b32 v62, 16, v247
  v_and_b32 v63, 0xffff0000, v247
  v_pk_fma_f32 v[56:57], v[56:57], v[26:27], v[26:27] op_sel:[0,0,1] op_sel_hi:[1,0,1]
  v_pk_fma_f32 v[58:59], v[58:59], v[26:27], v[26:27] op_sel:[0,0,1] op_sel_hi:[1,0,1]
  v_pk_fma_f32 v[60:61], v[60:61], v[26:27], v[26:27] op_sel:[0,0,1] op_sel_hi:[1,0,1]
  v_pk_fma_f32 v[62:63], v[62:63], v[26:27], v[26:27] op_sel:[0,0,1] op_sel_hi:[1,0,1]
  v_cvt_pk_bf16_f32 v244, v56, v57
  v_cvt_pk_bf16_f32 v245, v58, v59
  v_cvt_pk_bf16_f32 v246, v60, v61
  v_cvt_pk_bf16_f32 v247, v62, v63
  ds_write_b128 v18, v[244:247] offset:24576
  s_add_u32 s56, s84, 73728
  buffer_load_dwordx4 v[160:163], v3, s[12:15], s56 offen offset:0 sc1
  v_lshlrev_b32 v56, 16, v248
  v_and_b32 v57, 0xffff0000, v248
  v_lshlrev_b32 v58, 16, v249
  v_and_b32 v59, 0xffff0000, v249
  v_lshlrev_b32 v60, 16, v250
  v_and_b32 v61, 0xffff0000, v250
  v_lshlrev_b32 v62, 16, v251
  v_and_b32 v63, 0xffff0000, v251
  v_pk_fma_f32 v[56:57], v[56:57], v[26:27], v[26:27] op_sel:[0,0,1] op_sel_hi:[1,0,1]
  v_pk_fma_f32 v[58:59], v[58:59], v[26:27], v[26:27] op_sel:[0,0,1] op_sel_hi:[1,0,1]
  v_pk_fma_f32 v[60:61], v[60:61], v[26:27], v[26:27] op_sel:[0,0,1] op_sel_hi:[1,0,1]
  v_pk_fma_f32 v[62:63], v[62:63], v[26:27], v[26:27] op_sel:[0,0,1] op_sel_hi:[1,0,1]
  v_cvt_pk_bf16_f32 v248, v56, v57
  v_cvt_pk_bf16_f32 v249, v58, v59
  v_cvt_pk_bf16_f32 v250, v60, v61
  v_cvt_pk_bf16_f32 v251, v62, v63
  ds_write_b128 v18, v[248:251] offset:28672
  buffer_load_dwordx4 v[164:167], v3, s[12:15], s56 offen offset:1024 sc1
  v_lshlrev_b32 v56, 16, v252
  v_and_b32 v57, 0xffff0000, v252
  v_lshlrev_b32 v58, 16, v253
  v_and_b32 v59, 0xffff0000, v253
  v_lshlrev_b32 v60, 16, v254
  v_and_b32 v61, 0xffff0000, v254
  v_lshlrev_b32 v62, 16, v255
  v_and_b32 v63, 0xffff0000, v255
  v_pk_fma_f32 v[56:57], v[56:57], v[26:27], v[26:27] op_sel:[0,0,1] op_sel_hi:[1,0,1]
  v_pk_fma_f32 v[58:59], v[58:59], v[26:27], v[26:27] op_sel:[0,0,1] op_sel_hi:[1,0,1]
  v_pk_fma_f32 v[60:61], v[60:61], v[26:27], v[26:27] op_sel:[0,0,1] op_sel_hi:[1,0,1]
  v_pk_fma_f32 v[62:63], v[62:63], v[26:27], v[26:27] op_sel:[0,0,1] op_sel_hi:[1,0,1]
  v_cvt_pk_bf16_f32 v252, v56, v57
  v_cvt_pk_bf16_f32 v253, v58, v59
  v_cvt_pk_bf16_f32 v254, v60, v61
  v_cvt_pk_bf16_f32 v255, v62, v63
  ds_write_b128 v18, v[252:255] offset:32768
  buffer_load_dwordx4 v[168:171], v3, s[12:15], s56 offen offset:2048 sc1
  s_waitcnt lgkmcnt(0)
  s_barrier
  ds_read_b128 a[0:3], v15 offset:0
  ds_read_b128 a[4:7], v16 offset:0
  ds_read_b128 a[8:11], v17 offset:0
  ds_read_b128 a[12:15], v15 offset:4096
  ds_read_b128 a[16:19], v16 offset:4096
  ds_read_b128 a[20:23], v17 offset:4096
  s_waitcnt vmcnt(26) lgkmcnt(3)
  v_mfma_f32_16x16x32_bf16 v[40:43], v[88:91], v[184:187], 0
  ds_read_b128 a[24:27], v15 offset:8192
  buffer_load_dwordx4 v[172:175], v3, s[12:15], s56 offen offset:3072 sc1
  v_mfma_f32_16x16x32_bf16 v[44:47], v[88:91], a[0:3], 0
  ds_read_b128 a[28:31], v16 offset:8192
  v_mfma_f32_16x16x32_bf16 v[48:51], v[88:91], a[4:7], 0
  ds_read_b128 a[32:35], v17 offset:8192
  s_add_u32 s56, s84, 77824
  buffer_load_dwordx4 v[176:179], v3, s[12:15], s56 offen offset:0 sc1
PAD_6:
  s_cbranch_execz WRET_1
  v_mfma_f32_16x16x32_bf16 v[52:55], v[88:91], a[8:11], 0
  v_add_u32 v85, 4096, v3
  s_waitcnt vmcnt(27) lgkmcnt(3)
  v_mfma_f32_16x16x32_bf16 v[40:43], v[92:95], v[188:191], v[40:43]
  ds_read_b128 a[36:39], v15 offset:12288
  buffer_load_dwordx4 v[180:183], v3, s[12:15], s56 offen offset:1024 sc1
  v_add_u32 v86, 8192, v3
  v_mfma_f32_16x16x32_bf16 v[44:47], v[92:95], a[12:15], v[44:47]
  ds_read_b128 a[40:43], v16 offset:12288
  v_add_u32 v87, 12288, v3
  v_mfma_f32_16x16x32_bf16 v[48:51], v[92:95], a[16:19], v[48:51]
  ds_read_b128 a[44:47], v17 offset:12288
  v_add_u32 v9, 16384, v3
  v_mfma_f32_16x16x32_bf16 v[52:55], v[92:95], a[20:23], v[52:55]
  v_mov_b32 v84, 2147483648
  s_waitcnt vmcnt(26) lgkmcnt(3)
  v_mfma_f32_16x16x32_bf16 v[40:43], v[96:99], v[192:195], v[40:43]
  ds_read_b128 a[48:51], v15 offset:16384
  buffer_load_dwordx4 v[88:91], v3, s[12:15], s56 offen offset:2048 sc1
  v_cmp_gt_u32 s[0:1], 16, v0
  v_mfma_f32_16x16x32_bf16 v[44:47], v[96:99], a[24:27], v[44:47]
  ds_read_b128 a[52:55], v16 offset:16384
  v_add_u32 v7, s93, v3
  v_mfma_f32_16x16x32_bf16 v[48:51], v[96:99], a[28:31], v[48:51]
  ds_read_b128 a[56:59], v17 offset:16384
  v_cndmask_b32 v84, v84, v3, s[0:1]
  v_mfma_f32_16x16x32_bf16 v[52:55], v[96:99], a[32:35], v[52:55]
  s_waitcnt vmcnt(26) lgkmcnt(3)
  v_mfma_f32_16x16x32_bf16 v[40:43], v[100:103], v[196:199], v[40:43]
  ds_read_b128 a[60:63], v15 offset:20480
  buffer_load_dwordx4 v[92:95], v3, s[12:15], s56 offen offset:3072 sc1
  v_mfma_f32_16x16x32_bf16 v[44:47], v[100:103], a[36:39], v[44:47]
  ds_read_b128 a[64:67], v16 offset:20480
  v_mfma_f32_16x16x32_bf16 v[48:51], v[100:103], a[40:43], v[48:51]
  ds_read_b128 a[68:71], v17 offset:20480
  ds_read_b128 a[216:219], v18 offset:55296
  v_mfma_f32_16x16x32_bf16 v[52:55], v[100:103], a[44:47], v[52:55]
  s_waitcnt vmcnt(25) lgkmcnt(4)
  v_mfma_f32_16x16x32_bf16 v[40:43], v[104:107], v[200:203], v[40:43]
  ds_read_b128 a[72:75], v15 offset:24576
  s_add_u32 s56, s84, 81920
  buffer_load_dwordx4 v[96:99], v3, s[12:15], s56 offen offset:0 sc1
  v_mfma_f32_16x16x32_bf16 v[44:47], v[104:107], a[48:51], v[44:47]
  ds_read_b128 a[76:79], v16 offset:24576
  v_mfma_f32_16x16x32_bf16 v[48:51], v[104:107], a[52:55], v[48:51]
  ds_read_b128 a[80:83], v17 offset:24576
  ds_read_b128 a[220:223], v19 offset:55296
  v_mfma_f32_16x16x32_bf16 v[52:55], v[104:107], a[56:59], v[52:55]
  s_waitcnt vmcnt(25) lgkmcnt(5)
  v_mfma_f32_16x16x32_bf16 v[40:43], v[108:111], v[204:207], v[40:43]
  ds_read_b128 a[84:87], v15 offset:28672
  buffer_load_dwordx4 v[100:103], v3, s[12:15], s56 offen offset:1024 sc1
  v_mfma_f32_16x16x32_bf16 v[44:47], v[108:111], a[60:63], v[44:47]
  ds_read_b128 a[88:91], v16 offset:28672
  v_mfma_f32_16x16x32_bf16 v[48:51], v[108:111], a[64:67], v[48:51]
  ds_read_b128 a[92:95], v17 offset:28672
  ds_read_b128 a[224:227], v20 offset:55296
  v_mfma_f32_16x16x32_bf16 v[52:55], v[108:111], a[68:71], v[52:55]
  s_waitcnt vmcnt(23) lgkmcnt(5)
  v_mfma_f32_16x16x32_bf16 v[40:43], v[112:115], v[208:211], v[40:43]
  ds_read_b128 a[96:99], v15 offset:32768
  buffer_load_dwordx4 v[104:107], v3, s[12:15], s56 offen offset:2048 sc1
  v_mfma_f32_16x16x32_bf16 v[44:47], v[112:115], a[72:75], v[44:47]
  ds_read_b128 a[100:103], v16 offset:32768
  v_mfma_f32_16x16x32_bf16 v[48:51], v[112:115], a[76:79], v[48:51]
  ds_read_b128 a[104:107], v17 offset:32768
  ds_read_b128 a[228:231], v21 offset:55296
  v_mfma_f32_16x16x32_bf16 v[52:55], v[112:115], a[80:83], v[52:55]
  s_waitcnt vmcnt(23) lgkmcnt(5)
  v_mfma_f32_16x16x32_bf16 v[40:43], v[116:119], v[212:215], v[40:43]
  ds_read_b128 a[108:111], v19 offset:0
  buffer_load_dwordx4 v[108:111], v3, s[12:15], s56 offen offset:3072 sc1
  v_mfma_f32_16x16x32_bf16 v[44:47], v[116:119], a[84:87], v[44:47]
  ds_read_b128 a[112:115], v20 offset:0
  v_mfma_f32_16x16x32_bf16 v[48:51], v[116:119], a[88:91], v[48:51]
  ds_read_b128 a[116:119], v21 offset:0
  ds_read_b128 a[232:235], v18 offset:59392
  v_mfma_f32_16x16x32_bf16 v[52:55], v[116:119], a[92:95], v[52:55]
  s_waitcnt vmcnt(22) lgkmcnt(5)
  v_mfma_f32_16x16x32_bf16 v[40:43], v[120:123], v[216:219], v[40:43]
  ds_read_b128 a[120:123], v19 offset:4096
  s_add_u32 s56, s84, 86016
  buffer_load_dwordx4 v[112:115], v3, s[12:15], s56 offen offset:0 sc1
  v_mfma_f32_16x16x32_bf16 v[44:47], v[120:123], a[96:99], v[44:47]
  ds_read_b128 a[124:127], v20 offset:4096
  v_mfma_f32_16x16x32_bf16 v[48:51], v[120:123], a[100:103], v[48:51]
  ds_read_b128 a[128:131], v21 offset:4096
  ds_read_b128 a[236:239], v19 offset:59392
  v_mfma_f32_16x16x32_bf16 v[52:55], v[120:123], a[104:107], v[52:55]
  s_waitcnt vmcnt(22) lgkmcnt(5)
  v_mfma_f32_16x16x32_bf16 v[40:43], v[124:127], v[220:223], v[40:43]
  ds_read_b128 a[132:135], v19 offset:8192
  buffer_load_dwordx4 v[116:119], v3, s[12:15], s56 offen offset:1024 sc1
  v_mfma_f32_16x16x32_bf16 v[44:47], v[124:127], a[108:111], v[44:47]
  ds_read_b128 a[136:139], v20 offset:8192
  v_mfma_f32_16x16x32_bf16 v[48:51], v[124:127], a[112:115], v[48:51]
  ds_read_b128 a[140:143], v21 offset:8192
  ds_read_b128 a[240:243], v20 offset:59392
  v_mfma_f32_16x16x32_bf16 v[52:55], v[124:127], a[116:119], v[52:55]
  s_waitcnt vmcnt(21) lgkmcnt(5)
  v_mfma_f32_16x16x32_bf16 v[40:43], v[128:131], v[224:227], v[40:43]
  ds_read_b128 a[144:147], v19 offset:12288
  buffer_load_dwordx4 v[120:123], v3, s[12:15], s56 offen offset:2048 sc1
  v_mfma_f32_16x16x32_bf16 v[44:47], v[128:131], a[120:123], v[44:47]
  ds_read_b128 a[148:151], v20 offset:12288
  v_mfma_f32_16x16x32_bf16 v[48:51], v[128:131], a[124:127], v[48:51]
  ds_read_b128 a[152:155], v21 offset:12288
  ds_read_b128 a[244:247], v21 offset:59392
  v_mfma_f32_16x16x32_bf16 v[52:55], v[128:131], a[128:131], v[52:55]
  s_waitcnt vmcnt(21) lgkmcnt(5)
  v_mfma_f32_16x16x32_bf16 v[40:43], v[132:135], v[228:231], v[40:43]
  ds_read_b128 a[156:159], v19 offset:16384
  buffer_load_dwordx4 v[124:127], v3, s[12:15], s56 offen offset:3072 sc1
  v_mfma_f32_16x16x32_bf16 v[44:47], v[132:135], a[132:135], v[44:47]
  ds_read_b128 a[160:163], v20 offset:16384
  v_mfma_f32_16x16x32_bf16 v[48:51], v[132:135], a[136:139], v[48:51]
  ds_read_b128 a[164:167], v21 offset:16384
  ds_read_b128 a[248:251], v18 offset:63488
  v_mfma_f32_16x16x32_bf16 v[52:55], v[132:135], a[140:143], v[52:55]
  s_waitcnt vmcnt(21) lgkmcnt(5)
  v_mfma_f32_16x16x32_bf16 v[40:43], v[136:139], v[232:235], v[40:43]
  ds_read_b128 a[168:171], v19 offset:20480
  s_add_u32 s56, s84, 90112
  buffer_load_dwordx4 v[128:131], v3, s[12:15], s56 offen offset:0 sc1
  v_mfma_f32_16x16x32_bf16 v[44:47], v[136:139], a[144:147], v[44:47]
  ds_read_b128 a[172:175], v20 offset:20480
  v_mfma_f32_16x16x32_bf16 v[48:51], v[136:139], a[148:151], v[48:51]
  ds_read_b128 a[176:179], v21 offset:20480
  ds_read_b128 a[252:255], v19 offset:63488
  v_mfma_f32_16x16x32_bf16 v[52:55], v[136:139], a[152:155], v[52:55]
  s_waitcnt vmcnt(21) lgkmcnt(5)
  v_mfma_f32_16x16x32_bf16 v[40:43], v[140:143], v[236:239], v[40:43]
  ds_read_b128 a[180:183], v19 offset:24576
  buffer_load_dwordx4 v[132:135], v3, s[12:15], s56 offen offset:1024 sc1
  v_mfma_f32_16x16x32_bf16 v[44:47], v[140:143], a[156:159], v[44:47]
  ds_read_b128 a[184:187], v20 offset:24576
  v_mfma_f32_16x16x32_bf16 v[48:51], v[140:143], a[160:163], v[48:51]
  ds_read_b128 a[188:191], v21 offset:24576
  ds_read_b128 v[76:79], v20 offset:63488
  v_mfma_f32_16x16x32_bf16 v[52:55], v[140:143], a[164:167], v[52:55]
  s_waitcnt vmcnt(21) lgkmcnt(5)
  v_mfma_f32_16x16x32_bf16 v[40:43], v[144:147], v[240:243], v[40:43]
  ds_read_b128 a[192:195], v19 offset:28672
  s_add_u32 s56, s84, 147456
  buffer_load_dwordx4 v[136:139], v3, s[12:15], s56 offen offset:0 sc1
  v_mfma_f32_16x16x32_bf16 v[44:47], v[144:147], a[168:171], v[44:47]
  ds_read_b128 a[196:199], v20 offset:28672
  v_mfma_f32_16x16x32_bf16 v[48:51], v[144:147], a[172:175], v[48:51]
  ds_read_b128 a[200:203], v21 offset:28672
  ds_read_b128 v[80:83], v21 offset:63488
  v_mfma_f32_16x16x32_bf16 v[52:55], v[144:147], a[176:179], v[52:55]
  s_waitcnt vmcnt(21) lgkmcnt(5)
  v_mfma_f32_16x16x32_bf16 v[40:43], v[148:151], v[244:247], v[40:43]
  ds_read_b128 a[204:207], v19 offset:32768
  buffer_load_dwordx4 v[140:143], v3, s[12:15], s56 offen offset:1024 sc1
  v_mfma_f32_16x16x32_bf16 v[44:47], v[148:151], a[180:183], v[44:47]
  ds_read_b128 a[208:211], v20 offset:32768
  v_mfma_f32_16x16x32_bf16 v[48:51], v[148:151], a[184:187], v[48:51]
  ds_read_b128 a[212:215], v21 offset:32768
  v_mfma_f32_16x16x32_bf16 v[52:55], v[148:151], a[188:191], v[52:55]
  s_waitcnt vmcnt(21) lgkmcnt(4)
  v_mfma_f32_16x16x32_bf16 v[40:43], v[152:155], v[248:251], v[40:43]
  buffer_load_dwordx4 v[144:147], v3, s[12:15], s56 offen offset:2048 sc1
  v_mfma_f32_16x16x32_bf16 v[44:47], v[152:155], a[192:195], v[44:47]
  v_mfma_f32_16x16x32_bf16 v[48:51], v[152:155], a[196:199], v[48:51]
  v_mfma_f32_16x16x32_bf16 v[52:55], v[152:155], a[200:203], v[52:55]
  s_waitcnt vmcnt(21) lgkmcnt(0)
  v_mfma_f32_16x16x32_bf16 v[40:43], v[156:159], v[252:255], v[40:43]
  buffer_load_dwordx4 v[148:151], v3, s[12:15], s56 offen offset:3072 sc1
  v_mfma_f32_16x16x32_bf16 v[44:47], v[156:159], a[204:207], v[44:47]
  v_mfma_f32_16x16x32_bf16 v[48:51], v[156:159], a[208:211], v[48:51]
  v_mfma_f32_16x16x32_bf16 v[52:55], v[156:159], a[212:215], v[52:55]
  s_waitcnt vmcnt(16)
  v_mfma_f32_16x16x32_bf16 v[56:59], v[160:163], v[184:187], 0
  buffer_load_dwordx4 v[152:155], v85, s[12:15], s56 offen offset:0 sc1
  v_mfma_f32_16x16x32_bf16 v[56:59], v[164:167], v[188:191], v[56:59]
  v_mfma_f32_16x16x32_bf16 v[56:59], v[168:171], v[192:195], v[56:59]
  v_fmaak_f32 v26, v40, v40, 0x409d30fc
  v_mfma_f32_16x16x32_bf16 v[56:59], v[172:175], v[196:199], v[56:59]
  v_mfma_f32_16x16x32_bf16 v[56:59], v[176:179], v[200:203], v[56:59]
  buffer_load_dwordx4 v[156:159], v85, s[12:15], s56 offen offset:1024 sc1
  v_mul_f32 v26, v26, v40
  v_mfma_f32_16x16x32_bf16 v[56:59], v[180:183], v[204:207], v[56:59]
  v_exp_f32 v26, v26
  v_mfma_f32_16x16x32_bf16 v[60:63], v[160:163], a[0:3], 0
  s_barrier
  s_cmp_lg_u32 s24, 0
  s_cbranch_scc1 L_fs21
  s_mul_i32 s57, s99, 4
  s_add_u32 s57, s57, 1024
  s_mov_b64 exec, 1
  buffer_store_dword v5, v6, s[12:15], s57 offen sc1
  s_mov_b64 exec, -1
L_fs21:
  v_fmaak_f32 v27, v41, v41, 0x409d30fc
  v_add_f32 v26, 1.0, v26
  v_mfma_f32_16x16x32_bf16 v[60:63], v[164:167], a[12:15], v[60:63]
  v_rcp_f32 v26, v26
  v_mfma_f32_16x16x32_bf16 v[60:63], v[168:171], a[24:27], v[60:63]
  v_mul_f32 v27, v27, v41
  v_mul_f32 v26, v26, v40
  v_mfma_f32_16x16x32_bf16 v[60:63], v[172:175], a[36:39], v[60:63]
  v_exp_f32 v27, v27
  v_mfma_f32_16x16x32_bf16 v[60:63], v[176:179], a[48:51], v[60:63]
  v_fmaak_f32 v28, v42, v42, 0x409d30fc
  v_add_f32 v27, 1.0, v27
  v_mfma_f32_16x16x32_bf16 v[60:63], v[180:183], a[60:63], v[60:63]
  v_rcp_f32 v27, v27
  v_mfma_f32_16x16x32_bf16 v[64:67], v[160:163], a[4:7], 0
  v_mul_f32 v28, v28, v42
  v_mul_f32 v27, v27, v41
  v_mfma_f32_16x16x32_bf16 v[64:67], v[164:167], a[16:19], v[64:67]
  v_exp_f32 v28, v28
  v_mfma_f32_16x16x32_bf16 v[64:67], v[168:171], a[28:31], v[64:67]
  v_fmaak_f32 v29, v43, v43, 0x409d30fc
  v_add_f32 v28, 1.0, v28
  v_mfma_f32_16x16x32_bf16 v[64:67], v[172:175], a[40:43], v[64:67]
  v_rcp_f32 v28, v28
  v_mfma_f32_16x16x32_bf16 v[64:67], v[176:179], a[52:55], v[64:67]
  v_mul_f32 v29, v29, v43
  v_mul_f32 v28, v28, v42
  v_mfma_f32_16x16x32_bf16 v[64:67], v[180:183], a[64:67], v[64:67]
  v_exp_f32 v29, v29
  v_mfma_f32_16x16x32_bf16 v[68:71], v[160:163], a[8:11], 0
  v_fmaak_f32 v30, v44, v44, 0x409d30fc
  v_add_f32 v29, 1.0, v29
  v_mfma_f32_16x16x32_bf16 v[68:71], v[164:167], a[20:23], v[68:71]
  v_rcp_f32 v29, v29
  v_mfma_f32_16x16x32_bf16 v[68:71], v[168:171], a[32:35], v[68:71]
  v_mul_f32 v30, v30, v44
  v_mul_f32 v29, v29, v43
  v_mfma_f32_16x16x32_bf16 v[68:71], v[172:175], a[44:47], v[68:71]
  v_exp_f32 v30, v30
  v_mfma_f32_16x16x32_bf16 v[68:71], v[176:179], a[56:59], v[68:71]
  v_cvt_pk_bf16_f32 v32, v26, v27
  v_cvt_pk_bf16_f32 v33, v28, v29
  v_mfma_f32_16x16x32_bf16 v[68:71], v[180:183], a[68:71], v[68:71]
  ds_write_b64 v22, v[32:33] offset:0
  s_waitcnt vmcnt(12)
  v_mfma_f32_16x16x32_bf16 v[56:59], v[88:91], v[208:211], v[56:59]
  buffer_load_dwordx4 v[160:163], v85, s[12:15], s56 offen offset:2048 sc1
  v_fmaak_f32 v31, v45, v45, 0x409d30fc
  v_add_f32 v30, 1.0, v30
  v_mfma_f32_16x16x32_bf16 v[56:59], v[92:95], v[212:215], v[56:59]
  v_rcp_f32 v30, v30
  v_mfma_f32_16x16x32_bf16 v[56:59], v[96:99], v[216:219], v[56:59]
  v_mul_f32 v31, v31, v45
  v_mul_f32 v30, v30, v44
  v_mfma_f32_16x16x32_bf16 v[56:59], v[100:103], v[220:223], v[56:59]
  v_exp_f32 v31, v31
  v_mfma_f32_16x16x32_bf16 v[56:59], v[104:107], v[224:227], v[56:59]
  buffer_load_dwordx4 v[164:167], v85, s[12:15], s56 offen offset:3072 sc1
  v_fmaak_f32 v26, v46, v46, 0x409d30fc
  v_add_f32 v31, 1.0, v31
  v_mfma_f32_16x16x32_bf16 v[56:59], v[108:111], v[228:231], v[56:59]
  v_rcp_f32 v31, v31
  v_mfma_f32_16x16x32_bf16 v[60:63], v[88:91], a[72:75], v[60:63]
  v_mul_f32 v26, v26, v46
  v_mul_f32 v31, v31, v45
  v_mfma_f32_16x16x32_bf16 v[60:63], v[92:95], a[84:87], v[60:63]
  v_exp_f32 v26, v26
  v_mfma_f32_16x16x32_bf16 v[60:63], v[96:99], a[96:99], v[60:63]
  buffer_load_dwordx4 v[168:171], v86, s[12:15], s56 offen offset:0 sc1
  v_fmaak_f32 v27, v47, v47, 0x409d30fc
  v_add_f32 v26, 1.0, v26
  v_mfma_f32_16x16x32_bf16 v[60:63], v[100:103], a[108:111], v[60:63]
  v_rcp_f32 v26, v26
  v_mfma_f32_16x16x32_bf16 v[60:63], v[104:107], a[120:123], v[60:63]
  v_mul_f32 v27, v27, v47
  v_mul_f32 v26, v26, v46
  v_mfma_f32_16x16x32_bf16 v[60:63], v[108:111], a[132:135], v[60:63]
  v_exp_f32 v27, v27
  v_mfma_f32_16x16x32_bf16 v[64:67], v[88:91], a[76:79], v[64:67]
  buffer_load_dwordx4 v[172:175], v86, s[12:15], s56 offen offset:1024 sc1
  v_fmaak_f32 v28, v48, v48, 0x409d30fc
  v_add_f32 v27, 1.0, v27
  v_mfma_f32_16x16x32_bf16 v[64:67], v[92:95], a[88:91], v[64:67]
  v_rcp_f32 v27, v27
  v_mfma_f32_16x16x32_bf16 v[64:67], v[96:99], a[100:103], v[64:67]
  v_mul_f32 v28, v28, v48
  v_mul_f32 v27, v27, v47
  v_mfma_f32_16x16x32_bf16 v[64:67], v[100:103], a[112:115], v[64:67]
  v_exp_f32 v28, v28
  v_mfma_f32_16x16x32_bf16 v[64:67], v[104:107], a[124:127], v[64:67]
  buffer_load_dwordx4 v[176:179], v86, s[12:15], s56 offen offset:2048 sc1
  v_cvt_pk_bf16_f32 v34, v30, v31
  v_cvt_pk_bf16_f32 v35, v26, v27
  v_mfma_f32_16x16x32_bf16 v[64:67], v[108:111], a[136:139], v[64:67]
  ds_write_b64 v23, v[34:35] offset:0
  v_mfma_f32_16x16x32_bf16 v[68:71], v[88:91], a[80:83], v[68:71]
  v_fmaak_f32 v29, v49, v49, 0x409d30fc
  v_add_f32 v28, 1.0, v28
  v_mfma_f32_16x16x32_bf16 v[68:71], v[92:95], a[92:95], v[68:71]
  v_rcp_f32 v28, v28
  v_mfma_f32_16x16x32_bf16 v[68:71], v[96:99], a[104:107], v[68:71]
  buffer_load_dwordx4 v[180:183], v86, s[12:15], s56 offen offset:3072 sc1
  v_mul_f32 v29, v29, v49
  v_mul_f32 v28, v28, v48
  v_mfma_f32_16x16x32_bf16 v[68:71], v[100:103], a[116:119], v[68:71]
  v_exp_f32 v29, v29
  v_mfma_f32_16x16x32_bf16 v[68:71], v[104:107], a[128:131], v[68:71]
  v_fmaak_f32 v30, v50, v50, 0x409d30fc
  v_add_f32 v29, 1.0, v29
  v_mfma_f32_16x16x32_bf16 v[68:71], v[108:111], a[140:143], v[68:71]
  v_rcp_f32 v29, v29
  s_waitcnt vmcnt(12)
  v_mfma_f32_16x16x32_bf16 v[56:59], v[112:115], v[232:235], v[56:59]
  buffer_load_dwordx4 v[88:91], v87, s[12:15], s56 offen offset:0 sc1
  v_mul_f32 v30, v30, v50
  v_mul_f32 v29, v29, v49
  v_mfma_f32_16x16x32_bf16 v[56:59], v[116:119], v[236:239], v[56:59]
  v_exp_f32 v30, v30
  v_mfma_f32_16x16x32_bf16 v[56:59], v[120:123], v[240:243], v[56:59]
  v_fmaak_f32 v31, v51, v51, 0x409d30fc
  v_add_f32 v30, 1.0, v30
  v_mfma_f32_16x16x32_bf16 v[56:59], v[124:127], v[244:247], v[56:59]
  v_rcp_f32 v30, v30
  v_mfma_f32_16x16x32_bf16 v[56:59], v[128:131], v[248:251], v[56:59]
  buffer_load_dwordx4 v[92:95], v87, s[12:15], s56 offen offset:1024 sc1
  v_mul_f32 v31, v31, v51
  v_mul_f32 v30, v30, v50
  v_mfma_f32_16x16x32_bf16 v[56:59], v[132:135], v[252:255], v[56:59]
  v_exp_f32 v31, v31
  v_mfma_f32_16x16x32_bf16 v[60:63], v[112:115], a[144:147], v[60:63]
  v_fmaak_f32 v26, v52, v52, 0x409d30fc
  v_add_f32 v31, 1.0, v31
  v_mfma_f32_16x16x32_bf16 v[60:63], v[116:119], a[156:159], v[60:63]
  v_rcp_f32 v31, v31
  v_mfma_f32_16x16x32_bf16 v[60:63], v[120:123], a[168:171], v[60:63]
  buffer_load_dwordx4 v[96:99], v87, s[12:15], s56 offen offset:2048 sc1
  v_mul_f32 v26, v26, v52
  v_mul_f32 v31, v31, v51
  v_mfma_f32_16x16x32_bf16 v[60:63], v[124:127], a[180:183], v[60:63]
  v_exp_f32 v26, v26
  v_mfma_f32_16x16x32_bf16 v[60:63], v[128:131], a[192:195], v[60:63]
  v_cvt_pk_bf16_f32 v36, v28, v29
  v_cvt_pk_bf16_f32 v37, v30, v31
  v_mfma_f32_16x16x32_bf16 v[60:63], v[132:135], a[204:207], v[60:63]
  ds_write_b64 v24, v[36:37] offset:0
  v_mfma_f32_16x16x32_bf16 v[64:67], v[112:115], a[148:151], v[64:67]
  buffer_load_dwordx4 v[100:103], v87, s[12:15], s56 offen offset:3072 sc1
  v_fmaak_f32 v27, v53, v53, 0x409d30fc
  v_add_f32 v26, 1.0, v26
  v_mfma_f32_16x16x32_bf16 v[64:67], v[116:119], a[160:163], v[64:67]
  v_rcp_f32 v26, v26
  v_mfma_f32_16x16x32_bf16 v[64:67], v[120:123], a[172:175], v[64:67]
  v_mul_f32 v27, v27, v53
  v_mul_f32 v26, v26, v52
  v_mfma_f32_16x16x32_bf16 v[64:67], v[124:127], a[184:187], v[64:67]
  v_exp_f32 v27, v27
  v_mfma_f32_16x16x32_bf16 v[64:67], v[128:131], a[196:199], v[64:67]
  buffer_load_dwordx4 v[104:107], v9, s[12:15], s56 offen offset:0 sc1
  v_fmaak_f32 v28, v54, v54, 0x409d30fc
  v_add_f32 v27, 1.0, v27
  v_mfma_f32_16x16x32_bf16 v[64:67], v[132:135], a[208:211], v[64:67]
  v_rcp_f32 v27, v27
  v_mfma_f32_16x16x32_bf16 v[68:71], v[112:115], a[152:155], v[68:71]
  v_mul_f32 v28, v28, v54
  v_mul_f32 v27, v27, v53
  v_mfma_f32_16x16x32_bf16 v[68:71], v[116:119], a[164:167], v[68:71]
  v_exp_f32 v28, v28
  v_mfma_f32_16x16x32_bf16 v[68:71], v[120:123], a[176:179], v[68:71]
  buffer_load_dwordx4 v[108:111], v9, s[12:15], s56 offen offset:1024 sc1
  v_fmaak_f32 v29, v55, v55, 0x409d30fc
  v_add_f32 v28, 1.0, v28
  v_mfma_f32_16x16x32_bf16 v[68:71], v[124:127], a[188:191], v[68:71]
  v_rcp_f32 v28, v28
  v_mfma_f32_16x16x32_bf16 v[68:71], v[128:131], a[200:203], v[68:71]
  v_mul_f32 v29, v29, v55
  v_mul_f32 v28, v28, v54
  v_mfma_f32_16x16x32_bf16 v[68:71], v[132:135], a[212:215], v[68:71]
  v_exp_f32 v29, v29
  s_waitcnt vmcnt(12)
  v_mfma_f32_16x16x32_bf16 v[40:43], v[136:139], v[184:187], 0
  s_add_u32 s56, s84, 221184
  buffer_load_dwordx4 v[112:115], v3, s[12:15], s56 offen offset:0 sc1
  v_fmaak_f32 v30, v56, v56, 0x409d30fc
  v_add_f32 v29, 1.0, v29
  v_mfma_f32_16x16x32_bf16 v[40:43], v[140:143], v[188:191], v[40:43]
  v_rcp_f32 v29, v29
  v_mfma_f32_16x16x32_bf16 v[40:43], v[144:147], v[192:195], v[40:43]
  v_mul_f32 v30, v30, v56
  v_mul_f32 v29, v29, v55
  v_mfma_f32_16x16x32_bf16 v[40:43], v[148:151], v[196:199], v[40:43]
  v_exp_f32 v30, v30
  v_mfma_f32_16x16x32_bf16 v[40:43], v[152:155], v[200:203], v[40:43]
  buffer_load_dwordx4 v[116:119], v3, s[12:15], s56 offen offset:1024 sc1
  v_cvt_pk_bf16_f32 v38, v26, v27
  v_cvt_pk_bf16_f32 v39, v28, v29
  v_mfma_f32_16x16x32_bf16 v[40:43], v[156:159], v[204:207], v[40:43]
  ds_write_b64 v25, v[38:39] offset:0
  v_mfma_f32_16x16x32_bf16 v[44:47], v[136:139], a[0:3], 0
  v_fmaak_f32 v31, v57, v57, 0x409d30fc
  v_add_f32 v30, 1.0, v30
  v_mfma_f32_16x16x32_bf16 v[44:47], v[140:143], a[12:15], v[44:47]
  v_rcp_f32 v30, v30
  v_mfma_f32_16x16x32_bf16 v[44:47], v[144:147], a[24:27], v[44:47]
  buffer_load_dwordx4 v[120:123], v3, s[12:15], s56 offen offset:2048 sc1
  v_mul_f32 v31, v31, v57
  v_mul_f32 v30, v30, v56
  v_mfma_f32_16x16x32_bf16 v[44:47], v[148:151], a[36:39], v[44:47]
  v_exp_f32 v31, v31
  v_mfma_f32_16x16x32_bf16 v[44:47], v[152:155], a[48:51], v[44:47]
  v_fmaak_f32 v26, v58, v58, 0x409d30fc
  v_add_f32 v31, 1.0, v31
  v_mfma_f32_16x16x32_bf16 v[44:47], v[156:159], a[60:63], v[44:47]
  v_rcp_f32 v31, v31
  v_mfma_f32_16x16x32_bf16 v[48:51], v[136:139], a[4:7], 0
  buffer_load_dwordx4 v[124:127], v3, s[12:15], s56 offen offset:3072 sc1
  v_mul_f32 v26, v26, v58
  v_mul_f32 v31, v31, v57
  v_mfma_f32_16x16x32_bf16 v[48:51], v[140:143], a[16:19], v[48:51]
  v_exp_f32 v26, v26
  v_mfma_f32_16x16x32_bf16 v[48:51], v[144:147], a[28:31], v[48:51]
  v_fmaak_f32 v27, v59, v59, 0x409d30fc
  v_add_f32 v26, 1.0, v26
  v_mfma_f32_16x16x32_bf16 v[48:51], v[148:151], a[40:43], v[48:51]
  v_rcp_f32 v26, v26
  v_mfma_f32_16x16x32_bf16 v[48:51], v[152:155], a[52:55], v[48:51]
  buffer_load_dwordx4 v[128:131], v85, s[12:15], s56 offen offset:0 sc1
  v_mul_f32 v27, v27, v59
  v_mul_f32 v26, v26, v58
  v_mfma_f32_16x16x32_bf16 v[48:51], v[156:159], a[64:67], v[48:51]
  v_exp_f32 v27, v27
  v_mfma_f32_16x16x32_bf16 v[52:55], v[136:139], a[8:11], 0
  v_fmaak_f32 v28, v60, v60, 0x409d30fc
  v_add_f32 v27, 1.0, v27
  v_mfma_f32_16x16x32_bf16 v[52:55], v[140:143], a[20:23], v[52:55]
  v_rcp_f32 v27, v27
  v_mfma_f32_16x16x32_bf16 v[52:55], v[144:147], a[32:35], v[52:55]
  buffer_load_dwordx4 v[132:135], v85, s[12:15], s56 offen offset:1024 sc1
  v_mul_f32 v28, v28, v60
  v_mul_f32 v27, v27, v59
  v_mfma_f32_16x16x32_bf16 v[52:55], v[148:151], a[44:47], v[52:55]
  v_exp_f32 v28, v28
  v_mfma_f32_16x16x32_bf16 v[52:55], v[152:155], a[56:59], v[52:55]
  v_cvt_pk_bf16_f32 v32, v30, v31
  v_cvt_pk_bf16_f32 v33, v26, v27
  v_mfma_f32_16x16x32_bf16 v[52:55], v[156:159], a[68:71], v[52:55]
  ds_write_b64 v22, v[32:33] offset:8192
  s_waitcnt vmcnt(12)
  v_mfma_f32_16x16x32_bf16 v[40:43], v[160:163], v[208:211], v[40:43]
  buffer_load_dwordx4 v[136:139], v85, s[12:15], s56 offen offset:2048 sc1
  v_fmaak_f32 v29, v61, v61, 0x409d30fc
  v_add_f32 v28, 1.0, v28
  v_mfma_f32_16x16x32_bf16 v[40:43], v[164:167], v[212:215], v[40:43]
  v_rcp_f32 v28, v28
  v_mfma_f32_16x16x32_bf16 v[40:43], v[168:171], v[216:219], v[40:43]
  v_mul_f32 v29, v29, v61
  v_mul_f32 v28, v28, v60
  v_mfma_f32_16x16x32_bf16 v[40:43], v[172:175], v[220:223], v[40:43]
  v_exp_f32 v29, v29
  v_mfma_f32_16x16x32_bf16 v[40:43], v[176:179], v[224:227], v[40:43]
  buffer_load_dwordx4 v[140:143], v85, s[12:15], s56 offen offset:3072 sc1
  v_fmaak_f32 v30, v62, v62, 0x409d30fc
  v_add_f32 v29, 1.0, v29
  v_mfma_f32_16x16x32_bf16 v[40:43], v[180:183], v[228:231], v[40:43]
  v_rcp_f32 v29, v29
  v_mfma_f32_16x16x32_bf16 v[44:47], v[160:163], a[72:75], v[44:47]
  v_mul_f32 v30, v30, v62
  v_mul_f32 v29, v29, v61
  v_mfma_f32_16x16x32_bf16 v[44:47], v[164:167], a[84:87], v[44:47]
  v_exp_f32 v30, v30
  v_mfma_f32_16x16x32_bf16 v[44:47], v[168:171], a[96:99], v[44:47]
  buffer_load_dwordx4 v[144:147], v86, s[12:15], s56 offen offset:0 sc1
  v_fmaak_f32 v31, v63, v63, 0x409d30fc
  v_add_f32 v30, 1.0, v30
  v_mfma_f32_16x16x32_bf16 v[44:47], v[172:175], a[108:111], v[44:47]
  v_rcp_f32 v30, v30
  v_mfma_f32_16x16x32_bf16 v[44:47], v[176:179], a[120:123], v[44:47]
  v_mul_f32 v31, v31, v63
  v_mul_f32 v30, v30, v62
  v_mfma_f32_16x16x32_bf16 v[44:47], v[180:183], a[132:135], v[44:47]
  v_exp_f32 v31, v31
  v_mfma_f32_16x16x32_bf16 v[48:51], v[160:163], a[76:79], v[48:51]
  buffer_load_dwordx4 v[148:151], v86, s[12:15], s56 offen offset:1024 sc1
  v_fmaak_f32 v26, v64, v64, 0x409d30fc
  v_add_f32 v31, 1.0, v31
  v_mfma_f32_16x16x32_bf16 v[48:51], v[164:167], a[88:91], v[48:51]
  v_rcp_f32 v31, v31
  v_mfma_f32_16x16x32_bf16 v[48:51], v[168:171], a[100:103], v[48:51]
  v_mul_f32 v26, v26, v64
  v_mul_f32 v31, v31, v63
  v_mfma_f32_16x16x32_bf16 v[48:51], v[172:175], a[112:115], v[48:51]
  v_exp_f32 v26, v26
  v_mfma_f32_16x16x32_bf16 v[48:51], v[176:179], a[124:127], v[48:51]
  buffer_load_dwordx4 v[152:155], v86, s[12:15], s56 offen offset:2048 sc1
  v_cvt_pk_bf16_f32 v34, v28, v29
  v_cvt_pk_bf16_f32 v35, v30, v31
  v_mfma_f32_16x16x32_bf16 v[48:51], v[180:183], a[136:139], v[48:51]
  ds_write_b64 v23, v[34:35] offset:8192
  v_mfma_f32_16x16x32_bf16 v[52:55], v[160:163], a[80:83], v[52:55]
  v_fmaak_f32 v27, v65, v65, 0x409d30fc
  v_add_f32 v26, 1.0, v26
  v_mfma_f32_16x16x32_bf16 v[52:55], v[164:167], a[92:95], v[52:55]
  v_rcp_f32 v26, v26
  v_mfma_f32_16x16x32_bf16 v[52:55], v[168:171], a[104:107], v[52:55]
  buffer_load_dwordx4 v[156:159], v86, s[12:15], s56 offen offset:3072 sc1
  v_mul_f32 v27, v27, v65
  v_mul_f32 v26, v26, v64
  v_mfma_f32_16x16x32_bf16 v[52:55], v[172:175], a[116:119], v[52:55]
  v_exp_f32 v27, v27
  v_mfma_f32_16x16x32_bf16 v[52:55], v[176:179], a[128:131], v[52:55]
  v_fmaak_f32 v28, v66, v66, 0x409d30fc
  v_add_f32 v27, 1.0, v27
  v_mfma_f32_16x16x32_bf16 v[52:55], v[180:183], a[140:143], v[52:55]
  v_rcp_f32 v27, v27
  s_waitcnt vmcnt(12)
  v_mfma_f32_16x16x32_bf16 v[40:43], v[88:91], v[232:235], v[40:43]
  buffer_load_dwordx4 v[160:163], v87, s[12:15], s56 offen offset:0 sc1
  v_mul_f32 v28, v28, v66
  v_mul_f32 v27, v27, v65
  v_mfma_f32_16x16x32_bf16 v[40:43], v[92:95], v[236:239], v[40:43]
  v_exp_f32 v28, v28
  v_mfma_f32_16x16x32_bf16 v[40:43], v[96:99], v[240:243], v[40:43]
  v_fmaak_f32 v29, v67, v67, 0x409d30fc
  v_add_f32 v28, 1.0, v28
  v_mfma_f32_16x16x32_bf16 v[40:43], v[100:103], v[244:247], v[40:43]
  v_rcp_f32 v28, v28
  v_mfma_f32_16x16x32_bf16 v[40:43], v[104:107], v[248:251], v[40:43]
  buffer_load_dwordx4 v[164:167], v87, s[12:15], s56 offen offset:1024 sc1
  v_mul_f32 v29, v29, v67
  v_mul_f32 v28, v28, v66
  v_mfma_f32_16x16x32_bf16 v[40:43], v[108:111], v[252:255], v[40:43]
  v_exp_f32 v29, v29
  v_mfma_f32_16x16x32_bf16 v[44:47], v[88:91], a[144:147], v[44:47]
  v_fmaak_f32 v30, v68, v68, 0x409d30fc
  v_add_f32 v29, 1.0, v29
  v_mfma_f32_16x16x32_bf16 v[44:47], v[92:95], a[156:159], v[44:47]
  v_rcp_f32 v29, v29
  v_mfma_f32_16x16x32_bf16 v[44:47], v[96:99], a[168:171], v[44:47]
  buffer_load_dwordx4 v[168:171], v87, s[12:15], s56 offen offset:2048 sc1
  v_mul_f32 v30, v30, v68
  v_mul_f32 v29, v29, v67
  v_mfma_f32_16x16x32_bf16 v[44:47], v[100:103], a[180:183], v[44:47]
  v_exp_f32 v30, v30
  v_mfma_f32_16x16x32_bf16 v[44:47], v[104:107], a[192:195], v[44:47]
  v_cvt_pk_bf16_f32 v36, v26, v27
  v_cvt_pk_bf16_f32 v37, v28, v29
  v_mfma_f32_16x16x32_bf16 v[44:47], v[108:111], a[204:207], v[44:47]
  ds_write_b64 v24, v[36:37] offset:8192
  v_mfma_f32_16x16x32_bf16 v[48:51], v[88:91], a[148:151], v[48:51]
  buffer_load_dwordx4 v[172:175], v87, s[12:15], s56 offen offset:3072 sc1
  v_fmaak_f32 v31, v69, v69, 0x409d30fc
  v_add_f32 v30, 1.0, v30
  v_mfma_f32_16x16x32_bf16 v[48:51], v[92:95], a[160:163], v[48:51]
  v_rcp_f32 v30, v30
  v_mfma_f32_16x16x32_bf16 v[48:51], v[96:99], a[172:175], v[48:51]
  v_mul_f32 v31, v31, v69
  v_mul_f32 v30, v30, v68
  v_mfma_f32_16x16x32_bf16 v[48:51], v[100:103], a[184:187], v[48:51]
  v_exp_f32 v31, v31
  v_mfma_f32_16x16x32_bf16 v[48:51], v[104:107], a[196:199], v[48:51]
  buffer_load_dwordx4 v[176:179], v9, s[12:15], s56 offen offset:0 sc1
  v_fmaak_f32 v26, v70, v70, 0x409d30fc
  v_add_f32 v31, 1.0, v31
  v_mfma_f32_16x16x32_bf16 v[48:51], v[108:111], a[208:211], v[48:51]
  v_rcp_f32 v31, v31
  v_mfma_f32_16x16x32_bf16 v[52:55], v[88:91], a[152:155], v[52:55]
  v_mul_f32 v26, v26, v70
  v_mul_f32 v31, v31, v69
  v_mfma_f32_16x16x32_bf16 v[52:55], v[92:95], a[164:167], v[52:55]
  v_exp_f32 v26, v26
  v_mfma_f32_16x16x32_bf16 v[52:55], v[96:99], a[176:179], v[52:55]
  buffer_load_dwordx4 v[180:183], v9, s[12:15], s56 offen offset:1024 sc1
  v_fmaak_f32 v27, v71, v71, 0x409d30fc
  v_add_f32 v26, 1.0, v26
  v_mfma_f32_16x16x32_bf16 v[52:55], v[100:103], a[188:191], v[52:55]
  v_rcp_f32 v26, v26
  v_mfma_f32_16x16x32_bf16 v[52:55], v[104:107], a[200:203], v[52:55]
  v_mul_f32 v27, v27, v71
  v_mul_f32 v26, v26, v70
  v_mfma_f32_16x16x32_bf16 v[52:55], v[108:111], a[212:215], v[52:55]
  v_exp_f32 v27, v27
  s_waitcnt vmcnt(12)
  v_mfma_f32_16x16x32_bf16 v[56:59], v[112:115], v[184:187], 0
  s_add_u32 s56, s84, 294912
  buffer_load_dwordx4 v[88:91], v3, s[12:15], s56 offen offset:0 sc1
  v_fmaak_f32 v28, v40, v40, 0x409d30fc
  v_add_f32 v27, 1.0, v27
  v_mfma_f32_16x16x32_bf16 v[56:59], v[116:119], v[188:191], v[56:59]
  v_rcp_f32 v27, v27
  v_mfma_f32_16x16x32_bf16 v[56:59], v[120:123], v[192:195], v[56:59]
  v_mul_f32 v28, v28, v40
  v_mul_f32 v27, v27, v71
  v_mfma_f32_16x16x32_bf16 v[56:59], v[124:127], v[196:199], v[56:59]
  v_exp_f32 v28, v28
  v_mfma_f32_16x16x32_bf16 v[56:59], v[128:131], v[200:203], v[56:59]
  buffer_load_dwordx4 v[92:95], v3, s[12:15], s56 offen offset:1024 sc1
  v_cvt_pk_bf16_f32 v38, v30, v31
  v_cvt_pk_bf16_f32 v39, v26, v27
  v_mfma_f32_16x16x32_bf16 v[56:59], v[132:135], v[204:207], v[56:59]
  ds_write_b64 v25, v[38:39] offset:8192
  v_mfma_f32_16x16x32_bf16 v[60:63], v[112:115], a[0:3], 0
  v_fmaak_f32 v29, v41, v41, 0x409d30fc
  v_add_f32 v28, 1.0, v28
  v_mfma_f32_16x16x32_bf16 v[60:63], v[116:119], a[12:15], v[60:63]
  v_rcp_f32 v28, v28
  v_mfma_f32_16x16x32_bf16 v[60:63], v[120:123], a[24:27], v[60:63]
  buffer_load_dwordx4 v[96:99], v3, s[12:15], s56 offen offset:2048 sc1
  v_mul_f32 v29, v29, v41
  v_mul_f32 v28, v28, v40
  v_mfma_f32_16x16x32_bf16 v[60:63], v[124:127], a[36:39], v[60:63]
  v_exp_f32 v29, v29
  v_mfma_f32_16x16x32_bf16 v[60:63], v[128:131], a[48:51], v[60:63]
  v_fmaak_f32 v30, v42, v42, 0x409d30fc
  v_add_f32 v29, 1.0, v29
  v_mfma_f32_16x16x32_bf16 v[60:63], v[132:135], a[60:63], v[60:63]
  v_rcp_f32 v29, v29
  v_mfma_f32_16x16x32_bf16 v[64:67], v[112:115], a[4:7], 0
  buffer_load_dwordx4 v[100:103], v3, s[12:15], s56 offen offset:3072 sc1
  v_mul_f32 v30, v30, v42
  v_mul_f32 v29, v29, v41
  v_mfma_f32_16x16x32_bf16 v[64:67], v[116:119], a[16:19], v[64:67]
PAD_7:
  s_cbranch_execz WRET_1
  v_exp_f32 v30, v30
  v_mfma_f32_16x16x32_bf16 v[64:67], v[120:123], a[28:31], v[64:67]
  v_fmaak_f32 v31, v43, v43, 0x409d30fc
  v_add_f32 v30, 1.0, v30
  v_mfma_f32_16x16x32_bf16 v[64:67], v[124:127], a[40:43], v[64:67]
  v_rcp_f32 v30, v30
  v_mfma_f32_16x16x32_bf16 v[64:67], v[128:131], a[52:55], v[64:67]
  buffer_load_dwordx4 v[104:107], v85, s[12:15], s56 offen offset:0 sc1
  v_mul_f32 v31, v31, v43
  v_mul_f32 v30, v30, v42
  v_mfma_f32_16x16x32_bf16 v[64:67], v[132:135], a[64:67], v[64:67]
  v_exp_f32 v31, v31
  v_mfma_f32_16x16x32_bf16 v[68:71], v[112:115], a[8:11], 0
  v_fmaak_f32 v26, v44, v44, 0x409d30fc
  v_add_f32 v31, 1.0, v31
  v_mfma_f32_16x16x32_bf16 v[68:71], v[116:119], a[20:23], v[68:71]
  v_rcp_f32 v31, v31
  v_mfma_f32_16x16x32_bf16 v[68:71], v[120:123], a[32:35], v[68:71]
  buffer_load_dwordx4 v[108:111], v85, s[12:15], s56 offen offset:1024 sc1
  v_mul_f32 v26, v26, v44
  v_mul_f32 v31, v31, v43
  v_mfma_f32_16x16x32_bf16 v[68:71], v[124:127], a[44:47], v[68:71]
  v_exp_f32 v26, v26
  v_mfma_f32_16x16x32_bf16 v[68:71], v[128:131], a[56:59], v[68:71]
  v_cvt_pk_bf16_f32 v32, v28, v29
  v_cvt_pk_bf16_f32 v33, v30, v31
  v_mfma_f32_16x16x32_bf16 v[68:71], v[132:135], a[68:71], v[68:71]
  ds_write_b64 v22, v[32:33] offset:16384
  s_waitcnt vmcnt(12)
  v_mfma_f32_16x16x32_bf16 v[56:59], v[136:139], v[208:211], v[56:59]
  buffer_load_dwordx4 v[112:115], v85, s[12:15], s56 offen offset:2048 sc1
  v_fmaak_f32 v27, v45, v45, 0x409d30fc
  v_add_f32 v26, 1.0, v26
  v_mfma_f32_16x16x32_bf16 v[56:59], v[140:143], v[212:215], v[56:59]
  v_rcp_f32 v26, v26
  v_mfma_f32_16x16x32_bf16 v[56:59], v[144:147], v[216:219], v[56:59]
  s_mov_b32 s57, 1024
  buffer_load_dwordx4 v[72:75], v3, s[12:15], s57 offen sc1
  v_mul_f32 v27, v27, v45
  v_mul_f32 v26, v26, v44
  v_mfma_f32_16x16x32_bf16 v[56:59], v[148:151], v[220:223], v[56:59]
  v_exp_f32 v27, v27
  v_mfma_f32_16x16x32_bf16 v[56:59], v[152:155], v[224:227], v[56:59]
  buffer_load_dwordx4 v[116:119], v85, s[12:15], s56 offen offset:3072 sc1
  v_fmaak_f32 v28, v46, v46, 0x409d30fc
  v_add_f32 v27, 1.0, v27
  v_mfma_f32_16x16x32_bf16 v[56:59], v[156:159], v[228:231], v[56:59]
  v_rcp_f32 v27, v27
  v_mfma_f32_16x16x32_bf16 v[60:63], v[136:139], a[72:75], v[60:63]
  v_mul_f32 v28, v28, v46
  v_mul_f32 v27, v27, v45
  v_mfma_f32_16x16x32_bf16 v[60:63], v[140:143], a[84:87], v[60:63]
  v_exp_f32 v28, v28
  v_mfma_f32_16x16x32_bf16 v[60:63], v[144:147], a[96:99], v[60:63]
  buffer_load_dwordx4 v[120:123], v86, s[12:15], s56 offen offset:0 sc1
  v_fmaak_f32 v29, v47, v47, 0x409d30fc
  v_add_f32 v28, 1.0, v28
  v_mfma_f32_16x16x32_bf16 v[60:63], v[148:151], a[108:111], v[60:63]
  v_rcp_f32 v28, v28
  v_mfma_f32_16x16x32_bf16 v[60:63], v[152:155], a[120:123], v[60:63]
  v_mul_f32 v29, v29, v47
  v_mul_f32 v28, v28, v46
  v_mfma_f32_16x16x32_bf16 v[60:63], v[156:159], a[132:135], v[60:63]
  v_exp_f32 v29, v29
  v_mfma_f32_16x16x32_bf16 v[64:67], v[136:139], a[76:79], v[64:67]
  buffer_load_dwordx4 v[124:127], v86, s[12:15], s56 offen offset:1024 sc1
  v_fmaak_f32 v30, v48, v48, 0x409d30fc
  v_add_f32 v29, 1.0, v29
  v_mfma_f32_16x16x32_bf16 v[64:67], v[140:143], a[88:91], v[64:67]
  v_rcp_f32 v29, v29
  v_mfma_f32_16x16x32_bf16 v[64:67], v[144:147], a[100:103], v[64:67]
  v_mul_f32 v30, v30, v48
  v_mul_f32 v29, v29, v47
  v_mfma_f32_16x16x32_bf16 v[64:67], v[148:151], a[112:115], v[64:67]
  v_exp_f32 v30, v30
  v_mfma_f32_16x16x32_bf16 v[64:67], v[152:155], a[124:127], v[64:67]
  buffer_load_dwordx4 v[128:131], v86, s[12:15], s56 offen offset:2048 sc1
  v_cvt_pk_bf16_f32 v34, v26, v27
  v_cvt_pk_bf16_f32 v35, v28, v29
  v_mfma_f32_16x16x32_bf16 v[64:67], v[156:159], a[136:139], v[64:67]
  ds_write_b64 v23, v[34:35] offset:16384
  v_mfma_f32_16x16x32_bf16 v[68:71], v[136:139], a[80:83], v[68:71]
  v_fmaak_f32 v31, v49, v49, 0x409d30fc
  v_add_f32 v30, 1.0, v30
  v_mfma_f32_16x16x32_bf16 v[68:71], v[140:143], a[92:95], v[68:71]
  v_rcp_f32 v30, v30
  v_mfma_f32_16x16x32_bf16 v[68:71], v[144:147], a[104:107], v[68:71]
  buffer_load_dwordx4 v[132:135], v86, s[12:15], s56 offen offset:3072 sc1
  v_mul_f32 v31, v31, v49
  v_mul_f32 v30, v30, v48
  v_mfma_f32_16x16x32_bf16 v[68:71], v[148:151], a[116:119], v[68:71]
  v_exp_f32 v31, v31
  v_mfma_f32_16x16x32_bf16 v[68:71], v[152:155], a[128:131], v[68:71]
  v_fmaak_f32 v26, v50, v50, 0x409d30fc
  v_add_f32 v31, 1.0, v31
  v_mfma_f32_16x16x32_bf16 v[68:71], v[156:159], a[140:143], v[68:71]
  v_rcp_f32 v31, v31
  s_waitcnt vmcnt(13)
  v_mfma_f32_16x16x32_bf16 v[56:59], v[160:163], v[232:235], v[56:59]
  buffer_load_dwordx4 v[136:139], v87, s[12:15], s56 offen offset:0 sc1
  v_mul_f32 v26, v26, v50
  v_mul_f32 v31, v31, v49
  v_mfma_f32_16x16x32_bf16 v[56:59], v[164:167], v[236:239], v[56:59]
  v_exp_f32 v26, v26
  v_mfma_f32_16x16x32_bf16 v[56:59], v[168:171], v[240:243], v[56:59]
  v_fmaak_f32 v27, v51, v51, 0x409d30fc
  v_add_f32 v26, 1.0, v26
  v_mfma_f32_16x16x32_bf16 v[56:59], v[172:175], v[244:247], v[56:59]
  v_rcp_f32 v26, v26
  v_mfma_f32_16x16x32_bf16 v[56:59], v[176:179], v[248:251], v[56:59]
  buffer_load_dwordx4 v[140:143], v87, s[12:15], s56 offen offset:1024 sc1
  v_mul_f32 v27, v27, v51
  v_mul_f32 v26, v26, v50
  v_mfma_f32_16x16x32_bf16 v[56:59], v[180:183], v[252:255], v[56:59]
  v_exp_f32 v27, v27
  v_mfma_f32_16x16x32_bf16 v[60:63], v[160:163], a[144:147], v[60:63]
  v_fmaak_f32 v28, v52, v52, 0x409d30fc
  v_add_f32 v27, 1.0, v27
  v_mfma_f32_16x16x32_bf16 v[60:63], v[164:167], a[156:159], v[60:63]
  v_rcp_f32 v27, v27
  v_mfma_f32_16x16x32_bf16 v[60:63], v[168:171], a[168:171], v[60:63]
  buffer_load_dwordx4 v[144:147], v87, s[12:15], s56 offen offset:2048 sc1
  v_mul_f32 v28, v28, v52
  v_mul_f32 v27, v27, v51
  v_mfma_f32_16x16x32_bf16 v[60:63], v[172:175], a[180:183], v[60:63]
  v_exp_f32 v28, v28
  v_mfma_f32_16x16x32_bf16 v[60:63], v[176:179], a[192:195], v[60:63]
  v_cvt_pk_bf16_f32 v36, v30, v31
  v_cvt_pk_bf16_f32 v37, v26, v27
  v_mfma_f32_16x16x32_bf16 v[60:63], v[180:183], a[204:207], v[60:63]
  ds_write_b64 v24, v[36:37] offset:16384
  v_mfma_f32_16x16x32_bf16 v[64:67], v[160:163], a[148:151], v[64:67]
  buffer_load_dwordx4 v[148:151], v87, s[12:15], s56 offen offset:3072 sc1
  v_fmaak_f32 v29, v53, v53, 0x409d30fc
  v_add_f32 v28, 1.0, v28
  v_mfma_f32_16x16x32_bf16 v[64:67], v[164:167], a[160:163], v[64:67]
  v_rcp_f32 v28, v28
  v_mfma_f32_16x16x32_bf16 v[64:67], v[168:171], a[172:175], v[64:67]
  v_mul_f32 v29, v29, v53
  v_mul_f32 v28, v28, v52
  v_mfma_f32_16x16x32_bf16 v[64:67], v[172:175], a[184:187], v[64:67]
  v_exp_f32 v29, v29
  v_mfma_f32_16x16x32_bf16 v[64:67], v[176:179], a[196:199], v[64:67]
  buffer_load_dwordx4 v[152:155], v9, s[12:15], s56 offen offset:0 sc1
  v_fmaak_f32 v30, v54, v54, 0x409d30fc
  v_add_f32 v29, 1.0, v29
  v_mfma_f32_16x16x32_bf16 v[64:67], v[180:183], a[208:211], v[64:67]
  v_rcp_f32 v29, v29
  v_mfma_f32_16x16x32_bf16 v[68:71], v[160:163], a[152:155], v[68:71]
  v_mul_f32 v30, v30, v54
  v_mul_f32 v29, v29, v53
  v_mfma_f32_16x16x32_bf16 v[68:71], v[164:167], a[164:167], v[68:71]
  v_exp_f32 v30, v30
  v_mfma_f32_16x16x32_bf16 v[68:71], v[168:171], a[176:179], v[68:71]
  buffer_load_dwordx4 v[156:159], v9, s[12:15], s56 offen offset:1024 sc1
  v_fmaak_f32 v31, v55, v55, 0x409d30fc
  v_add_f32 v30, 1.0, v30
  v_mfma_f32_16x16x32_bf16 v[68:71], v[172:175], a[188:191], v[68:71]
  v_rcp_f32 v30, v30
  v_mfma_f32_16x16x32_bf16 v[68:71], v[176:179], a[200:203], v[68:71]
  v_mul_f32 v31, v31, v55
  v_mul_f32 v30, v30, v54
  v_mfma_f32_16x16x32_bf16 v[68:71], v[180:183], a[212:215], v[68:71]
  v_exp_f32 v31, v31
  s_waitcnt vmcnt(13)
  v_mfma_f32_16x16x32_bf16 v[40:43], v[88:91], v[184:187], 0
  s_add_u32 s56, s84, 368640
  buffer_load_dwordx4 v[160:163], v3, s[12:15], s56 offen offset:0 sc1
  v_fmaak_f32 v26, v56, v56, 0x409d30fc
  v_add_f32 v31, 1.0, v31
  v_mfma_f32_16x16x32_bf16 v[40:43], v[92:95], v[188:191], v[40:43]
  v_rcp_f32 v31, v31
  v_mfma_f32_16x16x32_bf16 v[40:43], v[96:99], v[192:195], v[40:43]
  v_mul_f32 v26, v26, v56
  v_mul_f32 v31, v31, v55
  v_mfma_f32_16x16x32_bf16 v[40:43], v[100:103], v[196:199], v[40:43]
  v_exp_f32 v26, v26
  v_mfma_f32_16x16x32_bf16 v[40:43], v[104:107], v[200:203], v[40:43]
  buffer_load_dwordx4 v[164:167], v3, s[12:15], s56 offen offset:1024 sc1
  v_cvt_pk_bf16_f32 v38, v28, v29
  v_cvt_pk_bf16_f32 v39, v30, v31
  v_mfma_f32_16x16x32_bf16 v[40:43], v[108:111], v[204:207], v[40:43]
  ds_write_b64 v25, v[38:39] offset:16384
  v_mfma_f32_16x16x32_bf16 v[44:47], v[88:91], a[0:3], 0
  s_waitcnt vmcnt(13)
  v_min3_u32 v72, v72, v73, v74
  v_min_u32 v72, v72, v75
  v_cmp_eq_u32 vcc, 0, v72
  s_mov_b32 s58, 0
  s_nop 3
  s_cbranch_vccz L_ok22
L_sp23:
  s_sleep 8
  s_mov_b32 s57, 1024
  buffer_load_dwordx4 v[72:75], v3, s[12:15], s57 offen sc1
  s_add_u32 s58, s58, 1
  s_cmp_gt_u32 s58, 400000
  s_cbranch_scc1 L_ok22
  s_waitcnt vmcnt(0)
  v_min3_u32 v72, v72, v73, v74
  v_min_u32 v72, v72, v75
  v_cmp_eq_u32 vcc, 0, v72
  s_nop 4
  s_cbranch_vccnz L_sp23
L_ok22:
  v_fmaak_f32 v27, v57, v57, 0x409d30fc
  v_add_f32 v26, 1.0, v26
  v_mfma_f32_16x16x32_bf16 v[44:47], v[92:95], a[12:15], v[44:47]
  v_rcp_f32 v26, v26
  v_mfma_f32_16x16x32_bf16 v[44:47], v[96:99], a[24:27], v[44:47]
  buffer_load_dwordx4 v[168:171], v3, s[12:15], s56 offen offset:2048 sc1
  v_mul_f32 v27, v27, v57
  v_mul_f32 v26, v26, v56
  v_mfma_f32_16x16x32_bf16 v[44:47], v[100:103], a[36:39], v[44:47]
  v_exp_f32 v27, v27
  v_mfma_f32_16x16x32_bf16 v[44:47], v[104:107], a[48:51], v[44:47]
  v_fmaak_f32 v28, v58, v58, 0x409d30fc
  v_add_f32 v27, 1.0, v27
  v_mfma_f32_16x16x32_bf16 v[44:47], v[108:111], a[60:63], v[44:47]
  v_rcp_f32 v27, v27
  v_mfma_f32_16x16x32_bf16 v[48:51], v[88:91], a[4:7], 0
  buffer_load_dwordx4 v[172:175], v3, s[12:15], s56 offen offset:3072 sc1
  v_mul_f32 v28, v28, v58
  v_mul_f32 v27, v27, v57
  v_mfma_f32_16x16x32_bf16 v[48:51], v[92:95], a[16:19], v[48:51]
  v_exp_f32 v28, v28
  v_mfma_f32_16x16x32_bf16 v[48:51], v[96:99], a[28:31], v[48:51]
  s_add_u32 m0, s93, 0
  s_add_u32 s59, s92, 8192
  buffer_load_dwordx4 v3, s[12:15], s59 offen offset:0 sc1 lds
  v_fmaak_f32 v29, v59, v59, 0x409d30fc
  v_add_f32 v28, 1.0, v28
  v_mfma_f32_16x16x32_bf16 v[48:51], v[100:103], a[40:43], v[48:51]
  v_rcp_f32 v28, v28
  v_mfma_f32_16x16x32_bf16 v[48:51], v[104:107], a[52:55], v[48:51]
  buffer_load_dwordx4 v[176:179], v85, s[12:15], s56 offen offset:0 sc1
  v_mul_f32 v29, v29, v59
  v_mul_f32 v28, v28, v58
  v_mfma_f32_16x16x32_bf16 v[48:51], v[108:111], a[64:67], v[48:51]
  v_exp_f32 v29, v29
  v_mfma_f32_16x16x32_bf16 v[52:55], v[88:91], a[8:11], 0
  v_fmaak_f32 v30, v60, v60, 0x409d30fc
  v_add_f32 v29, 1.0, v29
  v_mfma_f32_16x16x32_bf16 v[52:55], v[92:95], a[20:23], v[52:55]
  v_rcp_f32 v29, v29
  v_mfma_f32_16x16x32_bf16 v[52:55], v[96:99], a[32:35], v[52:55]
  buffer_load_dwordx4 v[180:183], v85, s[12:15], s56 offen offset:1024 sc1
  v_mul_f32 v30, v30, v60
  v_mul_f32 v29, v29, v59
  v_mfma_f32_16x16x32_bf16 v[52:55], v[100:103], a[44:47], v[52:55]
  v_exp_f32 v30, v30
  v_mfma_f32_16x16x32_bf16 v[52:55], v[104:107], a[56:59], v[52:55]
  v_cvt_pk_bf16_f32 v32, v26, v27
  v_cvt_pk_bf16_f32 v33, v28, v29
  v_mfma_f32_16x16x32_bf16 v[52:55], v[108:111], a[68:71], v[52:55]
  ds_write_b64 v22, v[32:33] offset:24576
  s_waitcnt vmcnt(13)
  v_mfma_f32_16x16x32_bf16 v[40:43], v[112:115], v[208:211], v[40:43]
  buffer_load_dwordx4 v[88:91], v85, s[12:15], s56 offen offset:2048 sc1
  v_fmaak_f32 v31, v61, v61, 0x409d30fc
  v_add_f32 v30, 1.0, v30
  v_mfma_f32_16x16x32_bf16 v[40:43], v[116:119], v[212:215], v[40:43]
  v_rcp_f32 v30, v30
  v_mfma_f32_16x16x32_bf16 v[40:43], v[120:123], v[216:219], v[40:43]
  v_mul_f32 v31, v31, v61
  v_mul_f32 v30, v30, v60
  v_mfma_f32_16x16x32_bf16 v[40:43], v[124:127], v[220:223], v[40:43]
  v_exp_f32 v31, v31
  v_mfma_f32_16x16x32_bf16 v[40:43], v[128:131], v[224:227], v[40:43]
  buffer_load_dwordx4 v[92:95], v85, s[12:15], s56 offen offset:3072 sc1
  v_fmaak_f32 v26, v62, v62, 0x409d30fc
  v_add_f32 v31, 1.0, v31
  v_mfma_f32_16x16x32_bf16 v[40:43], v[132:135], v[228:231], v[40:43]
  v_rcp_f32 v31, v31
  v_mfma_f32_16x16x32_bf16 v[44:47], v[112:115], a[72:75], v[44:47]
  v_mul_f32 v26, v26, v62
  v_mul_f32 v31, v31, v61
  v_mfma_f32_16x16x32_bf16 v[44:47], v[116:119], a[84:87], v[44:47]
  v_exp_f32 v26, v26
  v_mfma_f32_16x16x32_bf16 v[44:47], v[120:123], a[96:99], v[44:47]
  buffer_load_dwordx4 v[96:99], v86, s[12:15], s56 offen offset:0 sc1
  v_fmaak_f32 v27, v63, v63, 0x409d30fc
  v_add_f32 v26, 1.0, v26
  v_mfma_f32_16x16x32_bf16 v[44:47], v[124:127], a[108:111], v[44:47]
  v_rcp_f32 v26, v26
  v_mfma_f32_16x16x32_bf16 v[44:47], v[128:131], a[120:123], v[44:47]
  v_mul_f32 v27, v27, v63
  v_mul_f32 v26, v26, v62
  v_mfma_f32_16x16x32_bf16 v[44:47], v[132:135], a[132:135], v[44:47]
  v_exp_f32 v27, v27
  v_mfma_f32_16x16x32_bf16 v[48:51], v[112:115], a[76:79], v[48:51]
  buffer_load_dwordx4 v[100:103], v86, s[12:15], s56 offen offset:1024 sc1
  v_fmaak_f32 v28, v64, v64, 0x409d30fc
  v_add_f32 v27, 1.0, v27
  v_mfma_f32_16x16x32_bf16 v[48:51], v[116:119], a[88:91], v[48:51]
  v_rcp_f32 v27, v27
  v_mfma_f32_16x16x32_bf16 v[48:51], v[120:123], a[100:103], v[48:51]
  buffer_load_dwordx4 v3, s[12:15], s59 offen offset:1024 sc1 lds
  v_mul_f32 v28, v28, v64
  v_mul_f32 v27, v27, v63
  v_mfma_f32_16x16x32_bf16 v[48:51], v[124:127], a[112:115], v[48:51]
  v_exp_f32 v28, v28
  v_mfma_f32_16x16x32_bf16 v[48:51], v[128:131], a[124:127], v[48:51]
  buffer_load_dwordx4 v[104:107], v86, s[12:15], s56 offen offset:2048 sc1
  v_cvt_pk_bf16_f32 v34, v30, v31
  v_cvt_pk_bf16_f32 v35, v26, v27
  v_mfma_f32_16x16x32_bf16 v[48:51], v[132:135], a[136:139], v[48:51]
  ds_write_b64 v23, v[34:35] offset:24576
  v_mfma_f32_16x16x32_bf16 v[52:55], v[112:115], a[80:83], v[52:55]
  v_fmaak_f32 v29, v65, v65, 0x409d30fc
  v_add_f32 v28, 1.0, v28
  v_mfma_f32_16x16x32_bf16 v[52:55], v[116:119], a[92:95], v[52:55]
  v_rcp_f32 v28, v28
  v_mfma_f32_16x16x32_bf16 v[52:55], v[120:123], a[104:107], v[52:55]
  buffer_load_dwordx4 v[108:111], v86, s[12:15], s56 offen offset:3072 sc1
  v_mul_f32 v29, v29, v65
  v_mul_f32 v28, v28, v64
  v_mfma_f32_16x16x32_bf16 v[52:55], v[124:127], a[116:119], v[52:55]
  v_exp_f32 v29, v29
  v_mfma_f32_16x16x32_bf16 v[52:55], v[128:131], a[128:131], v[52:55]
  v_fmaak_f32 v30, v66, v66, 0x409d30fc
  v_add_f32 v29, 1.0, v29
  v_mfma_f32_16x16x32_bf16 v[52:55], v[132:135], a[140:143], v[52:55]
  v_rcp_f32 v29, v29
  s_waitcnt vmcnt(14)
  v_mfma_f32_16x16x32_bf16 v[40:43], v[136:139], v[232:235], v[40:43]
  buffer_load_dwordx4 v[112:115], v87, s[12:15], s56 offen offset:0 sc1
  v_mul_f32 v30, v30, v66
  v_mul_f32 v29, v29, v65
  v_mfma_f32_16x16x32_bf16 v[40:43], v[140:143], v[236:239], v[40:43]
  v_exp_f32 v30, v30
  v_mfma_f32_16x16x32_bf16 v[40:43], v[144:147], v[240:243], v[40:43]
  v_fmaak_f32 v31, v67, v67, 0x409d30fc
  v_add_f32 v30, 1.0, v30
  v_mfma_f32_16x16x32_bf16 v[40:43], v[148:151], v[244:247], v[40:43]
  v_rcp_f32 v30, v30
  v_mfma_f32_16x16x32_bf16 v[40:43], v[152:155], v[248:251], v[40:43]
  buffer_load_dwordx4 v[116:119], v87, s[12:15], s56 offen offset:1024 sc1
  v_mul_f32 v31, v31, v67
  v_mul_f32 v30, v30, v66
  v_mfma_f32_16x16x32_bf16 v[40:43], v[156:159], v[252:255], v[40:43]
  v_exp_f32 v31, v31
  v_mfma_f32_16x16x32_bf16 v[44:47], v[136:139], a[144:147], v[44:47]
  v_fmaak_f32 v26, v68, v68, 0x409d30fc
  v_add_f32 v31, 1.0, v31
  v_mfma_f32_16x16x32_bf16 v[44:47], v[140:143], a[156:159], v[44:47]
  v_rcp_f32 v31, v31
  v_mfma_f32_16x16x32_bf16 v[44:47], v[144:147], a[168:171], v[44:47]
  buffer_load_dwordx4 v[120:123], v87, s[12:15], s56 offen offset:2048 sc1
  v_mul_f32 v26, v26, v68
  v_mul_f32 v31, v31, v67
  v_mfma_f32_16x16x32_bf16 v[44:47], v[148:151], a[180:183], v[44:47]
  v_exp_f32 v26, v26
  v_mfma_f32_16x16x32_bf16 v[44:47], v[152:155], a[192:195], v[44:47]
  v_cvt_pk_bf16_f32 v36, v28, v29
  v_cvt_pk_bf16_f32 v37, v30, v31
  v_mfma_f32_16x16x32_bf16 v[44:47], v[156:159], a[204:207], v[44:47]
  ds_write_b64 v24, v[36:37] offset:24576
  v_mfma_f32_16x16x32_bf16 v[48:51], v[136:139], a[148:151], v[48:51]
  buffer_load_dwordx4 v[124:127], v87, s[12:15], s56 offen offset:3072 sc1
  v_fmaak_f32 v27, v69, v69, 0x409d30fc
  v_add_f32 v26, 1.0, v26
  v_mfma_f32_16x16x32_bf16 v[48:51], v[140:143], a[160:163], v[48:51]
  v_rcp_f32 v26, v26
  v_mfma_f32_16x16x32_bf16 v[48:51], v[144:147], a[172:175], v[48:51]
  s_add_u32 m0, s93, 2048
  s_add_u32 s59, s91, 8192
  buffer_load_dwordx4 v3, s[12:15], s59 offen offset:0 sc1 lds
  v_mul_f32 v27, v27, v69
  v_mul_f32 v26, v26, v68
  v_mfma_f32_16x16x32_bf16 v[48:51], v[148:151], a[184:187], v[48:51]
  v_exp_f32 v27, v27
  v_mfma_f32_16x16x32_bf16 v[48:51], v[152:155], a[196:199], v[48:51]
  buffer_load_dwordx4 v[128:131], v9, s[12:15], s56 offen offset:0 sc1
  v_fmaak_f32 v28, v70, v70, 0x409d30fc
  v_add_f32 v27, 1.0, v27
  v_mfma_f32_16x16x32_bf16 v[48:51], v[156:159], a[208:211], v[48:51]
  v_rcp_f32 v27, v27
  v_mfma_f32_16x16x32_bf16 v[52:55], v[136:139], a[152:155], v[52:55]
  v_mul_f32 v28, v28, v70
  v_mul_f32 v27, v27, v69
  v_mfma_f32_16x16x32_bf16 v[52:55], v[140:143], a[164:167], v[52:55]
  v_exp_f32 v28, v28
  v_mfma_f32_16x16x32_bf16 v[52:55], v[144:147], a[176:179], v[52:55]
  buffer_load_dwordx4 v[132:135], v9, s[12:15], s56 offen offset:1024 sc1
  v_fmaak_f32 v29, v71, v71, 0x409d30fc
  v_add_f32 v28, 1.0, v28
  v_mfma_f32_16x16x32_bf16 v[52:55], v[148:151], a[188:191], v[52:55]
  v_rcp_f32 v28, v28
  v_mfma_f32_16x16x32_bf16 v[52:55], v[152:155], a[200:203], v[52:55]
  v_mul_f32 v29, v29, v71
  v_mul_f32 v28, v28, v70
  v_mfma_f32_16x16x32_bf16 v[52:55], v[156:159], a[212:215], v[52:55]
  v_exp_f32 v29, v29
  s_waitcnt vmcnt(14)
  v_mfma_f32_16x16x32_bf16 v[56:59], v[160:163], v[184:187], 0
  s_add_u32 s56, s84, 442368
  buffer_load_dwordx4 v[136:139], v3, s[12:15], s56 offen offset:0 sc1
  v_fmaak_f32 v30, v40, v40, 0x409d30fc
  v_add_f32 v29, 1.0, v29
  v_mfma_f32_16x16x32_bf16 v[56:59], v[164:167], v[188:191], v[56:59]
  v_rcp_f32 v29, v29
  v_mfma_f32_16x16x32_bf16 v[56:59], v[168:171], v[192:195], v[56:59]
  v_mul_f32 v30, v30, v40
  v_mul_f32 v29, v29, v71
  v_mfma_f32_16x16x32_bf16 v[56:59], v[172:175], v[196:199], v[56:59]
  v_exp_f32 v30, v30
  v_mfma_f32_16x16x32_bf16 v[56:59], v[176:179], v[200:203], v[56:59]
  buffer_load_dwordx4 v[140:143], v3, s[12:15], s56 offen offset:1024 sc1
  v_cvt_pk_bf16_f32 v38, v26, v27
  v_cvt_pk_bf16_f32 v39, v28, v29
  v_mfma_f32_16x16x32_bf16 v[56:59], v[180:183], v[204:207], v[56:59]
  ds_write_b64 v25, v[38:39] offset:24576
  v_mfma_f32_16x16x32_bf16 v[60:63], v[160:163], a[0:3], 0
  v_fmaak_f32 v31, v41, v41, 0x409d30fc
  v_add_f32 v30, 1.0, v30
  v_mfma_f32_16x16x32_bf16 v[60:63], v[164:167], a[12:15], v[60:63]
  v_rcp_f32 v30, v30
  v_mfma_f32_16x16x32_bf16 v[60:63], v[168:171], a[24:27], v[60:63]
  buffer_load_dwordx4 v[144:147], v3, s[12:15], s56 offen offset:2048 sc1
  v_mul_f32 v31, v31, v41
  v_mul_f32 v30, v30, v40
  v_mfma_f32_16x16x32_bf16 v[60:63], v[172:175], a[36:39], v[60:63]
  v_exp_f32 v31, v31
  v_mfma_f32_16x16x32_bf16 v[60:63], v[176:179], a[48:51], v[60:63]
  v_fmaak_f32 v26, v42, v42, 0x409d30fc
  v_add_f32 v31, 1.0, v31
  v_mfma_f32_16x16x32_bf16 v[60:63], v[180:183], a[60:63], v[60:63]
  v_rcp_f32 v31, v31
  v_mfma_f32_16x16x32_bf16 v[64:67], v[160:163], a[4:7], 0
  buffer_load_dwordx4 v[148:151], v3, s[12:15], s56 offen offset:3072 sc1
  v_mul_f32 v26, v26, v42
  v_mul_f32 v31, v31, v41
  v_mfma_f32_16x16x32_bf16 v[64:67], v[164:167], a[16:19], v[64:67]
  v_exp_f32 v26, v26
  v_mfma_f32_16x16x32_bf16 v[64:67], v[168:171], a[28:31], v[64:67]
  buffer_load_dwordx4 v3, s[12:15], s59 offen offset:1024 sc1 lds
  v_fmaak_f32 v27, v43, v43, 0x409d30fc
  v_add_f32 v26, 1.0, v26
  v_mfma_f32_16x16x32_bf16 v[64:67], v[172:175], a[40:43], v[64:67]
  v_rcp_f32 v26, v26
  v_mfma_f32_16x16x32_bf16 v[64:67], v[176:179], a[52:55], v[64:67]
  buffer_load_dwordx4 v[152:155], v85, s[12:15], s56 offen offset:0 sc1
  v_mul_f32 v27, v27, v43
  v_mul_f32 v26, v26, v42
  v_mfma_f32_16x16x32_bf16 v[64:67], v[180:183], a[64:67], v[64:67]
  v_exp_f32 v27, v27
  v_mfma_f32_16x16x32_bf16 v[68:71], v[160:163], a[8:11], 0
  v_fmaak_f32 v28, v44, v44, 0x409d30fc
  v_add_f32 v27, 1.0, v27
  v_mfma_f32_16x16x32_bf16 v[68:71], v[164:167], a[20:23], v[68:71]
  v_rcp_f32 v27, v27
  v_mfma_f32_16x16x32_bf16 v[68:71], v[168:171], a[32:35], v[68:71]
  buffer_load_dwordx4 v[156:159], v85, s[12:15], s56 offen offset:1024 sc1
  v_mul_f32 v28, v28, v44
  v_mul_f32 v27, v27, v43
  v_mfma_f32_16x16x32_bf16 v[68:71], v[172:175], a[44:47], v[68:71]
  v_exp_f32 v28, v28
  v_mfma_f32_16x16x32_bf16 v[68:71], v[176:179], a[56:59], v[68:71]
  v_cvt_pk_bf16_f32 v32, v30, v31
  v_cvt_pk_bf16_f32 v33, v26, v27
  v_mfma_f32_16x16x32_bf16 v[68:71], v[180:183], a[68:71], v[68:71]
  ds_write_b64 v22, v[32:33] offset:32768
  s_waitcnt vmcnt(14)
  v_mfma_f32_16x16x32_bf16 v[56:59], v[88:91], v[208:211], v[56:59]
  buffer_load_dwordx4 v[160:163], v85, s[12:15], s56 offen offset:2048 sc1
  v_fmaak_f32 v29, v45, v45, 0x409d30fc
  v_add_f32 v28, 1.0, v28
  v_mfma_f32_16x16x32_bf16 v[56:59], v[92:95], v[212:215], v[56:59]
  v_rcp_f32 v28, v28
  v_mfma_f32_16x16x32_bf16 v[56:59], v[96:99], v[216:219], v[56:59]
  v_mul_f32 v29, v29, v45
  v_mul_f32 v28, v28, v44
  v_mfma_f32_16x16x32_bf16 v[56:59], v[100:103], v[220:223], v[56:59]
  v_exp_f32 v29, v29
  v_mfma_f32_16x16x32_bf16 v[56:59], v[104:107], v[224:227], v[56:59]
  buffer_load_dwordx4 v[164:167], v85, s[12:15], s56 offen offset:3072 sc1
  v_fmaak_f32 v30, v46, v46, 0x409d30fc
  v_add_f32 v29, 1.0, v29
  v_mfma_f32_16x16x32_bf16 v[56:59], v[108:111], v[228:231], v[56:59]
  v_rcp_f32 v29, v29
  v_mfma_f32_16x16x32_bf16 v[60:63], v[88:91], a[72:75], v[60:63]
  v_mul_f32 v30, v30, v46
  v_mul_f32 v29, v29, v45
  v_mfma_f32_16x16x32_bf16 v[60:63], v[92:95], a[84:87], v[60:63]
  v_exp_f32 v30, v30
  v_mfma_f32_16x16x32_bf16 v[60:63], v[96:99], a[96:99], v[60:63]
  buffer_load_dwordx4 v[168:171], v86, s[12:15], s56 offen offset:0 sc1
  v_fmaak_f32 v31, v47, v47, 0x409d30fc
  v_add_f32 v30, 1.0, v30
  v_mfma_f32_16x16x32_bf16 v[60:63], v[100:103], a[108:111], v[60:63]
  v_rcp_f32 v30, v30
  v_mfma_f32_16x16x32_bf16 v[60:63], v[104:107], a[120:123], v[60:63]
  v_mul_f32 v31, v31, v47
  v_mul_f32 v30, v30, v46
  v_mfma_f32_16x16x32_bf16 v[60:63], v[108:111], a[132:135], v[60:63]
  v_exp_f32 v31, v31
  v_mfma_f32_16x16x32_bf16 v[64:67], v[88:91], a[76:79], v[64:67]
  buffer_load_dwordx4 v[172:175], v86, s[12:15], s56 offen offset:1024 sc1
  v_fmaak_f32 v26, v48, v48, 0x409d30fc
  v_add_f32 v31, 1.0, v31
  v_mfma_f32_16x16x32_bf16 v[64:67], v[92:95], a[88:91], v[64:67]
  v_rcp_f32 v31, v31
  v_mfma_f32_16x16x32_bf16 v[64:67], v[96:99], a[100:103], v[64:67]
  s_add_u32 m0, s93, 4096
  s_add_u32 s59, s90, 8192
  buffer_load_dwordx4 v3, s[12:15], s59 offen offset:0 sc1 lds
  v_mul_f32 v26, v26, v48
  v_mul_f32 v31, v31, v47
  v_mfma_f32_16x16x32_bf16 v[64:67], v[100:103], a[112:115], v[64:67]
  v_exp_f32 v26, v26
  v_mfma_f32_16x16x32_bf16 v[64:67], v[104:107], a[124:127], v[64:67]
  buffer_load_dwordx4 v[176:179], v86, s[12:15], s56 offen offset:2048 sc1
  v_cvt_pk_bf16_f32 v34, v28, v29
  v_cvt_pk_bf16_f32 v35, v30, v31
  v_mfma_f32_16x16x32_bf16 v[64:67], v[108:111], a[136:139], v[64:67]
  ds_write_b64 v23, v[34:35] offset:32768
  v_mfma_f32_16x16x32_bf16 v[68:71], v[88:91], a[80:83], v[68:71]
  v_fmaak_f32 v27, v49, v49, 0x409d30fc
  v_add_f32 v26, 1.0, v26
  v_mfma_f32_16x16x32_bf16 v[68:71], v[92:95], a[92:95], v[68:71]
  v_rcp_f32 v26, v26
  v_mfma_f32_16x16x32_bf16 v[68:71], v[96:99], a[104:107], v[68:71]
  buffer_load_dwordx4 v[180:183], v86, s[12:15], s56 offen offset:3072 sc1
  v_mul_f32 v27, v27, v49
  v_mul_f32 v26, v26, v48
  v_mfma_f32_16x16x32_bf16 v[68:71], v[100:103], a[116:119], v[68:71]
  v_exp_f32 v27, v27
  v_mfma_f32_16x16x32_bf16 v[68:71], v[104:107], a[128:131], v[68:71]
  v_fmaak_f32 v28, v50, v50, 0x409d30fc
  v_add_f32 v27, 1.0, v27
  v_mfma_f32_16x16x32_bf16 v[68:71], v[108:111], a[140:143], v[68:71]
  v_rcp_f32 v27, v27
  s_waitcnt vmcnt(14)
  v_mfma_f32_16x16x32_bf16 v[56:59], v[112:115], v[232:235], v[56:59]
  buffer_load_dwordx4 v[88:91], v87, s[12:15], s56 offen offset:0 sc1
  v_mul_f32 v28, v28, v50
  v_mul_f32 v27, v27, v49
  v_mfma_f32_16x16x32_bf16 v[56:59], v[116:119], v[236:239], v[56:59]
  v_exp_f32 v28, v28
  v_mfma_f32_16x16x32_bf16 v[56:59], v[120:123], v[240:243], v[56:59]
  v_fmaak_f32 v29, v51, v51, 0x409d30fc
  v_add_f32 v28, 1.0, v28
  v_mfma_f32_16x16x32_bf16 v[56:59], v[124:127], v[244:247], v[56:59]
  v_rcp_f32 v28, v28
  v_mfma_f32_16x16x32_bf16 v[56:59], v[128:131], v[248:251], v[56:59]
  buffer_load_dwordx4 v[92:95], v87, s[12:15], s56 offen offset:1024 sc1
  v_mul_f32 v29, v29, v51
  v_mul_f32 v28, v28, v50
  v_mfma_f32_16x16x32_bf16 v[56:59], v[132:135], v[252:255], v[56:59]
  v_exp_f32 v29, v29
  v_mfma_f32_16x16x32_bf16 v[60:63], v[112:115], a[144:147], v[60:63]
  v_fmaak_f32 v30, v52, v52, 0x409d30fc
  v_add_f32 v29, 1.0, v29
  v_mfma_f32_16x16x32_bf16 v[60:63], v[116:119], a[156:159], v[60:63]
  v_rcp_f32 v29, v29
  v_mfma_f32_16x16x32_bf16 v[60:63], v[120:123], a[168:171], v[60:63]
  buffer_load_dwordx4 v[96:99], v87, s[12:15], s56 offen offset:2048 sc1
  v_mul_f32 v30, v30, v52
  v_mul_f32 v29, v29, v51
  v_mfma_f32_16x16x32_bf16 v[60:63], v[124:127], a[180:183], v[60:63]
  v_exp_f32 v30, v30
  v_mfma_f32_16x16x32_bf16 v[60:63], v[128:131], a[192:195], v[60:63]
  v_cvt_pk_bf16_f32 v36, v26, v27
  v_cvt_pk_bf16_f32 v37, v28, v29
  v_mfma_f32_16x16x32_bf16 v[60:63], v[132:135], a[204:207], v[60:63]
  ds_write_b64 v24, v[36:37] offset:32768
  v_mfma_f32_16x16x32_bf16 v[64:67], v[112:115], a[148:151], v[64:67]
  buffer_load_dwordx4 v[100:103], v87, s[12:15], s56 offen offset:3072 sc1
  v_fmaak_f32 v31, v53, v53, 0x409d30fc
  v_add_f32 v30, 1.0, v30
  v_mfma_f32_16x16x32_bf16 v[64:67], v[116:119], a[160:163], v[64:67]
  v_rcp_f32 v30, v30
  v_mfma_f32_16x16x32_bf16 v[64:67], v[120:123], a[172:175], v[64:67]
  buffer_load_dwordx4 v3, s[12:15], s59 offen offset:1024 sc1 lds
  v_mul_f32 v31, v31, v53
  v_mul_f32 v30, v30, v52
  v_mfma_f32_16x16x32_bf16 v[64:67], v[124:127], a[184:187], v[64:67]
  v_exp_f32 v31, v31
  v_mfma_f32_16x16x32_bf16 v[64:67], v[128:131], a[196:199], v[64:67]
  buffer_load_dwordx4 v[104:107], v9, s[12:15], s56 offen offset:0 sc1
  v_fmaak_f32 v26, v54, v54, 0x409d30fc
  v_add_f32 v31, 1.0, v31
  v_mfma_f32_16x16x32_bf16 v[64:67], v[132:135], a[208:211], v[64:67]
  v_rcp_f32 v31, v31
  v_mfma_f32_16x16x32_bf16 v[68:71], v[112:115], a[152:155], v[68:71]
  v_mul_f32 v26, v26, v54
  v_mul_f32 v31, v31, v53
  v_mfma_f32_16x16x32_bf16 v[68:71], v[116:119], a[164:167], v[68:71]
  v_exp_f32 v26, v26
  v_mfma_f32_16x16x32_bf16 v[68:71], v[120:123], a[176:179], v[68:71]
  buffer_load_dwordx4 v[108:111], v9, s[12:15], s56 offen offset:1024 sc1
  v_fmaak_f32 v27, v55, v55, 0x409d30fc
  v_add_f32 v26, 1.0, v26
  v_mfma_f32_16x16x32_bf16 v[68:71], v[124:127], a[188:191], v[68:71]
  v_rcp_f32 v26, v26
  v_mfma_f32_16x16x32_bf16 v[68:71], v[128:131], a[200:203], v[68:71]
  v_mul_f32 v27, v27, v55
  v_mul_f32 v26, v26, v54
  v_mfma_f32_16x16x32_bf16 v[68:71], v[132:135], a[212:215], v[68:71]
  v_exp_f32 v27, v27
  s_waitcnt vmcnt(14)
  v_mfma_f32_16x16x32_bf16 v[40:43], v[136:139], v[184:187], 0
  s_add_u32 s56, s84, 516096
  buffer_load_dwordx4 v[112:115], v3, s[12:15], s56 offen offset:0 sc1
  v_fmaak_f32 v28, v56, v56, 0x409d30fc
  v_add_f32 v27, 1.0, v27
  v_mfma_f32_16x16x32_bf16 v[40:43], v[140:143], v[188:191], v[40:43]
  v_rcp_f32 v27, v27
  v_mfma_f32_16x16x32_bf16 v[40:43], v[144:147], v[192:195], v[40:43]
  v_mul_f32 v28, v28, v56
  v_mul_f32 v27, v27, v55
  v_mfma_f32_16x16x32_bf16 v[40:43], v[148:151], v[196:199], v[40:43]
  v_exp_f32 v28, v28
  v_mfma_f32_16x16x32_bf16 v[40:43], v[152:155], v[200:203], v[40:43]
  buffer_load_dwordx4 v[116:119], v3, s[12:15], s56 offen offset:1024 sc1
  v_cvt_pk_bf16_f32 v38, v30, v31
  v_cvt_pk_bf16_f32 v39, v26, v27
  v_mfma_f32_16x16x32_bf16 v[40:43], v[156:159], v[204:207], v[40:43]
  ds_write_b64 v25, v[38:39] offset:32768
  v_mfma_f32_16x16x32_bf16 v[44:47], v[136:139], a[0:3], 0
  v_fmaak_f32 v29, v57, v57, 0x409d30fc
  v_add_f32 v28, 1.0, v28
  v_mfma_f32_16x16x32_bf16 v[44:47], v[140:143], a[12:15], v[44:47]
  v_rcp_f32 v28, v28
  v_mfma_f32_16x16x32_bf16 v[44:47], v[144:147], a[24:27], v[44:47]
  buffer_load_dwordx4 v[120:123], v3, s[12:15], s56 offen offset:2048 sc1
  v_mul_f32 v29, v29, v57
  v_mul_f32 v28, v28, v56
  v_mfma_f32_16x16x32_bf16 v[44:47], v[148:151], a[36:39], v[44:47]
  v_exp_f32 v29, v29
  v_mfma_f32_16x16x32_bf16 v[44:47], v[152:155], a[48:51], v[44:47]
  v_fmaak_f32 v30, v58, v58, 0x409d30fc
  v_add_f32 v29, 1.0, v29
  v_mfma_f32_16x16x32_bf16 v[44:47], v[156:159], a[60:63], v[44:47]
  v_rcp_f32 v29, v29
  v_mfma_f32_16x16x32_bf16 v[48:51], v[136:139], a[4:7], 0
  buffer_load_dwordx4 v[124:127], v3, s[12:15], s56 offen offset:3072 sc1
  v_mul_f32 v30, v30, v58
  v_mul_f32 v29, v29, v57
  v_mfma_f32_16x16x32_bf16 v[48:51], v[140:143], a[16:19], v[48:51]
  v_exp_f32 v30, v30
  v_mfma_f32_16x16x32_bf16 v[48:51], v[144:147], a[28:31], v[48:51]
  s_add_u32 m0, s93, 6144
  s_add_u32 s59, s89, 8192
  buffer_load_dwordx4 v3, s[12:15], s59 offen offset:0 sc1 lds
PAD_8:
  s_cbranch_execz WRET_1
  v_fmaak_f32 v31, v59, v59, 0x409d30fc
  v_add_f32 v30, 1.0, v30
  v_mfma_f32_16x16x32_bf16 v[48:51], v[148:151], a[40:43], v[48:51]
  v_rcp_f32 v30, v30
  v_mfma_f32_16x16x32_bf16 v[48:51], v[152:155], a[52:55], v[48:51]
  buffer_load_dwordx4 v[128:131], v85, s[12:15], s56 offen offset:0 sc1
  v_mul_f32 v31, v31, v59
  v_mul_f32 v30, v30, v58
  v_mfma_f32_16x16x32_bf16 v[48:51], v[156:159], a[64:67], v[48:51]
  v_exp_f32 v31, v31
  v_mfma_f32_16x16x32_bf16 v[52:55], v[136:139], a[8:11], 0
  v_fmaak_f32 v26, v60, v60, 0x409d30fc
  v_add_f32 v31, 1.0, v31
  v_mfma_f32_16x16x32_bf16 v[52:55], v[140:143], a[20:23], v[52:55]
  v_rcp_f32 v31, v31
  v_mfma_f32_16x16x32_bf16 v[52:55], v[144:147], a[32:35], v[52:55]
  buffer_load_dwordx4 v[132:135], v85, s[12:15], s56 offen offset:1024 sc1
  v_mul_f32 v26, v26, v60
  v_mul_f32 v31, v31, v59
  v_mfma_f32_16x16x32_bf16 v[52:55], v[148:151], a[44:47], v[52:55]
  v_exp_f32 v26, v26
  v_mfma_f32_16x16x32_bf16 v[52:55], v[152:155], a[56:59], v[52:55]
  v_cvt_pk_bf16_f32 v32, v28, v29
  v_cvt_pk_bf16_f32 v33, v30, v31
  v_mfma_f32_16x16x32_bf16 v[52:55], v[156:159], a[68:71], v[52:55]
  ds_write_b64 v22, v[32:33] offset:40960
  s_waitcnt vmcnt(14)
  v_mfma_f32_16x16x32_bf16 v[40:43], v[160:163], v[208:211], v[40:43]
  buffer_load_dwordx4 v[136:139], v85, s[12:15], s56 offen offset:2048 sc1
  v_fmaak_f32 v27, v61, v61, 0x409d30fc
  v_add_f32 v26, 1.0, v26
  v_mfma_f32_16x16x32_bf16 v[40:43], v[164:167], v[212:215], v[40:43]
  v_rcp_f32 v26, v26
  v_mfma_f32_16x16x32_bf16 v[40:43], v[168:171], v[216:219], v[40:43]
  v_mul_f32 v27, v27, v61
  v_mul_f32 v26, v26, v60
  v_mfma_f32_16x16x32_bf16 v[40:43], v[172:175], v[220:223], v[40:43]
  v_exp_f32 v27, v27
  v_mfma_f32_16x16x32_bf16 v[40:43], v[176:179], v[224:227], v[40:43]
  buffer_load_dwordx4 v[140:143], v85, s[12:15], s56 offen offset:3072 sc1
  v_fmaak_f32 v28, v62, v62, 0x409d30fc
  v_add_f32 v27, 1.0, v27
  v_mfma_f32_16x16x32_bf16 v[40:43], v[180:183], v[228:231], v[40:43]
  v_rcp_f32 v27, v27
  v_mfma_f32_16x16x32_bf16 v[44:47], v[160:163], a[72:75], v[44:47]
  v_mul_f32 v28, v28, v62
  v_mul_f32 v27, v27, v61
  v_mfma_f32_16x16x32_bf16 v[44:47], v[164:167], a[84:87], v[44:47]
  v_exp_f32 v28, v28
  v_mfma_f32_16x16x32_bf16 v[44:47], v[168:171], a[96:99], v[44:47]
  buffer_load_dwordx4 v[144:147], v86, s[12:15], s56 offen offset:0 sc1
  v_fmaak_f32 v29, v63, v63, 0x409d30fc
  v_add_f32 v28, 1.0, v28
  v_mfma_f32_16x16x32_bf16 v[44:47], v[172:175], a[108:111], v[44:47]
  v_rcp_f32 v28, v28
  v_mfma_f32_16x16x32_bf16 v[44:47], v[176:179], a[120:123], v[44:47]
  v_mul_f32 v29, v29, v63
  v_mul_f32 v28, v28, v62
  v_mfma_f32_16x16x32_bf16 v[44:47], v[180:183], a[132:135], v[44:47]
  v_exp_f32 v29, v29
  v_mfma_f32_16x16x32_bf16 v[48:51], v[160:163], a[76:79], v[48:51]
  buffer_load_dwordx4 v[148:151], v86, s[12:15], s56 offen offset:1024 sc1
  v_fmaak_f32 v30, v64, v64, 0x409d30fc
  v_add_f32 v29, 1.0, v29
  v_mfma_f32_16x16x32_bf16 v[48:51], v[164:167], a[88:91], v[48:51]
  v_rcp_f32 v29, v29
  v_mfma_f32_16x16x32_bf16 v[48:51], v[168:171], a[100:103], v[48:51]
  buffer_load_dwordx4 v3, s[12:15], s59 offen offset:1024 sc1 lds
  v_mul_f32 v30, v30, v64
  v_mul_f32 v29, v29, v63
  v_mfma_f32_16x16x32_bf16 v[48:51], v[172:175], a[112:115], v[48:51]
  v_exp_f32 v30, v30
  v_mfma_f32_16x16x32_bf16 v[48:51], v[176:179], a[124:127], v[48:51]
  buffer_load_dwordx4 v[152:155], v86, s[12:15], s56 offen offset:2048 sc1
  v_cvt_pk_bf16_f32 v34, v26, v27
  v_cvt_pk_bf16_f32 v35, v28, v29
  v_mfma_f32_16x16x32_bf16 v[48:51], v[180:183], a[136:139], v[48:51]
  ds_write_b64 v23, v[34:35] offset:40960
  v_mfma_f32_16x16x32_bf16 v[52:55], v[160:163], a[80:83], v[52:55]
  v_fmaak_f32 v31, v65, v65, 0x409d30fc
  v_add_f32 v30, 1.0, v30
  v_mfma_f32_16x16x32_bf16 v[52:55], v[164:167], a[92:95], v[52:55]
  v_rcp_f32 v30, v30
  v_mfma_f32_16x16x32_bf16 v[52:55], v[168:171], a[104:107], v[52:55]
  buffer_load_dwordx4 v[156:159], v86, s[12:15], s56 offen offset:3072 sc1
  v_mul_f32 v31, v31, v65
  v_mul_f32 v30, v30, v64
  v_mfma_f32_16x16x32_bf16 v[52:55], v[172:175], a[116:119], v[52:55]
  v_exp_f32 v31, v31
  v_mfma_f32_16x16x32_bf16 v[52:55], v[176:179], a[128:131], v[52:55]
  v_fmaak_f32 v26, v66, v66, 0x409d30fc
  v_add_f32 v31, 1.0, v31
  v_mfma_f32_16x16x32_bf16 v[52:55], v[180:183], a[140:143], v[52:55]
  v_rcp_f32 v31, v31
  s_waitcnt vmcnt(14)
  v_mfma_f32_16x16x32_bf16 v[40:43], v[88:91], v[232:235], v[40:43]
  buffer_load_dwordx4 v[160:163], v87, s[12:15], s56 offen offset:0 sc1
  v_mul_f32 v26, v26, v66
  v_mul_f32 v31, v31, v65
  v_mfma_f32_16x16x32_bf16 v[40:43], v[92:95], v[236:239], v[40:43]
  v_exp_f32 v26, v26
  v_mfma_f32_16x16x32_bf16 v[40:43], v[96:99], v[240:243], v[40:43]
  v_fmaak_f32 v27, v67, v67, 0x409d30fc
  v_add_f32 v26, 1.0, v26
  v_mfma_f32_16x16x32_bf16 v[40:43], v[100:103], v[244:247], v[40:43]
  v_rcp_f32 v26, v26
  v_mfma_f32_16x16x32_bf16 v[40:43], v[104:107], v[248:251], v[40:43]
  buffer_load_dwordx4 v[164:167], v87, s[12:15], s56 offen offset:1024 sc1
  v_mul_f32 v27, v27, v67
  v_mul_f32 v26, v26, v66
  v_mfma_f32_16x16x32_bf16 v[40:43], v[108:111], v[252:255], v[40:43]
  v_exp_f32 v27, v27
  v_mfma_f32_16x16x32_bf16 v[44:47], v[88:91], a[144:147], v[44:47]
  v_fmaak_f32 v28, v68, v68, 0x409d30fc
  v_add_f32 v27, 1.0, v27
  v_mfma_f32_16x16x32_bf16 v[44:47], v[92:95], a[156:159], v[44:47]
  v_rcp_f32 v27, v27
  v_mfma_f32_16x16x32_bf16 v[44:47], v[96:99], a[168:171], v[44:47]
  buffer_load_dwordx4 v[168:171], v87, s[12:15], s56 offen offset:2048 sc1
  v_mul_f32 v28, v28, v68
  v_mul_f32 v27, v27, v67
  v_mfma_f32_16x16x32_bf16 v[44:47], v[100:103], a[180:183], v[44:47]
  v_exp_f32 v28, v28
  v_mfma_f32_16x16x32_bf16 v[44:47], v[104:107], a[192:195], v[44:47]
  v_cvt_pk_bf16_f32 v36, v30, v31
  v_cvt_pk_bf16_f32 v37, v26, v27
  v_mfma_f32_16x16x32_bf16 v[44:47], v[108:111], a[204:207], v[44:47]
  ds_write_b64 v24, v[36:37] offset:40960
  v_mfma_f32_16x16x32_bf16 v[48:51], v[88:91], a[148:151], v[48:51]
  buffer_load_dwordx4 v[172:175], v87, s[12:15], s56 offen offset:3072 sc1
  v_fmaak_f32 v29, v69, v69, 0x409d30fc
  v_add_f32 v28, 1.0, v28
  v_mfma_f32_16x16x32_bf16 v[48:51], v[92:95], a[160:163], v[48:51]
  v_rcp_f32 v28, v28
  v_mfma_f32_16x16x32_bf16 v[48:51], v[96:99], a[172:175], v[48:51]
  s_add_u32 m0, s93, 8192
  s_add_u32 s59, s88, 8192
  buffer_load_dwordx4 v3, s[12:15], s59 offen offset:0 sc1 lds
  v_mul_f32 v29, v29, v69
  v_mul_f32 v28, v28, v68
  v_mfma_f32_16x16x32_bf16 v[48:51], v[100:103], a[184:187], v[48:51]
  v_exp_f32 v29, v29
  v_mfma_f32_16x16x32_bf16 v[48:51], v[104:107], a[196:199], v[48:51]
  buffer_load_dwordx4 v[176:179], v9, s[12:15], s56 offen offset:0 sc1
  v_fmaak_f32 v30, v70, v70, 0x409d30fc
  v_add_f32 v29, 1.0, v29
  v_mfma_f32_16x16x32_bf16 v[48:51], v[108:111], a[208:211], v[48:51]
  v_rcp_f32 v29, v29
  v_mfma_f32_16x16x32_bf16 v[52:55], v[88:91], a[152:155], v[52:55]
  v_mul_f32 v30, v30, v70
  v_mul_f32 v29, v29, v69
  v_mfma_f32_16x16x32_bf16 v[52:55], v[92:95], a[164:167], v[52:55]
  v_exp_f32 v30, v30
  v_mfma_f32_16x16x32_bf16 v[52:55], v[96:99], a[176:179], v[52:55]
  buffer_load_dwordx4 v[180:183], v9, s[12:15], s56 offen offset:1024 sc1
  v_fmaak_f32 v31, v71, v71, 0x409d30fc
  v_add_f32 v30, 1.0, v30
  v_mfma_f32_16x16x32_bf16 v[52:55], v[100:103], a[188:191], v[52:55]
  v_rcp_f32 v30, v30
  v_mfma_f32_16x16x32_bf16 v[52:55], v[104:107], a[200:203], v[52:55]
  v_mul_f32 v31, v31, v71
  v_mul_f32 v30, v30, v70
  v_mfma_f32_16x16x32_bf16 v[52:55], v[108:111], a[212:215], v[52:55]
  v_exp_f32 v31, v31
  s_waitcnt vmcnt(14)
  v_mfma_f32_16x16x32_bf16 v[56:59], v[112:115], v[184:187], 0
  s_add_u32 s56, s84, 589824
  buffer_load_dwordx4 v[88:91], v3, s[12:15], s56 offen offset:0 sc1
  v_fmaak_f32 v26, v40, v40, 0x409d30fc
  v_add_f32 v31, 1.0, v31
  v_mfma_f32_16x16x32_bf16 v[56:59], v[116:119], v[188:191], v[56:59]
  v_rcp_f32 v31, v31
  v_mfma_f32_16x16x32_bf16 v[56:59], v[120:123], v[192:195], v[56:59]
  v_mul_f32 v26, v26, v40
  v_mul_f32 v31, v31, v71
  v_mfma_f32_16x16x32_bf16 v[56:59], v[124:127], v[196:199], v[56:59]
  v_exp_f32 v26, v26
  v_mfma_f32_16x16x32_bf16 v[56:59], v[128:131], v[200:203], v[56:59]
  buffer_load_dwordx4 v[92:95], v3, s[12:15], s56 offen offset:1024 sc1
  v_cvt_pk_bf16_f32 v38, v28, v29
  v_cvt_pk_bf16_f32 v39, v30, v31
  v_mfma_f32_16x16x32_bf16 v[56:59], v[132:135], v[204:207], v[56:59]
  ds_write_b64 v25, v[38:39] offset:40960
  v_mfma_f32_16x16x32_bf16 v[60:63], v[112:115], a[0:3], 0
  v_fmaak_f32 v27, v41, v41, 0x409d30fc
  v_add_f32 v26, 1.0, v26
  v_mfma_f32_16x16x32_bf16 v[60:63], v[116:119], a[12:15], v[60:63]
  v_rcp_f32 v26, v26
  v_mfma_f32_16x16x32_bf16 v[60:63], v[120:123], a[24:27], v[60:63]
  buffer_load_dwordx4 v[96:99], v3, s[12:15], s56 offen offset:2048 sc1
  v_mul_f32 v27, v27, v41
  v_mul_f32 v26, v26, v40
  v_mfma_f32_16x16x32_bf16 v[60:63], v[124:127], a[36:39], v[60:63]
  v_exp_f32 v27, v27
  v_mfma_f32_16x16x32_bf16 v[60:63], v[128:131], a[48:51], v[60:63]
  v_fmaak_f32 v28, v42, v42, 0x409d30fc
  v_add_f32 v27, 1.0, v27
  v_mfma_f32_16x16x32_bf16 v[60:63], v[132:135], a[60:63], v[60:63]
  v_rcp_f32 v27, v27
  v_mfma_f32_16x16x32_bf16 v[64:67], v[112:115], a[4:7], 0
  buffer_load_dwordx4 v[100:103], v3, s[12:15], s56 offen offset:3072 sc1
  v_mul_f32 v28, v28, v42
  v_mul_f32 v27, v27, v41
  v_mfma_f32_16x16x32_bf16 v[64:67], v[116:119], a[16:19], v[64:67]
  v_exp_f32 v28, v28
  v_mfma_f32_16x16x32_bf16 v[64:67], v[120:123], a[28:31], v[64:67]
  buffer_load_dwordx4 v3, s[12:15], s59 offen offset:1024 sc1 lds
  v_fmaak_f32 v29, v43, v43, 0x409d30fc
  v_add_f32 v28, 1.0, v28
  v_mfma_f32_16x16x32_bf16 v[64:67], v[124:127], a[40:43], v[64:67]
  v_rcp_f32 v28, v28
  v_mfma_f32_16x16x32_bf16 v[64:67], v[128:131], a[52:55], v[64:67]
  buffer_load_dwordx4 v[104:107], v85, s[12:15], s56 offen offset:0 sc1
  v_mul_f32 v29, v29, v43
  v_mul_f32 v28, v28, v42
  v_mfma_f32_16x16x32_bf16 v[64:67], v[132:135], a[64:67], v[64:67]
  v_exp_f32 v29, v29
  v_mfma_f32_16x16x32_bf16 v[68:71], v[112:115], a[8:11], 0
  v_fmaak_f32 v30, v44, v44, 0x409d30fc
  v_add_f32 v29, 1.0, v29
  v_mfma_f32_16x16x32_bf16 v[68:71], v[116:119], a[20:23], v[68:71]
  v_rcp_f32 v29, v29
  v_mfma_f32_16x16x32_bf16 v[68:71], v[120:123], a[32:35], v[68:71]
  buffer_load_dwordx4 v[108:111], v85, s[12:15], s56 offen offset:1024 sc1
  v_mul_f32 v30, v30, v44
  v_mul_f32 v29, v29, v43
  v_mfma_f32_16x16x32_bf16 v[68:71], v[124:127], a[44:47], v[68:71]
  v_exp_f32 v30, v30
  v_mfma_f32_16x16x32_bf16 v[68:71], v[128:131], a[56:59], v[68:71]
  v_cvt_pk_bf16_f32 v32, v26, v27
  v_cvt_pk_bf16_f32 v33, v28, v29
  v_mfma_f32_16x16x32_bf16 v[68:71], v[132:135], a[68:71], v[68:71]
  ds_write_b64 v22, v[32:33] offset:49152
  s_waitcnt vmcnt(14)
  v_mfma_f32_16x16x32_bf16 v[56:59], v[136:139], v[208:211], v[56:59]
  buffer_load_dwordx4 v[112:115], v85, s[12:15], s56 offen offset:2048 sc1
  v_fmaak_f32 v31, v45, v45, 0x409d30fc
  v_add_f32 v30, 1.0, v30
  v_mfma_f32_16x16x32_bf16 v[56:59], v[140:143], v[212:215], v[56:59]
  v_rcp_f32 v30, v30
  v_mfma_f32_16x16x32_bf16 v[56:59], v[144:147], v[216:219], v[56:59]
  v_mul_f32 v31, v31, v45
  v_mul_f32 v30, v30, v44
  v_mfma_f32_16x16x32_bf16 v[56:59], v[148:151], v[220:223], v[56:59]
  v_exp_f32 v31, v31
  v_mfma_f32_16x16x32_bf16 v[56:59], v[152:155], v[224:227], v[56:59]
  buffer_load_dwordx4 v[116:119], v85, s[12:15], s56 offen offset:3072 sc1
  v_fmaak_f32 v26, v46, v46, 0x409d30fc
  v_add_f32 v31, 1.0, v31
  v_mfma_f32_16x16x32_bf16 v[56:59], v[156:159], v[228:231], v[56:59]
  v_rcp_f32 v31, v31
  v_mfma_f32_16x16x32_bf16 v[60:63], v[136:139], a[72:75], v[60:63]
  v_mul_f32 v26, v26, v46
  v_mul_f32 v31, v31, v45
  v_mfma_f32_16x16x32_bf16 v[60:63], v[140:143], a[84:87], v[60:63]
  v_exp_f32 v26, v26
  v_mfma_f32_16x16x32_bf16 v[60:63], v[144:147], a[96:99], v[60:63]
  buffer_load_dwordx4 v[120:123], v86, s[12:15], s56 offen offset:0 sc1
  v_fmaak_f32 v27, v47, v47, 0x409d30fc
  v_add_f32 v26, 1.0, v26
  v_mfma_f32_16x16x32_bf16 v[60:63], v[148:151], a[108:111], v[60:63]
  v_rcp_f32 v26, v26
  v_mfma_f32_16x16x32_bf16 v[60:63], v[152:155], a[120:123], v[60:63]
  v_mul_f32 v27, v27, v47
  v_mul_f32 v26, v26, v46
  v_mfma_f32_16x16x32_bf16 v[60:63], v[156:159], a[132:135], v[60:63]
  v_exp_f32 v27, v27
  v_mfma_f32_16x16x32_bf16 v[64:67], v[136:139], a[76:79], v[64:67]
  buffer_load_dwordx4 v[124:127], v86, s[12:15], s56 offen offset:1024 sc1
  v_fmaak_f32 v28, v48, v48, 0x409d30fc
  v_add_f32 v27, 1.0, v27
  v_mfma_f32_16x16x32_bf16 v[64:67], v[140:143], a[88:91], v[64:67]
  v_rcp_f32 v27, v27
  v_mfma_f32_16x16x32_bf16 v[64:67], v[144:147], a[100:103], v[64:67]
  s_add_u32 m0, s93, 10240
  s_add_u32 s59, s87, 8192
  buffer_load_dwordx4 v3, s[12:15], s59 offen offset:0 sc1 lds
  v_mul_f32 v28, v28, v48
  v_mul_f32 v27, v27, v47
  v_mfma_f32_16x16x32_bf16 v[64:67], v[148:151], a[112:115], v[64:67]
  v_exp_f32 v28, v28
  v_mfma_f32_16x16x32_bf16 v[64:67], v[152:155], a[124:127], v[64:67]
  buffer_load_dwordx4 v[128:131], v86, s[12:15], s56 offen offset:2048 sc1
  v_cvt_pk_bf16_f32 v34, v30, v31
  v_cvt_pk_bf16_f32 v35, v26, v27
  v_mfma_f32_16x16x32_bf16 v[64:67], v[156:159], a[136:139], v[64:67]
  ds_write_b64 v23, v[34:35] offset:49152
  v_mfma_f32_16x16x32_bf16 v[68:71], v[136:139], a[80:83], v[68:71]
  v_fmaak_f32 v29, v49, v49, 0x409d30fc
  v_add_f32 v28, 1.0, v28
  v_mfma_f32_16x16x32_bf16 v[68:71], v[140:143], a[92:95], v[68:71]
  v_rcp_f32 v28, v28
  v_mfma_f32_16x16x32_bf16 v[68:71], v[144:147], a[104:107], v[68:71]
  buffer_load_dwordx4 v[132:135], v86, s[12:15], s56 offen offset:3072 sc1
  v_mul_f32 v29, v29, v49
  v_mul_f32 v28, v28, v48
  v_mfma_f32_16x16x32_bf16 v[68:71], v[148:151], a[116:119], v[68:71]
  v_exp_f32 v29, v29
  v_mfma_f32_16x16x32_bf16 v[68:71], v[152:155], a[128:131], v[68:71]
  v_fmaak_f32 v30, v50, v50, 0x409d30fc
  v_add_f32 v29, 1.0, v29
  v_mfma_f32_16x16x32_bf16 v[68:71], v[156:159], a[140:143], v[68:71]
  v_rcp_f32 v29, v29
  s_waitcnt vmcnt(14)
  v_mfma_f32_16x16x32_bf16 v[56:59], v[160:163], v[232:235], v[56:59]
  buffer_load_dwordx4 v[136:139], v87, s[12:15], s56 offen offset:0 sc1
  v_mul_f32 v30, v30, v50
  v_mul_f32 v29, v29, v49
  v_mfma_f32_16x16x32_bf16 v[56:59], v[164:167], v[236:239], v[56:59]
  v_exp_f32 v30, v30
  v_mfma_f32_16x16x32_bf16 v[56:59], v[168:171], v[240:243], v[56:59]
  v_fmaak_f32 v31, v51, v51, 0x409d30fc
  v_add_f32 v30, 1.0, v30
  v_mfma_f32_16x16x32_bf16 v[56:59], v[172:175], v[244:247], v[56:59]
  v_rcp_f32 v30, v30
  v_mfma_f32_16x16x32_bf16 v[56:59], v[176:179], v[248:251], v[56:59]
  buffer_load_dwordx4 v[140:143], v87, s[12:15], s56 offen offset:1024 sc1
  v_mul_f32 v31, v31, v51
  v_mul_f32 v30, v30, v50
  v_mfma_f32_16x16x32_bf16 v[56:59], v[180:183], v[252:255], v[56:59]
  v_exp_f32 v31, v31
  v_mfma_f32_16x16x32_bf16 v[60:63], v[160:163], a[144:147], v[60:63]
  v_fmaak_f32 v26, v52, v52, 0x409d30fc
  v_add_f32 v31, 1.0, v31
  v_mfma_f32_16x16x32_bf16 v[60:63], v[164:167], a[156:159], v[60:63]
  v_rcp_f32 v31, v31
  v_mfma_f32_16x16x32_bf16 v[60:63], v[168:171], a[168:171], v[60:63]
  buffer_load_dwordx4 v[144:147], v87, s[12:15], s56 offen offset:2048 sc1
  v_mul_f32 v26, v26, v52
  v_mul_f32 v31, v31, v51
  v_mfma_f32_16x16x32_bf16 v[60:63], v[172:175], a[180:183], v[60:63]
  v_exp_f32 v26, v26
  v_mfma_f32_16x16x32_bf16 v[60:63], v[176:179], a[192:195], v[60:63]
  v_cvt_pk_bf16_f32 v36, v28, v29
  v_cvt_pk_bf16_f32 v37, v30, v31
  v_mfma_f32_16x16x32_bf16 v[60:63], v[180:183], a[204:207], v[60:63]
  ds_write_b64 v24, v[36:37] offset:49152
  v_mfma_f32_16x16x32_bf16 v[64:67], v[160:163], a[148:151], v[64:67]
  buffer_load_dwordx4 v[148:151], v87, s[12:15], s56 offen offset:3072 sc1
  v_fmaak_f32 v27, v53, v53, 0x409d30fc
  v_add_f32 v26, 1.0, v26
  v_mfma_f32_16x16x32_bf16 v[64:67], v[164:167], a[160:163], v[64:67]
  v_rcp_f32 v26, v26
  v_mfma_f32_16x16x32_bf16 v[64:67], v[168:171], a[172:175], v[64:67]
  buffer_load_dwordx4 v3, s[12:15], s59 offen offset:1024 sc1 lds
  v_mul_f32 v27, v27, v53
  v_mul_f32 v26, v26, v52
  v_mfma_f32_16x16x32_bf16 v[64:67], v[172:175], a[184:187], v[64:67]
  v_exp_f32 v27, v27
  v_mfma_f32_16x16x32_bf16 v[64:67], v[176:179], a[196:199], v[64:67]
  buffer_load_dwordx4 v[152:155], v9, s[12:15], s56 offen offset:0 sc1
  v_fmaak_f32 v28, v54, v54, 0x409d30fc
  v_add_f32 v27, 1.0, v27
  v_mfma_f32_16x16x32_bf16 v[64:67], v[180:183], a[208:211], v[64:67]
  v_rcp_f32 v27, v27
  v_mfma_f32_16x16x32_bf16 v[68:71], v[160:163], a[152:155], v[68:71]
  v_mul_f32 v28, v28, v54
  v_mul_f32 v27, v27, v53
  v_mfma_f32_16x16x32_bf16 v[68:71], v[164:167], a[164:167], v[68:71]
  v_exp_f32 v28, v28
  v_mfma_f32_16x16x32_bf16 v[68:71], v[168:171], a[176:179], v[68:71]
  buffer_load_dwordx4 v[156:159], v9, s[12:15], s56 offen offset:1024 sc1
  v_fmaak_f32 v29, v55, v55, 0x409d30fc
  v_add_f32 v28, 1.0, v28
  v_mfma_f32_16x16x32_bf16 v[68:71], v[172:175], a[188:191], v[68:71]
  v_rcp_f32 v28, v28
  v_mfma_f32_16x16x32_bf16 v[68:71], v[176:179], a[200:203], v[68:71]
  v_mul_f32 v29, v29, v55
  v_mul_f32 v28, v28, v54
  v_mfma_f32_16x16x32_bf16 v[68:71], v[180:183], a[212:215], v[68:71]
  v_exp_f32 v29, v29
  s_waitcnt vmcnt(14)
  v_mfma_f32_16x16x32_bf16 v[40:43], v[88:91], v[184:187], 0
  s_add_u32 s56, s30, 688128
  buffer_load_dwordx4 v[160:163], v3, s[12:15], s56 offen offset:0 sc1
  v_fmaak_f32 v30, v56, v56, 0x409d30fc
  v_add_f32 v29, 1.0, v29
  v_mfma_f32_16x16x32_bf16 v[40:43], v[92:95], v[188:191], v[40:43]
  v_rcp_f32 v29, v29
  v_mfma_f32_16x16x32_bf16 v[40:43], v[96:99], v[192:195], v[40:43]
  v_mul_f32 v30, v30, v56
  v_mul_f32 v29, v29, v55
  v_mfma_f32_16x16x32_bf16 v[40:43], v[100:103], v[196:199], v[40:43]
  v_exp_f32 v30, v30
  v_mfma_f32_16x16x32_bf16 v[40:43], v[104:107], v[200:203], v[40:43]
  buffer_load_dwordx4 v[164:167], v3, s[12:15], s56 offen offset:1024 sc1
  v_cvt_pk_bf16_f32 v38, v26, v27
  v_cvt_pk_bf16_f32 v39, v28, v29
  v_mfma_f32_16x16x32_bf16 v[40:43], v[108:111], v[204:207], v[40:43]
  ds_write_b64 v25, v[38:39] offset:49152
  v_mfma_f32_16x16x32_bf16 v[44:47], v[88:91], a[0:3], 0
  v_fmaak_f32 v31, v57, v57, 0x409d30fc
  v_add_f32 v30, 1.0, v30
  v_mfma_f32_16x16x32_bf16 v[44:47], v[92:95], a[12:15], v[44:47]
  v_rcp_f32 v30, v30
  v_mfma_f32_16x16x32_bf16 v[44:47], v[96:99], a[24:27], v[44:47]
  buffer_load_dwordx4 v[168:171], v84, s[12:15], s56 offen offset:2048 sc1
  v_mul_f32 v31, v31, v57
  v_mul_f32 v30, v30, v56
  v_mfma_f32_16x16x32_bf16 v[44:47], v[100:103], a[36:39], v[44:47]
  v_exp_f32 v31, v31
  v_mfma_f32_16x16x32_bf16 v[44:47], v[104:107], a[48:51], v[44:47]
  v_fmaak_f32 v26, v58, v58, 0x409d30fc
  v_add_f32 v31, 1.0, v31
  v_mfma_f32_16x16x32_bf16 v[44:47], v[108:111], a[60:63], v[44:47]
  v_rcp_f32 v31, v31
  v_mfma_f32_16x16x32_bf16 v[48:51], v[88:91], a[4:7], 0
  buffer_load_dwordx4 v[172:175], v3, s[12:15], s56 offen offset:3072 sc1
  v_mul_f32 v26, v26, v58
  v_mul_f32 v31, v31, v57
  v_mfma_f32_16x16x32_bf16 v[48:51], v[92:95], a[16:19], v[48:51]
  v_exp_f32 v26, v26
  v_mfma_f32_16x16x32_bf16 v[48:51], v[96:99], a[28:31], v[48:51]
  s_add_u32 m0, s93, 12288
  s_add_u32 s59, s86, 8192
  buffer_load_dwordx4 v3, s[12:15], s59 offen offset:0 sc1 lds
  v_fmaak_f32 v27, v59, v59, 0x409d30fc
  v_add_f32 v26, 1.0, v26
  v_mfma_f32_16x16x32_bf16 v[48:51], v[100:103], a[40:43], v[48:51]
  v_rcp_f32 v26, v26
  v_mfma_f32_16x16x32_bf16 v[48:51], v[104:107], a[52:55], v[48:51]
  s_add_u32 s56, s56, 4096
  buffer_load_dwordx4 v[176:179], v3, s[12:15], s56 offen offset:0 sc1
  v_mul_f32 v27, v27, v59
  v_mul_f32 v26, v26, v58
  v_mfma_f32_16x16x32_bf16 v[48:51], v[108:111], a[64:67], v[48:51]
  v_exp_f32 v27, v27
  v_mfma_f32_16x16x32_bf16 v[52:55], v[88:91], a[8:11], 0
  v_fmaak_f32 v28, v60, v60, 0x409d30fc
  v_add_f32 v27, 1.0, v27
  v_mfma_f32_16x16x32_bf16 v[52:55], v[92:95], a[20:23], v[52:55]
  v_rcp_f32 v27, v27
  v_mfma_f32_16x16x32_bf16 v[52:55], v[96:99], a[32:35], v[52:55]
  buffer_load_dwordx4 v[180:183], v3, s[12:15], s56 offen offset:1024 sc1
  v_mul_f32 v28, v28, v60
  v_mul_f32 v27, v27, v59
  v_mfma_f32_16x16x32_bf16 v[52:55], v[100:103], a[44:47], v[52:55]
  v_exp_f32 v28, v28
  v_mfma_f32_16x16x32_bf16 v[52:55], v[104:107], a[56:59], v[52:55]
  v_cvt_pk_bf16_f32 v32, v30, v31
  v_cvt_pk_bf16_f32 v33, v26, v27
  v_mfma_f32_16x16x32_bf16 v[52:55], v[108:111], a[68:71], v[52:55]
  ds_write_b64 v22, v[32:33] offset:57344
  s_waitcnt vmcnt(14)
  v_mfma_f32_16x16x32_bf16 v[40:43], v[112:115], v[208:211], v[40:43]
  buffer_load_dwordx4 v[88:91], v3, s[12:15], s56 offen offset:2048 sc1
  v_fmaak_f32 v29, v61, v61, 0x409d30fc
  v_add_f32 v28, 1.0, v28
  v_mfma_f32_16x16x32_bf16 v[40:43], v[116:119], v[212:215], v[40:43]
  v_rcp_f32 v28, v28
  v_mfma_f32_16x16x32_bf16 v[40:43], v[120:123], v[216:219], v[40:43]
  v_mul_f32 v29, v29, v61
  v_mul_f32 v28, v28, v60
  v_mfma_f32_16x16x32_bf16 v[40:43], v[124:127], v[220:223], v[40:43]
  v_exp_f32 v29, v29
  v_mfma_f32_16x16x32_bf16 v[40:43], v[128:131], v[224:227], v[40:43]
  buffer_load_dwordx4 v[92:95], v3, s[12:15], s56 offen offset:3072 sc1
  v_fmaak_f32 v30, v62, v62, 0x409d30fc
  v_add_f32 v29, 1.0, v29
  v_mfma_f32_16x16x32_bf16 v[40:43], v[132:135], v[228:231], v[40:43]
  v_rcp_f32 v29, v29
  v_mfma_f32_16x16x32_bf16 v[44:47], v[112:115], a[72:75], v[44:47]
  v_mul_f32 v30, v30, v62
  v_mul_f32 v29, v29, v61
  v_mfma_f32_16x16x32_bf16 v[44:47], v[116:119], a[84:87], v[44:47]
  v_exp_f32 v30, v30
  v_mfma_f32_16x16x32_bf16 v[44:47], v[120:123], a[96:99], v[44:47]
  s_add_u32 s56, s56, 4096
  buffer_load_dwordx4 v[96:99], v3, s[12:15], s56 offen offset:0 sc1
  v_fmaak_f32 v31, v63, v63, 0x409d30fc
  v_add_f32 v30, 1.0, v30
  v_mfma_f32_16x16x32_bf16 v[44:47], v[124:127], a[108:111], v[44:47]
  v_rcp_f32 v30, v30
  v_mfma_f32_16x16x32_bf16 v[44:47], v[128:131], a[120:123], v[44:47]
  v_mul_f32 v31, v31, v63
  v_mul_f32 v30, v30, v62
  v_mfma_f32_16x16x32_bf16 v[44:47], v[132:135], a[132:135], v[44:47]
  v_exp_f32 v31, v31
  v_mfma_f32_16x16x32_bf16 v[48:51], v[112:115], a[76:79], v[48:51]
  buffer_load_dwordx4 v[100:103], v3, s[12:15], s56 offen offset:1024 sc1
  v_fmaak_f32 v26, v64, v64, 0x409d30fc
  v_add_f32 v31, 1.0, v31
  v_mfma_f32_16x16x32_bf16 v[48:51], v[116:119], a[88:91], v[48:51]
  v_rcp_f32 v31, v31
  v_mfma_f32_16x16x32_bf16 v[48:51], v[120:123], a[100:103], v[48:51]
  buffer_load_dwordx4 v3, s[12:15], s59 offen offset:1024 sc1 lds
  v_mul_f32 v26, v26, v64
  v_mul_f32 v31, v31, v63
  v_mfma_f32_16x16x32_bf16 v[48:51], v[124:127], a[112:115], v[48:51]
  v_exp_f32 v26, v26
  v_mfma_f32_16x16x32_bf16 v[48:51], v[128:131], a[124:127], v[48:51]
  buffer_load_dwordx4 v[104:107], v3, s[12:15], s56 offen offset:2048 sc1
  v_cvt_pk_bf16_f32 v34, v28, v29
  v_cvt_pk_bf16_f32 v35, v30, v31
  v_mfma_f32_16x16x32_bf16 v[48:51], v[132:135], a[136:139], v[48:51]
  ds_write_b64 v23, v[34:35] offset:57344
  v_mfma_f32_16x16x32_bf16 v[52:55], v[112:115], a[80:83], v[52:55]
  v_fmaak_f32 v27, v65, v65, 0x409d30fc
  v_add_f32 v26, 1.0, v26
  v_mfma_f32_16x16x32_bf16 v[52:55], v[116:119], a[92:95], v[52:55]
  v_rcp_f32 v26, v26
  v_mfma_f32_16x16x32_bf16 v[52:55], v[120:123], a[104:107], v[52:55]
  buffer_load_dwordx4 v[108:111], v3, s[12:15], s56 offen offset:3072 sc1
  v_mul_f32 v27, v27, v65
  v_mul_f32 v26, v26, v64
  v_mfma_f32_16x16x32_bf16 v[52:55], v[124:127], a[116:119], v[52:55]
  v_exp_f32 v27, v27
  v_mfma_f32_16x16x32_bf16 v[52:55], v[128:131], a[128:131], v[52:55]
  v_fmaak_f32 v28, v66, v66, 0x409d30fc
  v_add_f32 v27, 1.0, v27
  v_mfma_f32_16x16x32_bf16 v[52:55], v[132:135], a[140:143], v[52:55]
  v_rcp_f32 v27, v27
  s_waitcnt vmcnt(14)
  v_mfma_f32_16x16x32_bf16 v[40:43], v[136:139], v[232:235], v[40:43]
  s_add_u32 s56, s56, 4096
  buffer_load_dwordx4 v[112:115], v3, s[12:15], s56 offen offset:0 sc1
  v_mul_f32 v28, v28, v66
  v_mul_f32 v27, v27, v65
  v_mfma_f32_16x16x32_bf16 v[40:43], v[140:143], v[236:239], v[40:43]
  v_exp_f32 v28, v28
  v_mfma_f32_16x16x32_bf16 v[40:43], v[144:147], v[240:243], v[40:43]
  v_fmaak_f32 v29, v67, v67, 0x409d30fc
  v_add_f32 v28, 1.0, v28
  v_mfma_f32_16x16x32_bf16 v[40:43], v[148:151], v[244:247], v[40:43]
  v_rcp_f32 v28, v28
  v_mfma_f32_16x16x32_bf16 v[40:43], v[152:155], v[248:251], v[40:43]
  buffer_load_dwordx4 v[116:119], v3, s[12:15], s56 offen offset:1024 sc1
  v_mul_f32 v29, v29, v67
  v_mul_f32 v28, v28, v66
  v_mfma_f32_16x16x32_bf16 v[40:43], v[156:159], v[252:255], v[40:43]
  v_exp_f32 v29, v29
  v_mfma_f32_16x16x32_bf16 v[44:47], v[136:139], a[144:147], v[44:47]
  v_fmaak_f32 v30, v68, v68, 0x409d30fc
  v_add_f32 v29, 1.0, v29
  v_mfma_f32_16x16x32_bf16 v[44:47], v[140:143], a[156:159], v[44:47]
  v_rcp_f32 v29, v29
  v_mfma_f32_16x16x32_bf16 v[44:47], v[144:147], a[168:171], v[44:47]
  buffer_load_dwordx4 v[120:123], v3, s[12:15], s56 offen offset:2048 sc1
  v_mul_f32 v30, v30, v68
  v_mul_f32 v29, v29, v67
  v_mfma_f32_16x16x32_bf16 v[44:47], v[148:151], a[180:183], v[44:47]
  v_exp_f32 v30, v30
  v_mfma_f32_16x16x32_bf16 v[44:47], v[152:155], a[192:195], v[44:47]
  v_cvt_pk_bf16_f32 v36, v26, v27
  v_cvt_pk_bf16_f32 v37, v28, v29
  v_mfma_f32_16x16x32_bf16 v[44:47], v[156:159], a[204:207], v[44:47]
  ds_write_b64 v24, v[36:37] offset:57344
  v_mfma_f32_16x16x32_bf16 v[48:51], v[136:139], a[148:151], v[48:51]
  buffer_load_dwordx4 v[124:127], v3, s[12:15], s56 offen offset:3072 sc1
  v_fmaak_f32 v31, v69, v69, 0x409d30fc
  v_add_f32 v30, 1.0, v30
  v_mfma_f32_16x16x32_bf16 v[48:51], v[140:143], a[160:163], v[48:51]
  v_rcp_f32 v30, v30
  v_mfma_f32_16x16x32_bf16 v[48:51], v[144:147], a[172:175], v[48:51]
  v_mul_f32 v31, v31, v69
  v_mul_f32 v30, v30, v68
  v_mfma_f32_16x16x32_bf16 v[48:51], v[148:151], a[184:187], v[48:51]
  v_exp_f32 v31, v31
  v_mfma_f32_16x16x32_bf16 v[48:51], v[152:155], a[196:199], v[48:51]
  s_add_u32 s56, s56, 4096
  buffer_load_dwordx4 v[128:131], v3, s[12:15], s56 offen offset:0 sc1
  v_fmaak_f32 v26, v70, v70, 0x409d30fc
  v_add_f32 v31, 1.0, v31
  v_mfma_f32_16x16x32_bf16 v[48:51], v[156:159], a[208:211], v[48:51]
  v_rcp_f32 v31, v31
  v_mfma_f32_16x16x32_bf16 v[52:55], v[136:139], a[152:155], v[52:55]
  v_mul_f32 v26, v26, v70
  v_mul_f32 v31, v31, v69
  v_mfma_f32_16x16x32_bf16 v[52:55], v[140:143], a[164:167], v[52:55]
  v_exp_f32 v26, v26
  v_mfma_f32_16x16x32_bf16 v[52:55], v[144:147], a[176:179], v[52:55]
  buffer_load_dwordx4 v[132:135], v3, s[12:15], s56 offen offset:1024 sc1
  v_fmaak_f32 v27, v71, v71, 0x409d30fc
  v_add_f32 v26, 1.0, v26
  v_mfma_f32_16x16x32_bf16 v[52:55], v[148:151], a[188:191], v[52:55]
  v_rcp_f32 v26, v26
  v_mfma_f32_16x16x32_bf16 v[52:55], v[152:155], a[200:203], v[52:55]
  v_mul_f32 v27, v27, v71
  v_mul_f32 v26, v26, v70
  v_mfma_f32_16x16x32_bf16 v[52:55], v[156:159], a[212:215], v[52:55]
  v_exp_f32 v27, v27
  s_waitcnt lgkmcnt(0)
  s_barrier
  s_waitcnt vmcnt(19)
  v_mfma_f32_16x16x32_bf16 v[56:59], v[160:163], a[216:219], 0
  buffer_load_dwordx4 v[136:139], v3, s[12:15], s56 offen offset:2048 sc1
  v_fmaak_f32 v28, v40, v40, 0x409d30fc
  v_add_f32 v27, 1.0, v27
  v_mfma_f32_16x16x32_bf16 v[60:63], v[160:163], a[220:223], 0
  v_rcp_f32 v27, v27
  v_mfma_f32_16x16x32_bf16 v[64:67], v[160:163], a[224:227], 0
  buffer_load_dwordx4 v[140:143], v3, s[12:15], s56 offen offset:3072 sc1
  v_mul_f32 v28, v28, v40
  v_mul_f32 v27, v27, v71
  v_mfma_f32_16x16x32_bf16 v[68:71], v[160:163], a[228:231], 0
  v_exp_f32 v28, v28
  s_waitcnt vmcnt(20)
  v_mfma_f32_16x16x32_bf16 v[56:59], v[164:167], a[232:235], v[56:59]
  ds_read_b128 v[184:187], v14 offset:0
  s_add_u32 s56, s56, 4096
  buffer_load_dwordx4 v[144:147], v3, s[12:15], s56 offen offset:0 sc1
  v_cvt_pk_bf16_f32 v38, v30, v31
  v_cvt_pk_bf16_f32 v39, v26, v27
  v_mfma_f32_16x16x32_bf16 v[60:63], v[164:167], a[236:239], v[60:63]
  ds_read_b128 a[0:3], v15 offset:0
  ds_write_b64 v25, v[38:39] offset:57344
  v_mfma_f32_16x16x32_bf16 v[64:67], v[164:167], a[240:243], v[64:67]
  ds_read_b128 a[4:7], v16 offset:0
  v_fmaak_f32 v29, v41, v41, 0x409d30fc
  v_add_f32 v28, 1.0, v28
  v_rcp_f32 v28, v28
  v_mfma_f32_16x16x32_bf16 v[68:71], v[164:167], a[244:247], v[68:71]
  ds_read_b128 a[8:11], v17 offset:0
  v_mul_f32 v29, v29, v41
  v_mul_f32 v28, v28, v40
  v_exp_f32 v29, v29
  s_waitcnt vmcnt(20)
  v_mfma_f32_16x16x32_bf16 v[56:59], v[168:171], a[248:251], v[56:59]
  ds_read_b128 v[188:191], v14 offset:4096
  s_mov_b32 s56, s85
  buffer_load_dwordx4 v[148:151], v3, s[12:15], s56 offen offset:0 sc1
  v_fmaak_f32 v30, v42, v42, 0x409d30fc
  v_add_f32 v29, 1.0, v29
  v_rcp_f32 v29, v29
  v_mfma_f32_16x16x32_bf16 v[60:63], v[168:171], a[252:255], v[60:63]
  ds_read_b128 a[12:15], v15 offset:4096
  v_mul_f32 v30, v30, v42
  v_mul_f32 v29, v29, v41
  v_exp_f32 v30, v30
  v_mfma_f32_16x16x32_bf16 v[64:67], v[168:171], v[76:79], v[64:67]
  ds_read_b128 a[16:19], v16 offset:4096
  v_fmaak_f32 v31, v43, v43, 0x409d30fc
  v_add_f32 v30, 1.0, v30
  v_mfma_f32_16x16x32_bf16 v[68:71], v[168:171], v[80:83], v[68:71]
  ds_read_b128 a[20:23], v17 offset:4096
  v_rcp_f32 v30, v30
  v_mul_f32 v31, v31, v43
  v_mul_f32 v30, v30, v42
  s_waitcnt vmcnt(20) lgkmcnt(4)
  v_mfma_f32_16x16x32_bf16 v[56:59], v[172:175], v[184:187], v[56:59]
  ds_read_b128 v[192:195], v14 offset:8192
PAD_9:
  s_cbranch_execz WRET_2
  buffer_load_dwordx4 v[152:155], v3, s[12:15], s56 offen offset:1024 sc1
  v_exp_f32 v31, v31
  v_mfma_f32_16x16x32_bf16 v[60:63], v[172:175], a[0:3], v[60:63]
  ds_read_b128 a[24:27], v15 offset:8192
  v_fmaak_f32 v26, v44, v44, 0x409d30fc
  v_add_f32 v31, 1.0, v31
  v_rcp_f32 v31, v31
  v_mfma_f32_16x16x32_bf16 v[64:67], v[172:175], a[4:7], v[64:67]
  ds_read_b128 a[28:31], v16 offset:8192
  buffer_load_dwordx4 v[156:159], v84, s[12:15], s56 offen offset:2048 sc1
  v_mul_f32 v26, v26, v44
  v_mul_f32 v31, v31, v43
  v_mfma_f32_16x16x32_bf16 v[68:71], v[172:175], a[8:11], v[68:71]
  ds_read_b128 a[32:35], v17 offset:8192
  v_exp_f32 v26, v26
  v_cvt_pk_bf16_f32 v32, v28, v29
  v_cvt_pk_bf16_f32 v33, v30, v31
  v_add_u32 v22, 8192, v22
  s_waitcnt vmcnt(20) lgkmcnt(4)
  v_mfma_f32_16x16x32_bf16 v[56:59], v[176:179], v[188:191], v[56:59]
  ds_read_b128 v[196:199], v14 offset:12288
  buffer_load_dwordx4 v[160:163], v3, s[12:15], s56 offen offset:3072 sc1
  ds_write_b64 v22, v[32:33] offset:57344
  v_mfma_f32_16x16x32_bf16 v[60:63], v[176:179], a[12:15], v[60:63]
  ds_read_b128 a[36:39], v15 offset:12288
  v_fmaak_f32 v27, v45, v45, 0x409d30fc
  v_add_f32 v26, 1.0, v26
  v_rcp_f32 v26, v26
  v_mfma_f32_16x16x32_bf16 v[64:67], v[176:179], a[16:19], v[64:67]
  ds_read_b128 a[40:43], v16 offset:12288
  v_mul_f32 v27, v27, v45
  v_mul_f32 v26, v26, v44
  v_mfma_f32_16x16x32_bf16 v[68:71], v[176:179], a[20:23], v[68:71]
  ds_read_b128 a[44:47], v17 offset:12288
  v_exp_f32 v27, v27
  v_fmaak_f32 v28, v46, v46, 0x409d30fc
  v_add_f32 v27, 1.0, v27
  s_waitcnt vmcnt(20) lgkmcnt(5)
  v_mfma_f32_16x16x32_bf16 v[56:59], v[180:183], v[192:195], v[56:59]
  ds_read_b128 v[200:203], v14 offset:16384
  s_add_u32 s56, s56, 4096
  buffer_load_dwordx4 v[164:167], v3, s[12:15], s56 offen offset:0 sc1
  v_rcp_f32 v27, v27
  v_mfma_f32_16x16x32_bf16 v[60:63], v[180:183], a[24:27], v[60:63]
  ds_read_b128 a[48:51], v15 offset:16384
  v_mul_f32 v28, v28, v46
  v_mul_f32 v27, v27, v45
  v_exp_f32 v28, v28
  v_mfma_f32_16x16x32_bf16 v[64:67], v[180:183], a[28:31], v[64:67]
  ds_read_b128 a[52:55], v16 offset:16384
  v_fmaak_f32 v29, v47, v47, 0x409d30fc
  v_add_f32 v28, 1.0, v28
  v_mfma_f32_16x16x32_bf16 v[68:71], v[180:183], a[32:35], v[68:71]
  ds_read_b128 a[56:59], v17 offset:16384
  v_rcp_f32 v28, v28
  v_mul_f32 v29, v29, v47
  v_mul_f32 v28, v28, v46
  s_waitcnt vmcnt(20) lgkmcnt(4)
  v_mfma_f32_16x16x32_bf16 v[56:59], v[88:91], v[196:199], v[56:59]
  ds_read_b128 v[204:207], v14 offset:20480
  buffer_load_dwordx4 v[168:171], v3, s[12:15], s56 offen offset:1024 sc1
  v_exp_f32 v29, v29
  v_mfma_f32_16x16x32_bf16 v[60:63], v[88:91], a[36:39], v[60:63]
  ds_read_b128 a[60:63], v15 offset:20480
  v_fmaak_f32 v30, v48, v48, 0x409d30fc
  v_add_f32 v29, 1.0, v29
  v_rcp_f32 v29, v29
  v_mfma_f32_16x16x32_bf16 v[64:67], v[88:91], a[40:43], v[64:67]
  ds_read_b128 a[64:67], v16 offset:20480
  buffer_load_dwordx4 v[172:175], v3, s[12:15], s56 offen offset:2048 sc1
  v_mul_f32 v30, v30, v48
  v_mul_f32 v29, v29, v47
  v_mfma_f32_16x16x32_bf16 v[68:71], v[88:91], a[44:47], v[68:71]
  ds_read_b128 a[68:71], v17 offset:20480
  v_exp_f32 v30, v30
  v_cvt_pk_bf16_f32 v34, v26, v27
  v_cvt_pk_bf16_f32 v35, v28, v29
  v_add_u32 v23, 8192, v23
  s_waitcnt vmcnt(21) lgkmcnt(4)
  v_mfma_f32_16x16x32_bf16 v[56:59], v[92:95], v[200:203], v[56:59]
  ds_read_b128 v[208:211], v14 offset:24576
  buffer_load_dwordx4 v[176:179], v3, s[12:15], s56 offen offset:3072 sc1
  ds_write_b64 v23, v[34:35] offset:57344
  v_mfma_f32_16x16x32_bf16 v[60:63], v[92:95], a[48:51], v[60:63]
  ds_read_b128 a[72:75], v15 offset:24576
  v_fmaak_f32 v31, v49, v49, 0x409d30fc
  v_add_f32 v30, 1.0, v30
  v_rcp_f32 v30, v30
  v_mfma_f32_16x16x32_bf16 v[64:67], v[92:95], a[52:55], v[64:67]
  ds_read_b128 a[76:79], v16 offset:24576
  v_mul_f32 v31, v31, v49
  v_mul_f32 v30, v30, v48
  v_mfma_f32_16x16x32_bf16 v[68:71], v[92:95], a[56:59], v[68:71]
  ds_read_b128 a[80:83], v17 offset:24576
  v_exp_f32 v31, v31
  v_fmaak_f32 v26, v50, v50, 0x409d30fc
  v_add_f32 v31, 1.0, v31
  s_waitcnt vmcnt(21) lgkmcnt(5)
  v_mfma_f32_16x16x32_bf16 v[56:59], v[96:99], v[204:207], v[56:59]
  ds_read_b128 v[212:215], v14 offset:28672
  s_add_u32 s56, s56, 4096
  buffer_load_dwordx4 v[180:183], v3, s[12:15], s56 offen offset:0 sc1
  v_rcp_f32 v31, v31
  v_mfma_f32_16x16x32_bf16 v[60:63], v[96:99], a[60:63], v[60:63]
  ds_read_b128 a[84:87], v15 offset:28672
  v_mul_f32 v26, v26, v50
  v_mul_f32 v31, v31, v49
  v_exp_f32 v26, v26
  v_mfma_f32_16x16x32_bf16 v[64:67], v[96:99], a[64:67], v[64:67]
  ds_read_b128 a[88:91], v16 offset:28672
  v_fmaak_f32 v27, v51, v51, 0x409d30fc
  v_add_f32 v26, 1.0, v26
  v_mfma_f32_16x16x32_bf16 v[68:71], v[96:99], a[68:71], v[68:71]
  ds_read_b128 a[92:95], v17 offset:28672
  v_rcp_f32 v26, v26
  v_mul_f32 v27, v27, v51
  v_mul_f32 v26, v26, v50
  s_waitcnt vmcnt(21) lgkmcnt(4)
  v_mfma_f32_16x16x32_bf16 v[56:59], v[100:103], v[208:211], v[56:59]
  ds_read_b128 v[216:219], v14 offset:32768
  buffer_load_dwordx4 v[88:91], v3, s[12:15], s56 offen offset:1024 sc1
  v_exp_f32 v27, v27
  v_mfma_f32_16x16x32_bf16 v[60:63], v[100:103], a[72:75], v[60:63]
  ds_read_b128 a[96:99], v15 offset:32768
  v_fmaak_f32 v28, v52, v52, 0x409d30fc
  v_add_f32 v27, 1.0, v27
  v_rcp_f32 v27, v27
  v_mfma_f32_16x16x32_bf16 v[64:67], v[100:103], a[76:79], v[64:67]
  ds_read_b128 a[100:103], v16 offset:32768
  buffer_load_dwordx4 v[92:95], v3, s[12:15], s56 offen offset:2048 sc1
  v_mul_f32 v28, v28, v52
  v_mul_f32 v27, v27, v51
  v_mfma_f32_16x16x32_bf16 v[68:71], v[100:103], a[80:83], v[68:71]
  ds_read_b128 a[104:107], v17 offset:32768
  v_exp_f32 v28, v28
  v_cvt_pk_bf16_f32 v36, v30, v31
  v_cvt_pk_bf16_f32 v37, v26, v27
  v_add_u32 v24, 8192, v24
  s_waitcnt vmcnt(21) lgkmcnt(4)
  v_mfma_f32_16x16x32_bf16 v[56:59], v[104:107], v[212:215], v[56:59]
  ds_read_b128 v[220:223], v18 offset:0
  buffer_load_dwordx4 v[96:99], v3, s[12:15], s56 offen offset:3072 sc1
  ds_write_b64 v24, v[36:37] offset:57344
  v_mfma_f32_16x16x32_bf16 v[60:63], v[104:107], a[84:87], v[60:63]
  ds_read_b128 a[108:111], v19 offset:0
  v_fmaak_f32 v29, v53, v53, 0x409d30fc
  v_add_f32 v28, 1.0, v28
  v_mfma_f32_16x16x32_bf16 v[64:67], v[104:107], a[88:91], v[64:67]
  ds_read_b128 a[112:115], v20 offset:0
  v_rcp_f32 v28, v28
  v_mul_f32 v29, v29, v53
  v_mul_f32 v28, v28, v52
  v_mfma_f32_16x16x32_bf16 v[68:71], v[104:107], a[92:95], v[68:71]
  ds_read_b128 a[116:119], v21 offset:0
  v_exp_f32 v29, v29
  s_waitcnt vmcnt(21) lgkmcnt(5)
  v_mfma_f32_16x16x32_bf16 v[56:59], v[108:111], v[216:219], v[56:59]
  ds_read_b128 v[224:227], v18 offset:4096
  s_add_u32 s56, s56, 4096
  buffer_load_dwordx4 v[100:103], v3, s[12:15], s56 offen offset:0 sc1
  v_fmaak_f32 v30, v54, v54, 0x409d30fc
  v_add_f32 v29, 1.0, v29
  v_mfma_f32_16x16x32_bf16 v[60:63], v[108:111], a[96:99], v[60:63]
  ds_read_b128 a[120:123], v19 offset:4096
  v_rcp_f32 v29, v29
  v_mfma_f32_16x16x32_bf16 v[64:67], v[108:111], a[100:103], v[64:67]
  ds_read_b128 a[124:127], v20 offset:4096
  v_mul_f32 v30, v30, v54
  v_mul_f32 v29, v29, v53
  v_mfma_f32_16x16x32_bf16 v[68:71], v[108:111], a[104:107], v[68:71]
  ds_read_b128 a[128:131], v21 offset:4096
  v_exp_f32 v30, v30
  s_waitcnt vmcnt(21) lgkmcnt(4)
  v_mfma_f32_16x16x32_bf16 v[56:59], v[112:115], v[220:223], v[56:59]
  ds_read_b128 v[228:231], v18 offset:8192
  buffer_load_dwordx4 v[104:107], v3, s[12:15], s56 offen offset:1024 sc1
  v_fmaak_f32 v31, v55, v55, 0x409d30fc
  v_add_f32 v30, 1.0, v30
  v_mfma_f32_16x16x32_bf16 v[60:63], v[112:115], a[108:111], v[60:63]
  ds_read_b128 a[132:135], v19 offset:8192
  v_rcp_f32 v30, v30
  v_mfma_f32_16x16x32_bf16 v[64:67], v[112:115], a[112:115], v[64:67]
  ds_read_b128 a[136:139], v20 offset:8192
  v_mul_f32 v31, v31, v55
  v_mul_f32 v30, v30, v54
  v_mfma_f32_16x16x32_bf16 v[68:71], v[112:115], a[116:119], v[68:71]
  ds_read_b128 a[140:143], v21 offset:8192
  v_exp_f32 v31, v31
  s_waitcnt vmcnt(21) lgkmcnt(4)
  v_mfma_f32_16x16x32_bf16 v[56:59], v[116:119], v[224:227], v[56:59]
  ds_read_b128 v[232:235], v18 offset:12288
  buffer_load_dwordx4 v[108:111], v3, s[12:15], s56 offen offset:2048 sc1
  v_add_f32 v31, 1.0, v31
  v_mfma_f32_16x16x32_bf16 v[60:63], v[116:119], a[120:123], v[60:63]
  ds_read_b128 a[144:147], v19 offset:12288
  v_rcp_f32 v31, v31
  v_mfma_f32_16x16x32_bf16 v[64:67], v[116:119], a[124:127], v[64:67]
  ds_read_b128 a[148:151], v20 offset:12288
  v_mul_f32 v31, v31, v55
  v_mfma_f32_16x16x32_bf16 v[68:71], v[116:119], a[128:131], v[68:71]
  ds_read_b128 a[152:155], v21 offset:12288
  v_cvt_pk_bf16_f32 v38, v28, v29
  v_cvt_pk_bf16_f32 v39, v30, v31
  v_add_u32 v25, 8192, v25
  s_waitcnt vmcnt(21) lgkmcnt(4)
  v_mfma_f32_16x16x32_bf16 v[56:59], v[120:123], v[228:231], v[56:59]
  ds_read_b128 v[236:239], v18 offset:16384
  buffer_load_dwordx4 v[112:115], v3, s[12:15], s56 offen offset:3072 sc1
  ds_write_b64 v25, v[38:39] offset:57344
  v_mfma_f32_16x16x32_bf16 v[60:63], v[120:123], a[132:135], v[60:63]
  ds_read_b128 a[156:159], v19 offset:16384
  v_mfma_f32_16x16x32_bf16 v[64:67], v[120:123], a[136:139], v[64:67]
  ds_read_b128 a[160:163], v20 offset:16384
  s_waitcnt lgkmcnt(0)
  s_barrier
  v_mfma_f32_16x16x32_bf16 v[68:71], v[120:123], a[140:143], v[68:71]
  ds_read_b128 a[164:167], v21 offset:16384
  s_waitcnt vmcnt(21)
  v_mfma_f32_16x16x32_bf16 v[56:59], v[124:127], v[232:235], v[56:59]
  ds_read_b128 v[240:243], v18 offset:20480
  s_add_u32 s56, s56, 4096
  buffer_load_dwordx4 v[116:119], v3, s[12:15], s56 offen offset:0 sc1
  v_mfma_f32_16x16x32_bf16 v[60:63], v[124:127], a[144:147], v[60:63]
  ds_read_b128 a[168:171], v19 offset:20480
  v_mfma_f32_16x16x32_bf16 v[64:67], v[124:127], a[148:151], v[64:67]
  ds_read_b128 a[172:175], v20 offset:20480
  v_mfma_f32_16x16x32_bf16 v[68:71], v[124:127], a[152:155], v[68:71]
  ds_read_b128 a[176:179], v21 offset:20480
  s_waitcnt vmcnt(21) lgkmcnt(4)
  v_mfma_f32_16x16x32_bf16 v[56:59], v[128:131], v[236:239], v[56:59]
  ds_read_b128 v[244:247], v18 offset:24576
  buffer_load_dwordx4 v[120:123], v3, s[12:15], s56 offen offset:1024 sc1
  v_mfma_f32_16x16x32_bf16 v[60:63], v[128:131], a[156:159], v[60:63]
  ds_read_b128 a[180:183], v19 offset:24576
  v_mfma_f32_16x16x32_bf16 v[64:67], v[128:131], a[160:163], v[64:67]
  ds_read_b128 a[184:187], v20 offset:24576
  v_mfma_f32_16x16x32_bf16 v[68:71], v[128:131], a[164:167], v[68:71]
  ds_read_b128 a[188:191], v21 offset:24576
  s_waitcnt vmcnt(21) lgkmcnt(4)
  v_mfma_f32_16x16x32_bf16 v[56:59], v[132:135], v[240:243], v[56:59]
  ds_read_b128 v[248:251], v18 offset:28672
  buffer_load_dwordx4 v[124:127], v3, s[12:15], s56 offen offset:2048 sc1
  v_mfma_f32_16x16x32_bf16 v[60:63], v[132:135], a[168:171], v[60:63]
  ds_read_b128 a[192:195], v19 offset:28672
  v_mfma_f32_16x16x32_bf16 v[64:67], v[132:135], a[172:175], v[64:67]
  ds_read_b128 a[196:199], v20 offset:28672
  v_mfma_f32_16x16x32_bf16 v[68:71], v[132:135], a[176:179], v[68:71]
  ds_read_b128 a[200:203], v21 offset:28672
  s_waitcnt vmcnt(21) lgkmcnt(4)
  v_mfma_f32_16x16x32_bf16 v[56:59], v[136:139], v[244:247], v[56:59]
  ds_read_b128 v[252:255], v18 offset:32768
  buffer_load_dwordx4 v[128:131], v3, s[12:15], s56 offen offset:3072 sc1
  v_mfma_f32_16x16x32_bf16 v[60:63], v[136:139], a[180:183], v[60:63]
  ds_read_b128 a[204:207], v19 offset:32768
  v_mfma_f32_16x16x32_bf16 v[64:67], v[136:139], a[184:187], v[64:67]
  ds_read_b128 a[208:211], v20 offset:32768
  v_mfma_f32_16x16x32_bf16 v[68:71], v[136:139], a[188:191], v[68:71]
  ds_read_b128 a[212:215], v21 offset:32768
  s_waitcnt vmcnt(21) lgkmcnt(4)
  v_mfma_f32_16x16x32_bf16 v[56:59], v[140:143], v[248:251], v[56:59]
  s_add_u32 s56, s56, 4096
  buffer_load_dwordx4 v[132:135], v3, s[12:15], s56 offen offset:0 sc1
  v_mfma_f32_16x16x32_bf16 v[60:63], v[140:143], a[192:195], v[60:63]
  v_mfma_f32_16x16x32_bf16 v[64:67], v[140:143], a[196:199], v[64:67]
  v_mfma_f32_16x16x32_bf16 v[68:71], v[140:143], a[200:203], v[68:71]
  s_waitcnt vmcnt(21) lgkmcnt(0)
  v_mfma_f32_16x16x32_bf16 v[56:59], v[144:147], v[252:255], v[56:59]
  s_mov_b32 s56, s86
  buffer_load_dwordx4 v[136:139], v3, s[12:15], s56 offen offset:0 sc1
  v_mfma_f32_16x16x32_bf16 v[60:63], v[144:147], a[204:207], v[60:63]
  v_mfma_f32_16x16x32_bf16 v[64:67], v[144:147], a[208:211], v[64:67]
  v_mfma_f32_16x16x32_bf16 v[68:71], v[144:147], a[212:215], v[68:71]
  s_waitcnt vmcnt(19)
  v_mfma_f32_16x16x32_bf16 v[40:43], v[148:151], a[216:219], 0
  buffer_load_dwordx4 v[140:143], v3, s[12:15], s56 offen offset:1024 sc1
  s_add_u32 s59, s35, 524288
  v_mfma_f32_16x16x32_bf16 v[40:43], v[152:155], a[232:235], v[40:43]
  v_cvt_pk_bf16_f32 v32, v56, v57
  v_cvt_pk_bf16_f32 v33, v58, v59
  v_mfma_f32_16x16x32_bf16 v[40:43], v[156:159], a[248:251], v[40:43]
  v_cvt_pk_bf16_f32 v34, v60, v61
  v_cvt_pk_bf16_f32 v35, v62, v63
  v_mfma_f32_16x16x32_bf16 v[44:47], v[148:151], a[220:223], 0
  v_mfma_f32_16x16x32_bf16 v[44:47], v[152:155], a[236:239], v[44:47]
  buffer_load_dwordx4 v[144:147], v84, s[12:15], s56 offen offset:2048 sc1
  v_permlane16_swap_b32 v32, v34
  v_permlane16_swap_b32 v33, v35
  v_mfma_f32_16x16x32_bf16 v[44:47], v[156:159], a[252:255], v[44:47]
  buffer_store_dwordx4 v[32:35], v3, s[12:15], s59 offen offset:0 sc1
  v_mfma_f32_16x16x32_bf16 v[48:51], v[148:151], a[224:227], 0
  v_cvt_pk_bf16_f32 v36, v64, v65
  v_cvt_pk_bf16_f32 v37, v66, v67
  v_mfma_f32_16x16x32_bf16 v[48:51], v[152:155], a[240:243], v[48:51]
  v_cvt_pk_bf16_f32 v38, v68, v69
  v_cvt_pk_bf16_f32 v39, v70, v71
  v_mfma_f32_16x16x32_bf16 v[48:51], v[156:159], v[76:79], v[48:51]
  v_mfma_f32_16x16x32_bf16 v[52:55], v[148:151], a[228:231], 0
  v_permlane16_swap_b32 v36, v38
  v_permlane16_swap_b32 v37, v39
  v_mfma_f32_16x16x32_bf16 v[52:55], v[152:155], a[244:247], v[52:55]
  buffer_store_dwordx4 v[36:39], v3, s[12:15], s59 offen offset:1024 sc1
  v_mfma_f32_16x16x32_bf16 v[52:55], v[156:159], v[80:83], v[52:55]
  s_waitcnt vmcnt(20)
  v_mfma_f32_16x16x32_bf16 v[40:43], v[160:163], v[184:187], v[40:43]
  buffer_load_dwordx4 v[148:151], v3, s[12:15], s56 offen offset:3072 sc1
  v_mfma_f32_16x16x32_bf16 v[40:43], v[164:167], v[188:191], v[40:43]
  v_mfma_f32_16x16x32_bf16 v[40:43], v[168:171], v[192:195], v[40:43]
  v_mfma_f32_16x16x32_bf16 v[44:47], v[160:163], a[0:3], v[44:47]
  v_mfma_f32_16x16x32_bf16 v[44:47], v[164:167], a[12:15], v[44:47]
  s_add_u32 s56, s56, 4096
  buffer_load_dwordx4 v[152:155], v3, s[12:15], s56 offen offset:0 sc1
  v_mfma_f32_16x16x32_bf16 v[44:47], v[168:171], a[24:27], v[44:47]
  v_mfma_f32_16x16x32_bf16 v[48:51], v[160:163], a[4:7], v[48:51]
  s_barrier
  v_mfma_f32_16x16x32_bf16 v[48:51], v[164:167], a[16:19], v[48:51]
  v_mfma_f32_16x16x32_bf16 v[48:51], v[168:171], a[28:31], v[48:51]
  buffer_load_dwordx4 v[156:159], v3, s[12:15], s56 offen offset:1024 sc1
  v_mfma_f32_16x16x32_bf16 v[52:55], v[160:163], a[8:11], v[52:55]
  v_mfma_f32_16x16x32_bf16 v[52:55], v[164:167], a[20:23], v[52:55]
  v_mfma_f32_16x16x32_bf16 v[52:55], v[168:171], a[32:35], v[52:55]
  s_waitcnt vmcnt(20)
  v_mfma_f32_16x16x32_bf16 v[40:43], v[172:175], v[196:199], v[40:43]
  buffer_load_dwordx4 v[160:163], v3, s[12:15], s56 offen offset:2048 sc1
  v_mfma_f32_16x16x32_bf16 v[40:43], v[176:179], v[200:203], v[40:43]
  v_mfma_f32_16x16x32_bf16 v[40:43], v[180:183], v[204:207], v[40:43]
  v_mfma_f32_16x16x32_bf16 v[44:47], v[172:175], a[36:39], v[44:47]
  v_mfma_f32_16x16x32_bf16 v[44:47], v[176:179], a[48:51], v[44:47]
  buffer_load_dwordx4 v[164:167], v3, s[12:15], s56 offen offset:3072 sc1
  v_mfma_f32_16x16x32_bf16 v[44:47], v[180:183], a[60:63], v[44:47]
  v_mfma_f32_16x16x32_bf16 v[48:51], v[172:175], a[40:43], v[48:51]
  v_mfma_f32_16x16x32_bf16 v[48:51], v[176:179], a[52:55], v[48:51]
  v_mfma_f32_16x16x32_bf16 v[48:51], v[180:183], a[64:67], v[48:51]
  s_add_u32 s56, s56, 4096
  ds_read_b128 v[168:171], v7 offset:12288
  v_mfma_f32_16x16x32_bf16 v[52:55], v[172:175], a[44:47], v[52:55]
  v_mfma_f32_16x16x32_bf16 v[52:55], v[176:179], a[56:59], v[52:55]
  v_mfma_f32_16x16x32_bf16 v[52:55], v[180:183], a[68:71], v[52:55]
  s_waitcnt vmcnt(19)
  v_mfma_f32_16x16x32_bf16 v[40:43], v[88:91], v[208:211], v[40:43]
  ds_read_b128 v[172:175], v7 offset:13312
  v_mfma_f32_16x16x32_bf16 v[40:43], v[92:95], v[212:215], v[40:43]
  v_mfma_f32_16x16x32_bf16 v[40:43], v[96:99], v[216:219], v[40:43]
  v_mfma_f32_16x16x32_bf16 v[44:47], v[88:91], a[72:75], v[44:47]
  v_mfma_f32_16x16x32_bf16 v[44:47], v[92:95], a[84:87], v[44:47]
  buffer_load_dwordx4 v[176:179], v3, s[12:15], s56 offen offset:2048 sc1
  v_mfma_f32_16x16x32_bf16 v[44:47], v[96:99], a[96:99], v[44:47]
  v_mfma_f32_16x16x32_bf16 v[48:51], v[88:91], a[76:79], v[48:51]
  v_mfma_f32_16x16x32_bf16 v[48:51], v[92:95], a[88:91], v[48:51]
  v_mfma_f32_16x16x32_bf16 v[48:51], v[96:99], a[100:103], v[48:51]
  buffer_load_dwordx4 v[180:183], v3, s[12:15], s56 offen offset:3072 sc1
  v_mfma_f32_16x16x32_bf16 v[52:55], v[88:91], a[80:83], v[52:55]
  v_mfma_f32_16x16x32_bf16 v[52:55], v[92:95], a[92:95], v[52:55]
  v_mfma_f32_16x16x32_bf16 v[52:55], v[96:99], a[104:107], v[52:55]
  s_waitcnt vmcnt(18)
  v_mfma_f32_16x16x32_bf16 v[40:43], v[100:103], v[220:223], v[40:43]
  s_add_u32 s56, s56, 4096
  buffer_load_dwordx4 v[88:91], v3, s[12:15], s56 offen offset:0 sc1
  v_mfma_f32_16x16x32_bf16 v[40:43], v[104:107], v[224:227], v[40:43]
  v_mfma_f32_16x16x32_bf16 v[40:43], v[108:111], v[228:231], v[40:43]
  v_mfma_f32_16x16x32_bf16 v[44:47], v[100:103], a[108:111], v[44:47]
  v_mfma_f32_16x16x32_bf16 v[44:47], v[104:107], a[120:123], v[44:47]
  buffer_load_dwordx4 v[92:95], v3, s[12:15], s56 offen offset:1024 sc1
  v_mfma_f32_16x16x32_bf16 v[44:47], v[108:111], a[132:135], v[44:47]
  v_mfma_f32_16x16x32_bf16 v[48:51], v[100:103], a[112:115], v[48:51]
  v_mfma_f32_16x16x32_bf16 v[48:51], v[104:107], a[124:127], v[48:51]
  v_mfma_f32_16x16x32_bf16 v[48:51], v[108:111], a[136:139], v[48:51]
  buffer_load_dwordx4 v[96:99], v3, s[12:15], s56 offen offset:2048 sc1
  v_mfma_f32_16x16x32_bf16 v[52:55], v[100:103], a[116:119], v[52:55]
  v_mfma_f32_16x16x32_bf16 v[52:55], v[104:107], a[128:131], v[52:55]
  v_mfma_f32_16x16x32_bf16 v[52:55], v[108:111], a[140:143], v[52:55]
  s_waitcnt vmcnt(18)
  v_mfma_f32_16x16x32_bf16 v[40:43], v[112:115], v[232:235], v[40:43]
  buffer_load_dwordx4 v[100:103], v3, s[12:15], s56 offen offset:3072 sc1
  v_mfma_f32_16x16x32_bf16 v[40:43], v[116:119], v[236:239], v[40:43]
  v_mfma_f32_16x16x32_bf16 v[40:43], v[120:123], v[240:243], v[40:43]
  v_mfma_f32_16x16x32_bf16 v[44:47], v[112:115], a[144:147], v[44:47]
  v_mfma_f32_16x16x32_bf16 v[44:47], v[116:119], a[156:159], v[44:47]
  s_add_u32 s56, s56, 4096
  buffer_load_dwordx4 v[104:107], v3, s[12:15], s56 offen offset:0 sc1
  v_mfma_f32_16x16x32_bf16 v[44:47], v[120:123], a[168:171], v[44:47]
  v_mfma_f32_16x16x32_bf16 v[48:51], v[112:115], a[148:151], v[48:51]
  v_mfma_f32_16x16x32_bf16 v[48:51], v[116:119], a[160:163], v[48:51]
  v_mfma_f32_16x16x32_bf16 v[48:51], v[120:123], a[172:175], v[48:51]
  buffer_load_dwordx4 v[108:111], v3, s[12:15], s56 offen offset:1024 sc1
  v_mfma_f32_16x16x32_bf16 v[52:55], v[112:115], a[152:155], v[52:55]
  v_mfma_f32_16x16x32_bf16 v[52:55], v[116:119], a[164:167], v[52:55]
  v_mfma_f32_16x16x32_bf16 v[52:55], v[120:123], a[176:179], v[52:55]
  s_waitcnt vmcnt(18)
  v_mfma_f32_16x16x32_bf16 v[40:43], v[124:127], v[244:247], v[40:43]
  buffer_load_dwordx4 v[112:115], v3, s[12:15], s56 offen offset:2048 sc1
  v_mfma_f32_16x16x32_bf16 v[40:43], v[128:131], v[248:251], v[40:43]
  v_mfma_f32_16x16x32_bf16 v[40:43], v[132:135], v[252:255], v[40:43]
  v_mfma_f32_16x16x32_bf16 v[44:47], v[124:127], a[180:183], v[44:47]
  v_mfma_f32_16x16x32_bf16 v[44:47], v[128:131], a[192:195], v[44:47]
  buffer_load_dwordx4 v[116:119], v3, s[12:15], s56 offen offset:3072 sc1
  v_mfma_f32_16x16x32_bf16 v[44:47], v[132:135], a[204:207], v[44:47]
  v_mfma_f32_16x16x32_bf16 v[48:51], v[124:127], a[184:187], v[48:51]
  v_mfma_f32_16x16x32_bf16 v[48:51], v[128:131], a[196:199], v[48:51]
  v_mfma_f32_16x16x32_bf16 v[48:51], v[132:135], a[208:211], v[48:51]
  s_add_u32 s56, s56, 4096
  buffer_load_dwordx4 v[120:123], v3, s[12:15], s56 offen offset:0 sc1
  v_mfma_f32_16x16x32_bf16 v[52:55], v[124:127], a[188:191], v[52:55]
  v_mfma_f32_16x16x32_bf16 v[52:55], v[128:131], a[200:203], v[52:55]
  v_mfma_f32_16x16x32_bf16 v[52:55], v[132:135], a[212:215], v[52:55]
  s_waitcnt vmcnt(18)
  v_mfma_f32_16x16x32_bf16 v[56:59], v[136:139], a[216:219], 0
  s_mov_b32 s56, s87
  buffer_load_dwordx4 v[124:127], v3, s[12:15], s56 offen offset:0 sc1
  s_add_u32 s59, s29, 1
  s_and_b32 s59, s59, 7
  s_lshl_b32 s59, s59, 16
  s_add_u32 s59, s59, s35
  v_mfma_f32_16x16x32_bf16 v[56:59], v[140:143], a[232:235], v[56:59]
  v_cvt_pk_bf16_f32 v32, v40, v41
  v_cvt_pk_bf16_f32 v33, v42, v43
  v_mfma_f32_16x16x32_bf16 v[56:59], v[144:147], a[248:251], v[56:59]
  s_barrier
  v_cvt_pk_bf16_f32 v34, v44, v45
  v_cvt_pk_bf16_f32 v35, v46, v47
  v_mfma_f32_16x16x32_bf16 v[60:63], v[136:139], a[220:223], 0
  buffer_store_dwordx4 v[32:35], v3, s[12:15], s59 offen offset:0 sc1
  v_mfma_f32_16x16x32_bf16 v[60:63], v[140:143], a[236:239], v[60:63]
  buffer_load_dwordx4 v[128:131], v3, s[12:15], s56 offen offset:1024 sc1
  v_cvt_pk_bf16_f32 v36, v48, v49
  v_cvt_pk_bf16_f32 v37, v50, v51
  v_mfma_f32_16x16x32_bf16 v[60:63], v[144:147], a[252:255], v[60:63]
  v_cvt_pk_bf16_f32 v38, v52, v53
  v_cvt_pk_bf16_f32 v39, v54, v55
  v_mfma_f32_16x16x32_bf16 v[64:67], v[136:139], a[224:227], 0
  buffer_store_dwordx4 v[36:39], v3, s[12:15], s59 offen offset:1024 sc1
  v_mfma_f32_16x16x32_bf16 v[64:67], v[140:143], a[240:243], v[64:67]
  s_sub_u32 s1, s25, 1
  s_and_b32 s1, s1, 7
  v_mfma_f32_16x16x32_bf16 v[64:67], v[144:147], v[76:79], v[64:67]
  buffer_load_dwordx4 v[132:135], v84, s[12:15], s56 offen offset:2048 sc1
  s_lshl_b32 s1, s1, 13
  s_add_u32 s73, s1, s66
  v_mfma_f32_16x16x32_bf16 v[68:71], v[136:139], a[228:231], 0
  s_sub_u32 s1, s25, 2
  s_and_b32 s1, s1, 7
  v_mfma_f32_16x16x32_bf16 v[68:71], v[140:143], a[244:247], v[68:71]
  s_lshl_b32 s1, s1, 13
  s_add_u32 s74, s1, s66
  v_mfma_f32_16x16x32_bf16 v[68:71], v[144:147], v[80:83], v[68:71]
  s_sub_u32 s1, s25, 3
  s_and_b32 s1, s1, 7
  s_waitcnt vmcnt(18)
  v_mfma_f32_16x16x32_bf16 v[56:59], v[148:151], v[184:187], v[56:59]
  buffer_load_dwordx4 v[136:139], v3, s[12:15], s56 offen offset:3072 sc1
  s_lshl_b32 s1, s1, 13
  s_add_u32 s75, s1, s66
  v_mfma_f32_16x16x32_bf16 v[56:59], v[152:155], v[188:191], v[56:59]
  s_sub_u32 s1, s25, 4
  s_and_b32 s1, s1, 7
  v_mfma_f32_16x16x32_bf16 v[56:59], v[156:159], v[192:195], v[56:59]
  s_lshl_b32 s1, s1, 13
  s_add_u32 s76, s1, s66
  v_mfma_f32_16x16x32_bf16 v[60:63], v[148:151], a[0:3], v[60:63]
  s_sub_u32 s1, s25, 5
  s_and_b32 s1, s1, 7
  v_mfma_f32_16x16x32_bf16 v[60:63], v[152:155], a[12:15], v[60:63]
  s_add_u32 s56, s56, 4096
  buffer_load_dwordx4 v[140:143], v3, s[12:15], s56 offen offset:0 sc1
  s_lshl_b32 s1, s1, 13
  s_add_u32 s77, s1, s66
  v_mfma_f32_16x16x32_bf16 v[60:63], v[156:159], a[24:27], v[60:63]
  s_sub_u32 s1, s25, 6
  s_and_b32 s1, s1, 7
  v_mfma_f32_16x16x32_bf16 v[64:67], v[148:151], a[4:7], v[64:67]
  s_lshl_b32 s1, s1, 13
  s_add_u32 s78, s1, s66
  v_mfma_f32_16x16x32_bf16 v[64:67], v[152:155], a[16:19], v[64:67]
  s_sub_u32 s1, s25, 7
  s_and_b32 s1, s1, 7
  v_mfma_f32_16x16x32_bf16 v[64:67], v[156:159], a[28:31], v[64:67]
  buffer_load_dwordx4 v[144:147], v3, s[12:15], s56 offen offset:1024 sc1
  s_lshl_b32 s1, s1, 13
  s_add_u32 s79, s1, s66
  v_mfma_f32_16x16x32_bf16 v[68:71], v[148:151], a[8:11], v[68:71]
  s_lshl_b32 s67, s24, 14
  s_lshl_b32 s1, s25, 10
  v_mfma_f32_16x16x32_bf16 v[68:71], v[152:155], a[20:23], v[68:71]
  s_lshl_b32 s80, s24, 8
  s_add_u32 s1, s1, s80
  v_mfma_f32_16x16x32_bf16 v[68:71], v[156:159], a[32:35], v[68:71]
  s_add_u32 s1, s1, s32
  s_add_u32 s80, s1, 524288
  s_waitcnt vmcnt(19) lgkmcnt(1)
  v_mfma_f32_16x16x32_bf16 v[56:59], v[160:163], v[196:199], v[56:59]
  buffer_load_dwordx4 v[148:151], v3, s[12:15], s56 offen offset:2048 sc1
  s_add_u32 s81, s80, 31744
  v_lshlrev_b32 v10, 13, v2
  v_mfma_f32_16x16x32_bf16 v[56:59], v[164:167], v[200:203], v[56:59]
  v_lshl_add_u32 v10, v1, 4, v10
  v_add_u32 v8, s67, v3
  v_mfma_f32_16x16x32_bf16 v[56:59], v[168:171], v[204:207], v[56:59]
  v_lshrrev_b32 v9, 3, v1
  v_mul_u32_u24 v9, 384, v9
  v_mfma_f32_16x16x32_bf16 v[60:63], v[160:163], a[36:39], v[60:63]
  v_add_u32 v10, v10, v9
  s_xor_b32 s1, s64, s24
  v_mfma_f32_16x16x32_bf16 v[60:63], v[164:167], a[48:51], v[60:63]
  buffer_load_dwordx4 v[152:155], v3, s[12:15], s56 offen offset:3072 sc1
  s_lshr_b32 s80, s1, 1
  s_lshl_b32 s80, s80, 10
  v_mfma_f32_16x16x32_bf16 v[60:63], v[168:171], a[60:63], v[60:63]
  s_and_b32 s1, s1, 1
  s_lshl_b32 s1, s1, 8
  v_mfma_f32_16x16x32_bf16 v[64:67], v[160:163], a[40:43], v[64:67]
  s_add_u32 s80, s80, s1
  s_and_b32 s1, s25, 1
  v_mfma_f32_16x16x32_bf16 v[64:67], v[164:167], a[52:55], v[64:67]
  s_lshl_b32 s1, s1, 7
  s_add_u32 s80, s80, s1
  v_mfma_f32_16x16x32_bf16 v[64:67], v[168:171], a[64:67], v[64:67]
  s_add_u32 s56, s56, 4096
  ds_read_b128 v[156:159], v7 offset:10240
  s_lshl_b32 s1, s24, 11
  s_add_u32 s80, s80, s1
  v_mfma_f32_16x16x32_bf16 v[68:71], v[160:163], a[44:47], v[68:71]
  s_add_u32 s80, s80, s32
  s_add_u32 s80, s80, 524288
  v_mfma_f32_16x16x32_bf16 v[68:71], v[164:167], a[56:59], v[68:71]
  s_add_u32 s81, s80, 31744
  v_min_u32 v11, 7, v0
  v_mfma_f32_16x16x32_bf16 v[68:71], v[168:171], a[68:71], v[68:71]
  s_add_u32 s1, s25, 6
  v_add_u32 v11, s1, v11
  s_waitcnt vmcnt(19) lgkmcnt(1)
  v_mfma_f32_16x16x32_bf16 v[56:59], v[172:175], v[208:211], v[56:59]
  ds_read_b128 v[160:163], v7 offset:11264
  v_and_b32 v11, 7, v11
  s_lshl_b32 s1, s26, 3
  v_mfma_f32_16x16x32_bf16 v[56:59], v[176:179], v[212:215], v[56:59]
  v_add_u32 v11, s1, v11
  v_mul_u32_u24 v11, 1152, v11
  v_mfma_f32_16x16x32_bf16 v[56:59], v[180:183], v[216:219], v[56:59]
  v_min_u32 v9, 1, v0
  s_add_u32 s1, s25, 4
  v_mfma_f32_16x16x32_bf16 v[60:63], v[172:175], a[72:75], v[60:63]
  v_add_u32 v9, s1, v9
  v_and_b32 v9, 7, v9
  v_mfma_f32_16x16x32_bf16 v[60:63], v[176:179], a[84:87], v[60:63]
  buffer_load_dwordx4 v[164:167], v3, s[12:15], s56 offen offset:2048 sc1
  s_lshl_b32 s1, s26, 3
  v_add_u32 v9, s1, v9
  v_mfma_f32_16x16x32_bf16 v[60:63], v[180:183], a[96:99], v[60:63]
  v_mul_u32_u24 v9, 1152, v9
  v_min_u32 v4, 2, v0
  v_mfma_f32_16x16x32_bf16 v[64:67], v[172:175], a[76:79], v[64:67]
  s_barrier
  s_add_u32 s1, s25, 1
  v_add_u32 v4, s1, v4
  v_mfma_f32_16x16x32_bf16 v[64:67], v[176:179], a[88:91], v[64:67]
  v_and_b32 v4, 7, v4
  s_lshl_b32 s1, s26, 3
  v_mfma_f32_16x16x32_bf16 v[64:67], v[180:183], a[100:103], v[64:67]
  buffer_load_dwordx4 v[168:171], v3, s[12:15], s56 offen offset:3072 sc1
  v_add_u32 v4, s1, v4
  v_mul_u32_u24 v4, 1152, v4
  v_mfma_f32_16x16x32_bf16 v[68:71], v[172:175], a[80:83], v[68:71]
  v_mfma_f32_16x16x32_bf16 v[68:71], v[176:179], a[92:95], v[68:71]
  v_mfma_f32_16x16x32_bf16 v[68:71], v[180:183], a[104:107], v[68:71]
  s_waitcnt vmcnt(18)
  v_mfma_f32_16x16x32_bf16 v[56:59], v[88:91], v[220:223], v[56:59]
  s_add_u32 s56, s56, 4096
  buffer_load_dwordx4 v[172:175], v3, s[12:15], s56 offen offset:0 sc1
  v_mfma_f32_16x16x32_bf16 v[56:59], v[92:95], v[224:227], v[56:59]
  v_mfma_f32_16x16x32_bf16 v[56:59], v[96:99], v[228:231], v[56:59]
  v_mfma_f32_16x16x32_bf16 v[60:63], v[88:91], a[108:111], v[60:63]
  v_mfma_f32_16x16x32_bf16 v[60:63], v[92:95], a[120:123], v[60:63]
  buffer_load_dwordx4 v[176:179], v3, s[12:15], s56 offen offset:1024 sc1
  v_mfma_f32_16x16x32_bf16 v[60:63], v[96:99], a[132:135], v[60:63]
  v_mfma_f32_16x16x32_bf16 v[64:67], v[88:91], a[112:115], v[64:67]
  v_mfma_f32_16x16x32_bf16 v[64:67], v[92:95], a[124:127], v[64:67]
  v_mfma_f32_16x16x32_bf16 v[64:67], v[96:99], a[136:139], v[64:67]
  buffer_load_dwordx4 v[180:183], v3, s[12:15], s56 offen offset:2048 sc1
  v_mfma_f32_16x16x32_bf16 v[68:71], v[88:91], a[116:119], v[68:71]
  v_mfma_f32_16x16x32_bf16 v[68:71], v[92:95], a[128:131], v[68:71]
  v_mfma_f32_16x16x32_bf16 v[68:71], v[96:99], a[140:143], v[68:71]
  s_waitcnt vmcnt(18)
  v_mfma_f32_16x16x32_bf16 v[56:59], v[100:103], v[232:235], v[56:59]
  buffer_load_dwordx4 v[88:91], v3, s[12:15], s56 offen offset:3072 sc1
  v_mfma_f32_16x16x32_bf16 v[56:59], v[104:107], v[236:239], v[56:59]
  v_mfma_f32_16x16x32_bf16 v[56:59], v[108:111], v[240:243], v[56:59]
  v_mfma_f32_16x16x32_bf16 v[60:63], v[100:103], a[144:147], v[60:63]
  v_mfma_f32_16x16x32_bf16 v[60:63], v[104:107], a[156:159], v[60:63]
  s_add_u32 s56, s56, 4096
  buffer_load_dwordx4 v[92:95], v3, s[12:15], s56 offen offset:0 sc1
  v_mfma_f32_16x16x32_bf16 v[60:63], v[108:111], a[168:171], v[60:63]
  v_mfma_f32_16x16x32_bf16 v[64:67], v[100:103], a[148:151], v[64:67]
  v_mfma_f32_16x16x32_bf16 v[64:67], v[104:107], a[160:163], v[64:67]
  v_mfma_f32_16x16x32_bf16 v[64:67], v[108:111], a[172:175], v[64:67]
  buffer_load_dwordx4 v[96:99], v3, s[12:15], s56 offen offset:1024 sc1
  v_mfma_f32_16x16x32_bf16 v[68:71], v[100:103], a[152:155], v[68:71]
  v_mfma_f32_16x16x32_bf16 v[68:71], v[104:107], a[164:167], v[68:71]
  v_mfma_f32_16x16x32_bf16 v[68:71], v[108:111], a[176:179], v[68:71]
  s_waitcnt vmcnt(18)
  v_mfma_f32_16x16x32_bf16 v[56:59], v[112:115], v[244:247], v[56:59]
  buffer_load_dwordx4 v[100:103], v3, s[12:15], s56 offen offset:2048 sc1
PAD_10:
  s_cbranch_execz WRET_2
  v_mfma_f32_16x16x32_bf16 v[56:59], v[116:119], v[248:251], v[56:59]
  v_mfma_f32_16x16x32_bf16 v[56:59], v[120:123], v[252:255], v[56:59]
  v_mfma_f32_16x16x32_bf16 v[60:63], v[112:115], a[180:183], v[60:63]
  v_mfma_f32_16x16x32_bf16 v[60:63], v[116:119], a[192:195], v[60:63]
  buffer_load_dwordx4 v[104:107], v3, s[12:15], s56 offen offset:3072 sc1
  v_mfma_f32_16x16x32_bf16 v[60:63], v[120:123], a[204:207], v[60:63]
  v_mfma_f32_16x16x32_bf16 v[64:67], v[112:115], a[184:187], v[64:67]
  v_mfma_f32_16x16x32_bf16 v[64:67], v[116:119], a[196:199], v[64:67]
  v_mfma_f32_16x16x32_bf16 v[64:67], v[120:123], a[208:211], v[64:67]
  s_add_u32 s56, s56, 4096
  buffer_load_dwordx4 v[108:111], v3, s[12:15], s56 offen offset:0 sc1
  v_mfma_f32_16x16x32_bf16 v[68:71], v[112:115], a[188:191], v[68:71]
  v_mfma_f32_16x16x32_bf16 v[68:71], v[116:119], a[200:203], v[68:71]
  v_mfma_f32_16x16x32_bf16 v[68:71], v[120:123], a[212:215], v[68:71]
  s_waitcnt vmcnt(16)
  v_mfma_f32_16x16x32_bf16 v[40:43], v[124:127], a[216:219], 0
  s_mov_b32 s56, s88
  buffer_load_dwordx4 v[112:115], v3, s[12:15], s56 offen offset:0 sc1
  s_add_u32 s59, s29, 2
  s_and_b32 s59, s59, 7
  s_lshl_b32 s59, s59, 16
  s_add_u32 s59, s59, s35
  v_mfma_f32_16x16x32_bf16 v[40:43], v[128:131], a[232:235], v[40:43]
  v_cvt_pk_bf16_f32 v32, v56, v57
  v_cvt_pk_bf16_f32 v33, v58, v59
  v_mfma_f32_16x16x32_bf16 v[40:43], v[132:135], a[248:251], v[40:43]
  s_barrier
  v_cvt_pk_bf16_f32 v34, v60, v61
  v_cvt_pk_bf16_f32 v35, v62, v63
  v_mfma_f32_16x16x32_bf16 v[44:47], v[124:127], a[220:223], 0
  buffer_store_dwordx4 v[32:35], v3, s[12:15], s59 offen offset:0 sc1
  v_mfma_f32_16x16x32_bf16 v[44:47], v[128:131], a[236:239], v[44:47]
  buffer_load_dwordx4 v[116:119], v3, s[12:15], s56 offen offset:1024 sc1
  v_cvt_pk_bf16_f32 v36, v64, v65
  v_cvt_pk_bf16_f32 v37, v66, v67
  v_mfma_f32_16x16x32_bf16 v[44:47], v[132:135], a[252:255], v[44:47]
  v_cvt_pk_bf16_f32 v38, v68, v69
  v_cvt_pk_bf16_f32 v39, v70, v71
  v_mfma_f32_16x16x32_bf16 v[48:51], v[124:127], a[224:227], 0
  buffer_store_dwordx4 v[36:39], v3, s[12:15], s59 offen offset:1024 sc1
  v_mfma_f32_16x16x32_bf16 v[48:51], v[128:131], a[240:243], v[48:51]
  v_mfma_f32_16x16x32_bf16 v[48:51], v[132:135], v[76:79], v[48:51]
  buffer_load_dwordx4 v[120:123], v84, s[12:15], s56 offen offset:2048 sc1
  v_mfma_f32_16x16x32_bf16 v[52:55], v[124:127], a[228:231], 0
  v_mfma_f32_16x16x32_bf16 v[52:55], v[128:131], a[244:247], v[52:55]
  v_mfma_f32_16x16x32_bf16 v[52:55], v[132:135], v[80:83], v[52:55]
  s_waitcnt vmcnt(18)
  v_mfma_f32_16x16x32_bf16 v[40:43], v[136:139], v[184:187], v[40:43]
  buffer_load_dwordx4 v[124:127], v3, s[12:15], s56 offen offset:3072 sc1
  v_mfma_f32_16x16x32_bf16 v[40:43], v[140:143], v[188:191], v[40:43]
  v_mfma_f32_16x16x32_bf16 v[40:43], v[144:147], v[192:195], v[40:43]
  v_mfma_f32_16x16x32_bf16 v[44:47], v[136:139], a[0:3], v[44:47]
  v_mfma_f32_16x16x32_bf16 v[44:47], v[140:143], a[12:15], v[44:47]
  s_add_u32 s56, s56, 4096
  buffer_load_dwordx4 v[128:131], v3, s[12:15], s56 offen offset:0 sc1
  v_mfma_f32_16x16x32_bf16 v[44:47], v[144:147], a[24:27], v[44:47]
  v_mfma_f32_16x16x32_bf16 v[48:51], v[136:139], a[4:7], v[48:51]
  v_mfma_f32_16x16x32_bf16 v[48:51], v[140:143], a[16:19], v[48:51]
  v_mfma_f32_16x16x32_bf16 v[48:51], v[144:147], a[28:31], v[48:51]
  buffer_load_dwordx4 v[132:135], v3, s[12:15], s56 offen offset:1024 sc1
  v_mfma_f32_16x16x32_bf16 v[52:55], v[136:139], a[8:11], v[52:55]
  v_mfma_f32_16x16x32_bf16 v[52:55], v[140:143], a[20:23], v[52:55]
  v_mfma_f32_16x16x32_bf16 v[52:55], v[144:147], a[32:35], v[52:55]
  s_waitcnt vmcnt(19) lgkmcnt(1)
  v_mfma_f32_16x16x32_bf16 v[40:43], v[148:151], v[196:199], v[40:43]
  buffer_load_dwordx4 v[136:139], v3, s[12:15], s56 offen offset:2048 sc1
  v_mfma_f32_16x16x32_bf16 v[40:43], v[152:155], v[200:203], v[40:43]
  v_mfma_f32_16x16x32_bf16 v[40:43], v[156:159], v[204:207], v[40:43]
  v_mfma_f32_16x16x32_bf16 v[44:47], v[148:151], a[36:39], v[44:47]
  v_mfma_f32_16x16x32_bf16 v[44:47], v[152:155], a[48:51], v[44:47]
  buffer_load_dwordx4 v[140:143], v3, s[12:15], s56 offen offset:3072 sc1
  v_mfma_f32_16x16x32_bf16 v[44:47], v[156:159], a[60:63], v[44:47]
  v_mfma_f32_16x16x32_bf16 v[48:51], v[148:151], a[40:43], v[48:51]
  v_mfma_f32_16x16x32_bf16 v[48:51], v[152:155], a[52:55], v[48:51]
  v_mfma_f32_16x16x32_bf16 v[48:51], v[156:159], a[64:67], v[48:51]
  s_add_u32 s56, s56, 4096
  ds_read_b128 v[144:147], v7 offset:8192
  v_mfma_f32_16x16x32_bf16 v[52:55], v[148:151], a[44:47], v[52:55]
  v_mfma_f32_16x16x32_bf16 v[52:55], v[152:155], a[56:59], v[52:55]
  v_mfma_f32_16x16x32_bf16 v[52:55], v[156:159], a[68:71], v[52:55]
  s_waitcnt vmcnt(19) lgkmcnt(1)
  v_mfma_f32_16x16x32_bf16 v[40:43], v[160:163], v[208:211], v[40:43]
  ds_read_b128 v[148:151], v7 offset:9216
  v_mfma_f32_16x16x32_bf16 v[40:43], v[164:167], v[212:215], v[40:43]
  v_mfma_f32_16x16x32_bf16 v[40:43], v[168:171], v[216:219], v[40:43]
  v_mfma_f32_16x16x32_bf16 v[44:47], v[160:163], a[72:75], v[44:47]
  v_mfma_f32_16x16x32_bf16 v[44:47], v[164:167], a[84:87], v[44:47]
  buffer_load_dwordx4 v[152:155], v3, s[12:15], s56 offen offset:2048 sc1
  v_mfma_f32_16x16x32_bf16 v[44:47], v[168:171], a[96:99], v[44:47]
  v_mfma_f32_16x16x32_bf16 v[48:51], v[160:163], a[76:79], v[48:51]
  s_barrier
  v_mfma_f32_16x16x32_bf16 v[48:51], v[164:167], a[88:91], v[48:51]
  v_mfma_f32_16x16x32_bf16 v[48:51], v[168:171], a[100:103], v[48:51]
  buffer_load_dwordx4 v[156:159], v3, s[12:15], s56 offen offset:3072 sc1
  v_mfma_f32_16x16x32_bf16 v[52:55], v[160:163], a[80:83], v[52:55]
  v_mfma_f32_16x16x32_bf16 v[52:55], v[164:167], a[92:95], v[52:55]
  v_mfma_f32_16x16x32_bf16 v[52:55], v[168:171], a[104:107], v[52:55]
  s_waitcnt vmcnt(18)
  v_mfma_f32_16x16x32_bf16 v[40:43], v[172:175], v[220:223], v[40:43]
  s_add_u32 s56, s56, 4096
  buffer_load_dwordx4 v[160:163], v3, s[12:15], s56 offen offset:0 sc1
  v_mfma_f32_16x16x32_bf16 v[40:43], v[176:179], v[224:227], v[40:43]
  v_mfma_f32_16x16x32_bf16 v[40:43], v[180:183], v[228:231], v[40:43]
  v_mfma_f32_16x16x32_bf16 v[44:47], v[172:175], a[108:111], v[44:47]
  v_mfma_f32_16x16x32_bf16 v[44:47], v[176:179], a[120:123], v[44:47]
  buffer_load_dwordx4 v[164:167], v3, s[12:15], s56 offen offset:1024 sc1
  v_mfma_f32_16x16x32_bf16 v[44:47], v[180:183], a[132:135], v[44:47]
  v_mfma_f32_16x16x32_bf16 v[48:51], v[172:175], a[112:115], v[48:51]
  v_mfma_f32_16x16x32_bf16 v[48:51], v[176:179], a[124:127], v[48:51]
  v_mfma_f32_16x16x32_bf16 v[48:51], v[180:183], a[136:139], v[48:51]
  buffer_load_dwordx4 v[168:171], v3, s[12:15], s56 offen offset:2048 sc1
  v_mfma_f32_16x16x32_bf16 v[52:55], v[172:175], a[116:119], v[52:55]
  v_mfma_f32_16x16x32_bf16 v[52:55], v[176:179], a[128:131], v[52:55]
  v_mfma_f32_16x16x32_bf16 v[52:55], v[180:183], a[140:143], v[52:55]
  s_waitcnt vmcnt(18)
  v_mfma_f32_16x16x32_bf16 v[40:43], v[88:91], v[232:235], v[40:43]
  buffer_load_dwordx4 v[172:175], v3, s[12:15], s56 offen offset:3072 sc1
  v_mfma_f32_16x16x32_bf16 v[40:43], v[92:95], v[236:239], v[40:43]
  v_mfma_f32_16x16x32_bf16 v[40:43], v[96:99], v[240:243], v[40:43]
  v_mfma_f32_16x16x32_bf16 v[44:47], v[88:91], a[144:147], v[44:47]
  v_mfma_f32_16x16x32_bf16 v[44:47], v[92:95], a[156:159], v[44:47]
  s_add_u32 s56, s56, 4096
  buffer_load_dwordx4 v[176:179], v3, s[12:15], s56 offen offset:0 sc1
  v_mfma_f32_16x16x32_bf16 v[44:47], v[96:99], a[168:171], v[44:47]
  v_mfma_f32_16x16x32_bf16 v[48:51], v[88:91], a[148:151], v[48:51]
  v_mfma_f32_16x16x32_bf16 v[48:51], v[92:95], a[160:163], v[48:51]
  v_mfma_f32_16x16x32_bf16 v[48:51], v[96:99], a[172:175], v[48:51]
  buffer_load_dwordx4 v[180:183], v3, s[12:15], s56 offen offset:1024 sc1
  v_mfma_f32_16x16x32_bf16 v[52:55], v[88:91], a[152:155], v[52:55]
  v_mfma_f32_16x16x32_bf16 v[52:55], v[92:95], a[164:167], v[52:55]
  v_mfma_f32_16x16x32_bf16 v[52:55], v[96:99], a[176:179], v[52:55]
  s_waitcnt vmcnt(18)
  v_mfma_f32_16x16x32_bf16 v[40:43], v[100:103], v[244:247], v[40:43]
  buffer_load_dwordx4 v[88:91], v3, s[12:15], s56 offen offset:2048 sc1
  v_mfma_f32_16x16x32_bf16 v[40:43], v[104:107], v[248:251], v[40:43]
  v_mfma_f32_16x16x32_bf16 v[40:43], v[108:111], v[252:255], v[40:43]
  v_mfma_f32_16x16x32_bf16 v[44:47], v[100:103], a[180:183], v[44:47]
  v_mfma_f32_16x16x32_bf16 v[44:47], v[104:107], a[192:195], v[44:47]
  buffer_load_dwordx4 v[92:95], v3, s[12:15], s56 offen offset:3072 sc1
  v_mfma_f32_16x16x32_bf16 v[44:47], v[108:111], a[204:207], v[44:47]
  v_mfma_f32_16x16x32_bf16 v[48:51], v[100:103], a[184:187], v[48:51]
  v_mfma_f32_16x16x32_bf16 v[48:51], v[104:107], a[196:199], v[48:51]
  v_mfma_f32_16x16x32_bf16 v[48:51], v[108:111], a[208:211], v[48:51]
  s_add_u32 s56, s56, 4096
  buffer_load_dwordx4 v[96:99], v3, s[12:15], s56 offen offset:0 sc1
  v_mfma_f32_16x16x32_bf16 v[52:55], v[100:103], a[188:191], v[52:55]
  v_mfma_f32_16x16x32_bf16 v[52:55], v[104:107], a[200:203], v[52:55]
  v_mfma_f32_16x16x32_bf16 v[52:55], v[108:111], a[212:215], v[52:55]
  s_waitcnt vmcnt(16)
  v_mfma_f32_16x16x32_bf16 v[56:59], v[112:115], a[216:219], 0
  s_mov_b32 s56, s89
  buffer_load_dwordx4 v[100:103], v3, s[12:15], s56 offen offset:0 sc1
  s_add_u32 s59, s29, 3
  s_and_b32 s59, s59, 7
  s_lshl_b32 s59, s59, 16
  s_add_u32 s59, s59, s35
  v_mfma_f32_16x16x32_bf16 v[56:59], v[116:119], a[232:235], v[56:59]
  v_cvt_pk_bf16_f32 v32, v40, v41
  v_cvt_pk_bf16_f32 v33, v42, v43
  v_mfma_f32_16x16x32_bf16 v[56:59], v[120:123], a[248:251], v[56:59]
  s_barrier
  v_cvt_pk_bf16_f32 v34, v44, v45
  v_cvt_pk_bf16_f32 v35, v46, v47
  v_mfma_f32_16x16x32_bf16 v[60:63], v[112:115], a[220:223], 0
  buffer_store_dwordx4 v[32:35], v3, s[12:15], s59 offen offset:0 sc1
  v_mfma_f32_16x16x32_bf16 v[60:63], v[116:119], a[236:239], v[60:63]
  buffer_load_dwordx4 v[104:107], v3, s[12:15], s56 offen offset:1024 sc1
  v_cvt_pk_bf16_f32 v36, v48, v49
  v_cvt_pk_bf16_f32 v37, v50, v51
  v_mfma_f32_16x16x32_bf16 v[60:63], v[120:123], a[252:255], v[60:63]
  v_cvt_pk_bf16_f32 v38, v52, v53
  v_cvt_pk_bf16_f32 v39, v54, v55
  v_mfma_f32_16x16x32_bf16 v[64:67], v[112:115], a[224:227], 0
  buffer_store_dwordx4 v[36:39], v3, s[12:15], s59 offen offset:1024 sc1
  v_mfma_f32_16x16x32_bf16 v[64:67], v[116:119], a[240:243], v[64:67]
  v_mfma_f32_16x16x32_bf16 v[64:67], v[120:123], v[76:79], v[64:67]
  buffer_load_dwordx4 v[108:111], v84, s[12:15], s56 offen offset:2048 sc1
  v_mfma_f32_16x16x32_bf16 v[68:71], v[112:115], a[228:231], 0
  v_mfma_f32_16x16x32_bf16 v[68:71], v[116:119], a[244:247], v[68:71]
  v_mfma_f32_16x16x32_bf16 v[68:71], v[120:123], v[80:83], v[68:71]
  s_waitcnt vmcnt(18)
  v_mfma_f32_16x16x32_bf16 v[56:59], v[124:127], v[184:187], v[56:59]
  buffer_load_dwordx4 v[112:115], v3, s[12:15], s56 offen offset:3072 sc1
  v_mfma_f32_16x16x32_bf16 v[56:59], v[128:131], v[188:191], v[56:59]
  v_mfma_f32_16x16x32_bf16 v[56:59], v[132:135], v[192:195], v[56:59]
  s_barrier
  s_cmp_lg_u32 s24, 0
  s_cbranch_scc1 L_fs24
  s_mul_i32 s57, s99, 1152
  s_add_u32 s57, s57, 459136
  s_mov_b64 exec, 1
  buffer_store_dword v5, v6, s[12:15], s57 offen sc1
  s_mov_b64 exec, -1
L_fs24:
  v_mfma_f32_16x16x32_bf16 v[60:63], v[124:127], a[0:3], v[60:63]
  v_mfma_f32_16x16x32_bf16 v[60:63], v[128:131], a[12:15], v[60:63]
  s_add_u32 s56, s56, 4096
  buffer_load_dwordx4 v[116:119], v3, s[12:15], s56 offen offset:0 sc1
  v_mfma_f32_16x16x32_bf16 v[60:63], v[132:135], a[24:27], v[60:63]
  v_mfma_f32_16x16x32_bf16 v[64:67], v[124:127], a[4:7], v[64:67]
  v_mfma_f32_16x16x32_bf16 v[64:67], v[128:131], a[16:19], v[64:67]
  v_mfma_f32_16x16x32_bf16 v[64:67], v[132:135], a[28:31], v[64:67]
  buffer_load_dwordx4 v[120:123], v3, s[12:15], s56 offen offset:1024 sc1
  v_mfma_f32_16x16x32_bf16 v[68:71], v[124:127], a[8:11], v[68:71]
  v_mfma_f32_16x16x32_bf16 v[68:71], v[128:131], a[20:23], v[68:71]
  v_mfma_f32_16x16x32_bf16 v[68:71], v[132:135], a[32:35], v[68:71]
  s_waitcnt vmcnt(19) lgkmcnt(1)
  v_mfma_f32_16x16x32_bf16 v[56:59], v[136:139], v[196:199], v[56:59]
  buffer_load_dwordx4 v[124:127], v3, s[12:15], s56 offen offset:2048 sc1
  v_mfma_f32_16x16x32_bf16 v[56:59], v[140:143], v[200:203], v[56:59]
  v_mfma_f32_16x16x32_bf16 v[56:59], v[144:147], v[204:207], v[56:59]
  v_mfma_f32_16x16x32_bf16 v[60:63], v[136:139], a[36:39], v[60:63]
  v_mfma_f32_16x16x32_bf16 v[60:63], v[140:143], a[48:51], v[60:63]
  buffer_load_dwordx4 v[128:131], v3, s[12:15], s56 offen offset:3072 sc1
  v_mfma_f32_16x16x32_bf16 v[60:63], v[144:147], a[60:63], v[60:63]
  v_mfma_f32_16x16x32_bf16 v[64:67], v[136:139], a[40:43], v[64:67]
  v_mfma_f32_16x16x32_bf16 v[64:67], v[140:143], a[52:55], v[64:67]
  v_mfma_f32_16x16x32_bf16 v[64:67], v[144:147], a[64:67], v[64:67]
  s_add_u32 s56, s56, 4096
  ds_read_b128 v[132:135], v7 offset:6144
  v_mfma_f32_16x16x32_bf16 v[68:71], v[136:139], a[44:47], v[68:71]
  v_mfma_f32_16x16x32_bf16 v[68:71], v[140:143], a[56:59], v[68:71]
  v_mfma_f32_16x16x32_bf16 v[68:71], v[144:147], a[68:71], v[68:71]
  s_waitcnt vmcnt(19) lgkmcnt(1)
  v_mfma_f32_16x16x32_bf16 v[56:59], v[148:151], v[208:211], v[56:59]
  ds_read_b128 v[136:139], v7 offset:7168
  v_mfma_f32_16x16x32_bf16 v[56:59], v[152:155], v[212:215], v[56:59]
  v_mfma_f32_16x16x32_bf16 v[56:59], v[156:159], v[216:219], v[56:59]
  v_mfma_f32_16x16x32_bf16 v[60:63], v[148:151], a[72:75], v[60:63]
  v_mfma_f32_16x16x32_bf16 v[60:63], v[152:155], a[84:87], v[60:63]
  buffer_load_dwordx4 v[140:143], v3, s[12:15], s56 offen offset:2048 sc1
  v_mfma_f32_16x16x32_bf16 v[60:63], v[156:159], a[96:99], v[60:63]
  v_mfma_f32_16x16x32_bf16 v[64:67], v[148:151], a[76:79], v[64:67]
  s_barrier
  v_mfma_f32_16x16x32_bf16 v[64:67], v[152:155], a[88:91], v[64:67]
  v_mfma_f32_16x16x32_bf16 v[64:67], v[156:159], a[100:103], v[64:67]
  buffer_load_dwordx4 v[144:147], v3, s[12:15], s56 offen offset:3072 sc1
  v_mfma_f32_16x16x32_bf16 v[68:71], v[148:151], a[80:83], v[68:71]
  v_mfma_f32_16x16x32_bf16 v[68:71], v[152:155], a[92:95], v[68:71]
  v_mfma_f32_16x16x32_bf16 v[68:71], v[156:159], a[104:107], v[68:71]
  s_waitcnt vmcnt(18)
  v_mfma_f32_16x16x32_bf16 v[56:59], v[160:163], v[220:223], v[56:59]
  s_add_u32 s56, s56, 4096
  buffer_load_dwordx4 v[148:151], v3, s[12:15], s56 offen offset:0 sc1
  v_mfma_f32_16x16x32_bf16 v[56:59], v[164:167], v[224:227], v[56:59]
  v_mfma_f32_16x16x32_bf16 v[56:59], v[168:171], v[228:231], v[56:59]
  v_mfma_f32_16x16x32_bf16 v[60:63], v[160:163], a[108:111], v[60:63]
  v_mfma_f32_16x16x32_bf16 v[60:63], v[164:167], a[120:123], v[60:63]
  buffer_load_dwordx4 v[152:155], v3, s[12:15], s56 offen offset:1024 sc1
  v_mfma_f32_16x16x32_bf16 v[60:63], v[168:171], a[132:135], v[60:63]
  v_mfma_f32_16x16x32_bf16 v[64:67], v[160:163], a[112:115], v[64:67]
  v_mfma_f32_16x16x32_bf16 v[64:67], v[164:167], a[124:127], v[64:67]
  v_mfma_f32_16x16x32_bf16 v[64:67], v[168:171], a[136:139], v[64:67]
  buffer_load_dwordx4 v[156:159], v3, s[12:15], s56 offen offset:2048 sc1
  v_mfma_f32_16x16x32_bf16 v[68:71], v[160:163], a[116:119], v[68:71]
  v_mfma_f32_16x16x32_bf16 v[68:71], v[164:167], a[128:131], v[68:71]
  v_mfma_f32_16x16x32_bf16 v[68:71], v[168:171], a[140:143], v[68:71]
  s_waitcnt vmcnt(18)
  v_mfma_f32_16x16x32_bf16 v[56:59], v[172:175], v[232:235], v[56:59]
  buffer_load_dwordx4 v[160:163], v3, s[12:15], s56 offen offset:3072 sc1
  v_mfma_f32_16x16x32_bf16 v[56:59], v[176:179], v[236:239], v[56:59]
  v_mfma_f32_16x16x32_bf16 v[56:59], v[180:183], v[240:243], v[56:59]
  v_mfma_f32_16x16x32_bf16 v[60:63], v[172:175], a[144:147], v[60:63]
  v_mfma_f32_16x16x32_bf16 v[60:63], v[176:179], a[156:159], v[60:63]
  s_add_u32 s56, s56, 4096
  buffer_load_dwordx4 v[164:167], v3, s[12:15], s56 offen offset:0 sc1
  v_mfma_f32_16x16x32_bf16 v[60:63], v[180:183], a[168:171], v[60:63]
  v_mfma_f32_16x16x32_bf16 v[64:67], v[172:175], a[148:151], v[64:67]
  v_mfma_f32_16x16x32_bf16 v[64:67], v[176:179], a[160:163], v[64:67]
  v_mfma_f32_16x16x32_bf16 v[64:67], v[180:183], a[172:175], v[64:67]
  buffer_load_dwordx4 v[168:171], v3, s[12:15], s56 offen offset:1024 sc1
  v_mfma_f32_16x16x32_bf16 v[68:71], v[172:175], a[152:155], v[68:71]
  v_mfma_f32_16x16x32_bf16 v[68:71], v[176:179], a[164:167], v[68:71]
  v_mfma_f32_16x16x32_bf16 v[68:71], v[180:183], a[176:179], v[68:71]
  s_waitcnt vmcnt(18)
  v_mfma_f32_16x16x32_bf16 v[56:59], v[88:91], v[244:247], v[56:59]
  buffer_load_dwordx4 v[172:175], v3, s[12:15], s56 offen offset:2048 sc1
  v_mfma_f32_16x16x32_bf16 v[56:59], v[92:95], v[248:251], v[56:59]
  v_mfma_f32_16x16x32_bf16 v[56:59], v[96:99], v[252:255], v[56:59]
  v_mfma_f32_16x16x32_bf16 v[60:63], v[88:91], a[180:183], v[60:63]
  v_mfma_f32_16x16x32_bf16 v[60:63], v[92:95], a[192:195], v[60:63]
  buffer_load_dwordx4 v[176:179], v3, s[12:15], s56 offen offset:3072 sc1
  v_mfma_f32_16x16x32_bf16 v[60:63], v[96:99], a[204:207], v[60:63]
  v_mfma_f32_16x16x32_bf16 v[64:67], v[88:91], a[184:187], v[64:67]
  v_mfma_f32_16x16x32_bf16 v[64:67], v[92:95], a[196:199], v[64:67]
  v_mfma_f32_16x16x32_bf16 v[64:67], v[96:99], a[208:211], v[64:67]
  s_add_u32 s56, s56, 4096
  buffer_load_dwordx4 v[180:183], v3, s[12:15], s56 offen offset:0 sc1
  v_mfma_f32_16x16x32_bf16 v[68:71], v[88:91], a[188:191], v[68:71]
  v_mfma_f32_16x16x32_bf16 v[68:71], v[92:95], a[200:203], v[68:71]
  v_mfma_f32_16x16x32_bf16 v[68:71], v[96:99], a[212:215], v[68:71]
  s_waitcnt vmcnt(16)
  v_mfma_f32_16x16x32_bf16 v[40:43], v[100:103], a[216:219], 0
  s_mov_b32 s56, s90
  buffer_load_dwordx4 v[88:91], v3, s[12:15], s56 offen offset:0 sc1
  s_add_u32 s59, s29, 4
  s_and_b32 s59, s59, 7
  s_lshl_b32 s59, s59, 16
  s_add_u32 s59, s59, s35
  v_mfma_f32_16x16x32_bf16 v[40:43], v[104:107], a[232:235], v[40:43]
  v_cvt_pk_bf16_f32 v32, v56, v57
  v_cvt_pk_bf16_f32 v33, v58, v59
  v_mfma_f32_16x16x32_bf16 v[40:43], v[108:111], a[248:251], v[40:43]
  s_barrier
  v_cvt_pk_bf16_f32 v34, v60, v61
  v_cvt_pk_bf16_f32 v35, v62, v63
  v_mfma_f32_16x16x32_bf16 v[44:47], v[100:103], a[220:223], 0
  buffer_store_dwordx4 v[32:35], v3, s[12:15], s59 offen offset:0 sc1
  v_mfma_f32_16x16x32_bf16 v[44:47], v[104:107], a[236:239], v[44:47]
  buffer_load_dwordx4 v[92:95], v3, s[12:15], s56 offen offset:1024 sc1
  v_cvt_pk_bf16_f32 v36, v64, v65
  v_cvt_pk_bf16_f32 v37, v66, v67
  v_mfma_f32_16x16x32_bf16 v[44:47], v[108:111], a[252:255], v[44:47]
  v_cvt_pk_bf16_f32 v38, v68, v69
  v_cvt_pk_bf16_f32 v39, v70, v71
  v_mfma_f32_16x16x32_bf16 v[48:51], v[100:103], a[224:227], 0
  buffer_store_dwordx4 v[36:39], v3, s[12:15], s59 offen offset:1024 sc1
  v_mfma_f32_16x16x32_bf16 v[48:51], v[104:107], a[240:243], v[48:51]
  v_mfma_f32_16x16x32_bf16 v[48:51], v[108:111], v[76:79], v[48:51]
  buffer_load_dwordx4 v[96:99], v84, s[12:15], s56 offen offset:2048 sc1
  v_mfma_f32_16x16x32_bf16 v[52:55], v[100:103], a[228:231], 0
  v_mfma_f32_16x16x32_bf16 v[52:55], v[104:107], a[244:247], v[52:55]
  v_mfma_f32_16x16x32_bf16 v[52:55], v[108:111], v[80:83], v[52:55]
  s_waitcnt vmcnt(18)
  v_mfma_f32_16x16x32_bf16 v[40:43], v[112:115], v[184:187], v[40:43]
  buffer_load_dwordx4 v[100:103], v3, s[12:15], s56 offen offset:3072 sc1
  v_mfma_f32_16x16x32_bf16 v[40:43], v[116:119], v[188:191], v[40:43]
  v_mfma_f32_16x16x32_bf16 v[40:43], v[120:123], v[192:195], v[40:43]
  s_mov_b32 s57, 459136
  buffer_load_dword v12, v11, s[12:15], s57 offen sc1
  v_mfma_f32_16x16x32_bf16 v[44:47], v[112:115], a[0:3], v[44:47]
  v_mfma_f32_16x16x32_bf16 v[44:47], v[116:119], a[12:15], v[44:47]
  s_add_u32 s56, s56, 4096
  buffer_load_dwordx4 v[104:107], v3, s[12:15], s56 offen offset:0 sc1
  v_mfma_f32_16x16x32_bf16 v[44:47], v[120:123], a[24:27], v[44:47]
  v_mfma_f32_16x16x32_bf16 v[48:51], v[112:115], a[4:7], v[48:51]
  v_mfma_f32_16x16x32_bf16 v[48:51], v[116:119], a[16:19], v[48:51]
  v_mfma_f32_16x16x32_bf16 v[48:51], v[120:123], a[28:31], v[48:51]
  buffer_load_dwordx4 v[108:111], v3, s[12:15], s56 offen offset:1024 sc1
  v_mfma_f32_16x16x32_bf16 v[52:55], v[112:115], a[8:11], v[52:55]
  v_mfma_f32_16x16x32_bf16 v[52:55], v[116:119], a[20:23], v[52:55]
  v_mfma_f32_16x16x32_bf16 v[52:55], v[120:123], a[32:35], v[52:55]
  s_waitcnt vmcnt(20) lgkmcnt(1)
  v_mfma_f32_16x16x32_bf16 v[40:43], v[124:127], v[196:199], v[40:43]
  buffer_load_dwordx4 v[112:115], v3, s[12:15], s56 offen offset:2048 sc1
  v_mfma_f32_16x16x32_bf16 v[40:43], v[128:131], v[200:203], v[40:43]
  v_mfma_f32_16x16x32_bf16 v[40:43], v[132:135], v[204:207], v[40:43]
  v_mfma_f32_16x16x32_bf16 v[44:47], v[124:127], a[36:39], v[44:47]
  v_mfma_f32_16x16x32_bf16 v[44:47], v[128:131], a[48:51], v[44:47]
  buffer_load_dwordx4 v[116:119], v3, s[12:15], s56 offen offset:3072 sc1
  v_mfma_f32_16x16x32_bf16 v[44:47], v[132:135], a[60:63], v[44:47]
  v_mfma_f32_16x16x32_bf16 v[48:51], v[124:127], a[40:43], v[48:51]
  v_mfma_f32_16x16x32_bf16 v[48:51], v[128:131], a[52:55], v[48:51]
  v_mfma_f32_16x16x32_bf16 v[48:51], v[132:135], a[64:67], v[48:51]
  s_add_u32 s56, s56, 4096
  ds_read_b128 v[120:123], v7 offset:4096
  v_mfma_f32_16x16x32_bf16 v[52:55], v[124:127], a[44:47], v[52:55]
  v_mfma_f32_16x16x32_bf16 v[52:55], v[128:131], a[56:59], v[52:55]
  v_mfma_f32_16x16x32_bf16 v[52:55], v[132:135], a[68:71], v[52:55]
  s_waitcnt vmcnt(20) lgkmcnt(1)
  v_mfma_f32_16x16x32_bf16 v[40:43], v[136:139], v[208:211], v[40:43]
  ds_read_b128 v[124:127], v7 offset:5120
  v_mfma_f32_16x16x32_bf16 v[40:43], v[140:143], v[212:215], v[40:43]
  v_mfma_f32_16x16x32_bf16 v[40:43], v[144:147], v[216:219], v[40:43]
  v_mfma_f32_16x16x32_bf16 v[44:47], v[136:139], a[72:75], v[44:47]
  v_mfma_f32_16x16x32_bf16 v[44:47], v[140:143], a[84:87], v[44:47]
  buffer_load_dwordx4 v[128:131], v3, s[12:15], s56 offen offset:2048 sc1
  v_mfma_f32_16x16x32_bf16 v[44:47], v[144:147], a[96:99], v[44:47]
  v_mfma_f32_16x16x32_bf16 v[48:51], v[136:139], a[76:79], v[48:51]
  s_barrier
  v_mfma_f32_16x16x32_bf16 v[48:51], v[140:143], a[88:91], v[48:51]
  v_mfma_f32_16x16x32_bf16 v[48:51], v[144:147], a[100:103], v[48:51]
  buffer_load_dwordx4 v[132:135], v3, s[12:15], s56 offen offset:3072 sc1
  v_mfma_f32_16x16x32_bf16 v[52:55], v[136:139], a[80:83], v[52:55]
  v_mfma_f32_16x16x32_bf16 v[52:55], v[140:143], a[92:95], v[52:55]
  v_mfma_f32_16x16x32_bf16 v[52:55], v[144:147], a[104:107], v[52:55]
  s_waitcnt vmcnt(19)
  v_mfma_f32_16x16x32_bf16 v[40:43], v[148:151], v[220:223], v[40:43]
  s_add_u32 s56, s56, 4096
  buffer_load_dwordx4 v[136:139], v3, s[12:15], s56 offen offset:0 sc1
  v_mfma_f32_16x16x32_bf16 v[40:43], v[152:155], v[224:227], v[40:43]
  v_mfma_f32_16x16x32_bf16 v[40:43], v[156:159], v[228:231], v[40:43]
  v_mfma_f32_16x16x32_bf16 v[44:47], v[148:151], a[108:111], v[44:47]
  v_mfma_f32_16x16x32_bf16 v[44:47], v[152:155], a[120:123], v[44:47]
  buffer_load_dwordx4 v[140:143], v3, s[12:15], s56 offen offset:1024 sc1
  v_mfma_f32_16x16x32_bf16 v[44:47], v[156:159], a[132:135], v[44:47]
  v_mfma_f32_16x16x32_bf16 v[48:51], v[148:151], a[112:115], v[48:51]
  v_mfma_f32_16x16x32_bf16 v[48:51], v[152:155], a[124:127], v[48:51]
  v_mfma_f32_16x16x32_bf16 v[48:51], v[156:159], a[136:139], v[48:51]
  buffer_load_dwordx4 v[144:147], v3, s[12:15], s56 offen offset:2048 sc1
  v_mfma_f32_16x16x32_bf16 v[52:55], v[148:151], a[116:119], v[52:55]
  v_mfma_f32_16x16x32_bf16 v[52:55], v[152:155], a[128:131], v[52:55]
  v_mfma_f32_16x16x32_bf16 v[52:55], v[156:159], a[140:143], v[52:55]
  s_waitcnt vmcnt(19)
  v_mfma_f32_16x16x32_bf16 v[40:43], v[160:163], v[232:235], v[40:43]
  buffer_load_dwordx4 v[148:151], v3, s[12:15], s56 offen offset:3072 sc1
  v_mfma_f32_16x16x32_bf16 v[40:43], v[164:167], v[236:239], v[40:43]
  v_mfma_f32_16x16x32_bf16 v[40:43], v[168:171], v[240:243], v[40:43]
  v_mfma_f32_16x16x32_bf16 v[44:47], v[160:163], a[144:147], v[44:47]
  v_mfma_f32_16x16x32_bf16 v[44:47], v[164:167], a[156:159], v[44:47]
  s_add_u32 s56, s56, 4096
  buffer_load_dwordx4 v[152:155], v3, s[12:15], s56 offen offset:0 sc1
  v_mfma_f32_16x16x32_bf16 v[44:47], v[168:171], a[168:171], v[44:47]
  v_mfma_f32_16x16x32_bf16 v[48:51], v[160:163], a[148:151], v[48:51]
  v_mfma_f32_16x16x32_bf16 v[48:51], v[164:167], a[160:163], v[48:51]
  v_mfma_f32_16x16x32_bf16 v[48:51], v[168:171], a[172:175], v[48:51]
  buffer_load_dwordx4 v[156:159], v3, s[12:15], s56 offen offset:1024 sc1
  v_mfma_f32_16x16x32_bf16 v[52:55], v[160:163], a[152:155], v[52:55]
  v_mfma_f32_16x16x32_bf16 v[52:55], v[164:167], a[164:167], v[52:55]
  v_mfma_f32_16x16x32_bf16 v[52:55], v[168:171], a[176:179], v[52:55]
  s_waitcnt vmcnt(19)
  v_mfma_f32_16x16x32_bf16 v[40:43], v[172:175], v[244:247], v[40:43]
  buffer_load_dwordx4 v[160:163], v3, s[12:15], s56 offen offset:2048 sc1
  v_mfma_f32_16x16x32_bf16 v[40:43], v[176:179], v[248:251], v[40:43]
  v_mfma_f32_16x16x32_bf16 v[40:43], v[180:183], v[252:255], v[40:43]
  v_mfma_f32_16x16x32_bf16 v[44:47], v[172:175], a[180:183], v[44:47]
  v_mfma_f32_16x16x32_bf16 v[44:47], v[176:179], a[192:195], v[44:47]
  buffer_load_dwordx4 v[164:167], v3, s[12:15], s56 offen offset:3072 sc1
  v_mfma_f32_16x16x32_bf16 v[44:47], v[180:183], a[204:207], v[44:47]
  v_mfma_f32_16x16x32_bf16 v[48:51], v[172:175], a[184:187], v[48:51]
  v_mfma_f32_16x16x32_bf16 v[48:51], v[176:179], a[196:199], v[48:51]
  v_mfma_f32_16x16x32_bf16 v[48:51], v[180:183], a[208:211], v[48:51]
  s_add_u32 s56, s56, 4096
  buffer_load_dwordx4 v[168:171], v3, s[12:15], s56 offen offset:0 sc1
  v_mfma_f32_16x16x32_bf16 v[52:55], v[172:175], a[188:191], v[52:55]
  v_mfma_f32_16x16x32_bf16 v[52:55], v[176:179], a[200:203], v[52:55]
  v_mfma_f32_16x16x32_bf16 v[52:55], v[180:183], a[212:215], v[52:55]
  s_waitcnt vmcnt(17)
  v_mfma_f32_16x16x32_bf16 v[56:59], v[88:91], a[216:219], 0
  s_mov_b32 s56, s91
  buffer_load_dwordx4 v[172:175], v3, s[12:15], s56 offen offset:0 sc1
  s_add_u32 s59, s29, 5
  s_and_b32 s59, s59, 7
  s_lshl_b32 s59, s59, 16
  s_add_u32 s59, s59, s35
  v_mfma_f32_16x16x32_bf16 v[56:59], v[92:95], a[232:235], v[56:59]
  v_cvt_pk_bf16_f32 v32, v40, v41
  v_cvt_pk_bf16_f32 v33, v42, v43
  v_mfma_f32_16x16x32_bf16 v[56:59], v[96:99], a[248:251], v[56:59]
  s_barrier
  v_cvt_pk_bf16_f32 v34, v44, v45
  v_cvt_pk_bf16_f32 v35, v46, v47
  v_mfma_f32_16x16x32_bf16 v[60:63], v[88:91], a[220:223], 0
  buffer_store_dwordx4 v[32:35], v3, s[12:15], s59 offen offset:0 sc1
  v_mfma_f32_16x16x32_bf16 v[60:63], v[92:95], a[236:239], v[60:63]
  buffer_load_dwordx4 v[176:179], v3, s[12:15], s56 offen offset:1024 sc1
  v_cvt_pk_bf16_f32 v36, v48, v49
  v_cvt_pk_bf16_f32 v37, v50, v51
  v_mfma_f32_16x16x32_bf16 v[60:63], v[96:99], a[252:255], v[60:63]
  v_cvt_pk_bf16_f32 v38, v52, v53
  v_cvt_pk_bf16_f32 v39, v54, v55
  v_mfma_f32_16x16x32_bf16 v[64:67], v[88:91], a[224:227], 0
  buffer_store_dwordx4 v[36:39], v3, s[12:15], s59 offen offset:1024 sc1
  v_mfma_f32_16x16x32_bf16 v[64:67], v[92:95], a[240:243], v[64:67]
  v_mfma_f32_16x16x32_bf16 v[64:67], v[96:99], v[76:79], v[64:67]
  buffer_load_dwordx4 v[180:183], v84, s[12:15], s56 offen offset:2048 sc1
  v_mfma_f32_16x16x32_bf16 v[68:71], v[88:91], a[228:231], 0
  v_mfma_f32_16x16x32_bf16 v[68:71], v[92:95], a[244:247], v[68:71]
  v_mfma_f32_16x16x32_bf16 v[68:71], v[96:99], v[80:83], v[68:71]
  s_waitcnt vmcnt(18)
  v_mfma_f32_16x16x32_bf16 v[56:59], v[100:103], v[184:187], v[56:59]
  buffer_load_dwordx4 v[88:91], v3, s[12:15], s56 offen offset:3072 sc1
  v_mfma_f32_16x16x32_bf16 v[56:59], v[104:107], v[188:191], v[56:59]
  v_mfma_f32_16x16x32_bf16 v[56:59], v[108:111], v[192:195], v[56:59]
  s_barrier
  s_cmp_lg_u32 s24, 0
  s_cbranch_scc1 L_fs25
  s_mul_i32 s57, s99, 1152
  s_add_u32 s57, s57, 459264
  s_mov_b64 exec, 1
  buffer_store_dword v5, v6, s[12:15], s57 offen sc1
  s_mov_b64 exec, -1
L_fs25:
  v_cmp_gt_u32 vcc, 1, v12
  s_mov_b32 s58, 0
  s_nop 3
  s_cbranch_vccz L_ok26
L_sp27:
  s_sleep 2
  s_mov_b32 s57, 459136
  buffer_load_dword v12, v11, s[12:15], s57 offen sc1
  s_add_u32 s58, s58, 1
  s_cmp_gt_u32 s58, 400000
  s_cbranch_scc1 L_ok26
  s_waitcnt vmcnt(0)
  v_cmp_gt_u32 vcc, 1, v12
  s_nop 4
  s_cbranch_vccnz L_sp27
L_ok26:
  s_add_u32 m0, s67, 0
  s_nop 0
  buffer_load_dwordx4 v10, s[12:15], s80 offen offset:0 sc1 lds
  buffer_load_dwordx4 v10, s[12:15], s81 offen offset:1024 sc1 lds
  v_mfma_f32_16x16x32_bf16 v[60:63], v[100:103], a[0:3], v[60:63]
  v_mfma_f32_16x16x32_bf16 v[60:63], v[104:107], a[12:15], v[60:63]
  s_add_u32 s56, s56, 4096
  buffer_load_dwordx4 v[92:95], v3, s[12:15], s56 offen offset:0 sc1
  v_mfma_f32_16x16x32_bf16 v[60:63], v[108:111], a[24:27], v[60:63]
  v_mfma_f32_16x16x32_bf16 v[64:67], v[100:103], a[4:7], v[64:67]
  s_add_u32 m0, s67, 2048
  s_nop 0
  buffer_load_dwordx4 v3, s[12:15], s73 offen offset:0 sc1 lds
  v_mfma_f32_16x16x32_bf16 v[64:67], v[104:107], a[16:19], v[64:67]
  v_mfma_f32_16x16x32_bf16 v[64:67], v[108:111], a[28:31], v[64:67]
  buffer_load_dwordx4 v[96:99], v3, s[12:15], s56 offen offset:1024 sc1
  v_mfma_f32_16x16x32_bf16 v[68:71], v[100:103], a[8:11], v[68:71]
  v_mfma_f32_16x16x32_bf16 v[68:71], v[104:107], a[20:23], v[68:71]
  v_mfma_f32_16x16x32_bf16 v[68:71], v[108:111], a[32:35], v[68:71]
  s_waitcnt vmcnt(22) lgkmcnt(1)
  v_mfma_f32_16x16x32_bf16 v[56:59], v[112:115], v[196:199], v[56:59]
  buffer_load_dwordx4 v[100:103], v3, s[12:15], s56 offen offset:2048 sc1
  v_mfma_f32_16x16x32_bf16 v[56:59], v[116:119], v[200:203], v[56:59]
  v_mfma_f32_16x16x32_bf16 v[56:59], v[120:123], v[204:207], v[56:59]
  v_mfma_f32_16x16x32_bf16 v[60:63], v[112:115], a[36:39], v[60:63]
  v_mfma_f32_16x16x32_bf16 v[60:63], v[116:119], a[48:51], v[60:63]
  buffer_load_dwordx4 v[104:107], v3, s[12:15], s56 offen offset:3072 sc1
  v_mfma_f32_16x16x32_bf16 v[60:63], v[120:123], a[60:63], v[60:63]
  v_mfma_f32_16x16x32_bf16 v[64:67], v[112:115], a[40:43], v[64:67]
  v_mfma_f32_16x16x32_bf16 v[64:67], v[116:119], a[52:55], v[64:67]
  v_mfma_f32_16x16x32_bf16 v[64:67], v[120:123], a[64:67], v[64:67]
  s_add_u32 s56, s56, 4096
  ds_read_b128 v[108:111], v7 offset:2048
  v_mfma_f32_16x16x32_bf16 v[68:71], v[112:115], a[44:47], v[68:71]
  v_mfma_f32_16x16x32_bf16 v[68:71], v[116:119], a[56:59], v[68:71]
  v_mfma_f32_16x16x32_bf16 v[68:71], v[120:123], a[68:71], v[68:71]
  s_waitcnt vmcnt(22) lgkmcnt(1)
  v_mfma_f32_16x16x32_bf16 v[56:59], v[124:127], v[208:211], v[56:59]
  ds_read_b128 v[112:115], v7 offset:3072
  v_mfma_f32_16x16x32_bf16 v[56:59], v[128:131], v[212:215], v[56:59]
  v_mfma_f32_16x16x32_bf16 v[56:59], v[132:135], v[216:219], v[56:59]
  v_mfma_f32_16x16x32_bf16 v[60:63], v[124:127], a[72:75], v[60:63]
  v_mfma_f32_16x16x32_bf16 v[60:63], v[128:131], a[84:87], v[60:63]
  buffer_load_dwordx4 v[116:119], v3, s[12:15], s56 offen offset:2048 sc1
  v_mfma_f32_16x16x32_bf16 v[60:63], v[132:135], a[96:99], v[60:63]
  v_mfma_f32_16x16x32_bf16 v[64:67], v[124:127], a[76:79], v[64:67]
  s_barrier
  v_mfma_f32_16x16x32_bf16 v[64:67], v[128:131], a[88:91], v[64:67]
  v_mfma_f32_16x16x32_bf16 v[64:67], v[132:135], a[100:103], v[64:67]
  buffer_load_dwordx4 v[120:123], v3, s[12:15], s56 offen offset:3072 sc1
  v_mfma_f32_16x16x32_bf16 v[68:71], v[124:127], a[80:83], v[68:71]
  v_mfma_f32_16x16x32_bf16 v[68:71], v[128:131], a[92:95], v[68:71]
  v_mfma_f32_16x16x32_bf16 v[68:71], v[132:135], a[104:107], v[68:71]
  s_waitcnt vmcnt(21)
  v_mfma_f32_16x16x32_bf16 v[56:59], v[136:139], v[220:223], v[56:59]
  s_add_u32 s56, s56, 4096
  buffer_load_dwordx4 v[124:127], v3, s[12:15], s56 offen offset:0 sc1
  v_mfma_f32_16x16x32_bf16 v[56:59], v[140:143], v[224:227], v[56:59]
  v_mfma_f32_16x16x32_bf16 v[56:59], v[144:147], v[228:231], v[56:59]
  v_mfma_f32_16x16x32_bf16 v[60:63], v[136:139], a[108:111], v[60:63]
  v_mfma_f32_16x16x32_bf16 v[60:63], v[140:143], a[120:123], v[60:63]
  buffer_load_dwordx4 v[128:131], v3, s[12:15], s56 offen offset:1024 sc1
  v_mfma_f32_16x16x32_bf16 v[60:63], v[144:147], a[132:135], v[60:63]
  v_mfma_f32_16x16x32_bf16 v[64:67], v[136:139], a[112:115], v[64:67]
  v_mfma_f32_16x16x32_bf16 v[64:67], v[140:143], a[124:127], v[64:67]
PAD_11:
  s_cbranch_execz WRET_2
  v_mfma_f32_16x16x32_bf16 v[64:67], v[144:147], a[136:139], v[64:67]
  buffer_load_dwordx4 v[132:135], v3, s[12:15], s56 offen offset:2048 sc1
  v_mfma_f32_16x16x32_bf16 v[68:71], v[136:139], a[116:119], v[68:71]
  v_mfma_f32_16x16x32_bf16 v[68:71], v[140:143], a[128:131], v[68:71]
  v_mfma_f32_16x16x32_bf16 v[68:71], v[144:147], a[140:143], v[68:71]
  s_waitcnt vmcnt(21)
  v_mfma_f32_16x16x32_bf16 v[56:59], v[148:151], v[232:235], v[56:59]
  buffer_load_dwordx4 v[136:139], v3, s[12:15], s56 offen offset:3072 sc1
  v_mfma_f32_16x16x32_bf16 v[56:59], v[152:155], v[236:239], v[56:59]
  v_mfma_f32_16x16x32_bf16 v[56:59], v[156:159], v[240:243], v[56:59]
  v_mfma_f32_16x16x32_bf16 v[60:63], v[148:151], a[144:147], v[60:63]
  v_mfma_f32_16x16x32_bf16 v[60:63], v[152:155], a[156:159], v[60:63]
  s_add_u32 s56, s56, 4096
  buffer_load_dwordx4 v[140:143], v3, s[12:15], s56 offen offset:0 sc1
  v_mfma_f32_16x16x32_bf16 v[60:63], v[156:159], a[168:171], v[60:63]
  v_mfma_f32_16x16x32_bf16 v[64:67], v[148:151], a[148:151], v[64:67]
  v_mfma_f32_16x16x32_bf16 v[64:67], v[152:155], a[160:163], v[64:67]
  v_mfma_f32_16x16x32_bf16 v[64:67], v[156:159], a[172:175], v[64:67]
  buffer_load_dwordx4 v[144:147], v3, s[12:15], s56 offen offset:1024 sc1
  v_mfma_f32_16x16x32_bf16 v[68:71], v[148:151], a[152:155], v[68:71]
  v_mfma_f32_16x16x32_bf16 v[68:71], v[152:155], a[164:167], v[68:71]
  v_mfma_f32_16x16x32_bf16 v[68:71], v[156:159], a[176:179], v[68:71]
  s_waitcnt vmcnt(21)
  v_mfma_f32_16x16x32_bf16 v[56:59], v[160:163], v[244:247], v[56:59]
  buffer_load_dwordx4 v[148:151], v3, s[12:15], s56 offen offset:2048 sc1
  v_mfma_f32_16x16x32_bf16 v[56:59], v[164:167], v[248:251], v[56:59]
  v_mfma_f32_16x16x32_bf16 v[56:59], v[168:171], v[252:255], v[56:59]
  v_mfma_f32_16x16x32_bf16 v[60:63], v[160:163], a[180:183], v[60:63]
  v_mfma_f32_16x16x32_bf16 v[60:63], v[164:167], a[192:195], v[60:63]
  buffer_load_dwordx4 v[152:155], v3, s[12:15], s56 offen offset:3072 sc1
  v_mfma_f32_16x16x32_bf16 v[60:63], v[168:171], a[204:207], v[60:63]
  v_mfma_f32_16x16x32_bf16 v[64:67], v[160:163], a[184:187], v[64:67]
  v_mfma_f32_16x16x32_bf16 v[64:67], v[164:167], a[196:199], v[64:67]
  v_mfma_f32_16x16x32_bf16 v[64:67], v[168:171], a[208:211], v[64:67]
  s_add_u32 s56, s56, 4096
  buffer_load_dwordx4 v[156:159], v3, s[12:15], s56 offen offset:0 sc1
  v_mfma_f32_16x16x32_bf16 v[68:71], v[160:163], a[188:191], v[68:71]
  v_mfma_f32_16x16x32_bf16 v[68:71], v[164:167], a[200:203], v[68:71]
  v_mfma_f32_16x16x32_bf16 v[68:71], v[168:171], a[212:215], v[68:71]
  s_waitcnt vmcnt(19)
  v_mfma_f32_16x16x32_bf16 v[40:43], v[172:175], a[216:219], 0
  s_mov_b32 s56, s92
  buffer_load_dwordx4 v[160:163], v3, s[12:15], s56 offen offset:0 sc1
  s_add_u32 s59, s29, 6
  s_and_b32 s59, s59, 7
  s_lshl_b32 s59, s59, 16
  s_add_u32 s59, s59, s35
  v_mfma_f32_16x16x32_bf16 v[40:43], v[176:179], a[232:235], v[40:43]
  v_cvt_pk_bf16_f32 v32, v56, v57
  v_cvt_pk_bf16_f32 v33, v58, v59
  v_mfma_f32_16x16x32_bf16 v[40:43], v[180:183], a[248:251], v[40:43]
  s_barrier
  v_cvt_pk_bf16_f32 v34, v60, v61
  v_cvt_pk_bf16_f32 v35, v62, v63
  v_mfma_f32_16x16x32_bf16 v[44:47], v[172:175], a[220:223], 0
  buffer_store_dwordx4 v[32:35], v3, s[12:15], s59 offen offset:0 sc1
  v_mfma_f32_16x16x32_bf16 v[44:47], v[176:179], a[236:239], v[44:47]
  buffer_load_dwordx4 v[164:167], v3, s[12:15], s56 offen offset:1024 sc1
  v_cvt_pk_bf16_f32 v36, v64, v65
  v_cvt_pk_bf16_f32 v37, v66, v67
  v_mfma_f32_16x16x32_bf16 v[44:47], v[180:183], a[252:255], v[44:47]
  v_cvt_pk_bf16_f32 v38, v68, v69
  v_cvt_pk_bf16_f32 v39, v70, v71
  v_mfma_f32_16x16x32_bf16 v[48:51], v[172:175], a[224:227], 0
  buffer_store_dwordx4 v[36:39], v3, s[12:15], s59 offen offset:1024 sc1
  v_mfma_f32_16x16x32_bf16 v[48:51], v[176:179], a[240:243], v[48:51]
  s_mov_b32 s60, 0xbeeff558
  s_lshl_b32 s3, s24, 1
  v_lshrrev_b32 v31, 1, v2
  v_add_u32 v31, s3, v31
  v_mfma_f32_16x16x32_bf16 v[48:51], v[180:183], v[76:79], v[48:51]
  buffer_load_dwordx4 v[168:171], v84, s[12:15], s56 offen offset:2048 sc1
  v_lshrrev_b32 v30, 1, v1
  v_xor_b32 v31, v31, v30
  v_mfma_f32_16x16x32_bf16 v[52:55], v[172:175], a[228:231], 0
  v_and_b32 v30, 8, v22
  v_lshl_add_u32 v31, v31, 4, v30
  v_mfma_f32_16x16x32_bf16 v[52:55], v[176:179], a[244:247], v[52:55]
  v_add_u32 v31, 73728, v31
  v_mfma_f32_16x16x32_bf16 v[52:55], v[180:183], v[80:83], v[52:55]
  v_bfe_u32 v30, v14, 4, 6
  v_lshl_add_u32 v30, v30, 7, v31
  s_waitcnt vmcnt(18)
  v_mfma_f32_16x16x32_bf16 v[40:43], v[88:91], v[184:187], v[40:43]
  buffer_load_dwordx4 v[172:175], v3, s[12:15], s56 offen offset:3072 sc1
  ds_read_b64 v[26:27], v30
  v_add_u32 v30, 73728, v22
  v_mfma_f32_16x16x32_bf16 v[40:43], v[92:95], v[188:191], v[40:43]
  ds_read_b64 v[28:29], v30
  v_mfma_f32_16x16x32_bf16 v[40:43], v[96:99], v[192:195], v[40:43]
  s_mov_b32 s57, 459264
  buffer_load_dword v12, v9, s[12:15], s57 offen sc1
  buffer_load_dwordx4 v3, s[12:15], s73 offen offset:1024 sc1 lds
  s_add_u32 m0, s67, 4096
  s_nop 0
  buffer_load_dwordx4 v3, s[12:15], s74 offen offset:0 sc1 lds
  v_mfma_f32_16x16x32_bf16 v[44:47], v[88:91], a[0:3], v[44:47]
  v_mfma_f32_16x16x32_bf16 v[44:47], v[92:95], a[12:15], v[44:47]
  s_add_u32 s56, s56, 4096
  buffer_load_dwordx4 v[176:179], v3, s[12:15], s56 offen offset:0 sc1
  s_waitcnt lgkmcnt(1)
  v_lshlrev_b32 v56, 16, v26
  v_and_b32 v57, 0xffff0000, v26
  v_mfma_f32_16x16x32_bf16 v[44:47], v[96:99], a[24:27], v[44:47]
  s_waitcnt lgkmcnt(0)
  v_lshlrev_b32 v30, 16, v28
  v_and_b32 v28, 0xffff0000, v28
  v_mfma_f32_16x16x32_bf16 v[48:51], v[88:91], a[4:7], v[48:51]
  buffer_load_dwordx4 v3, s[12:15], s74 offen offset:1024 sc1 lds
  v_add_f32 v56, v56, v30
  v_add_f32 v57, v57, v28
  v_mfma_f32_16x16x32_bf16 v[48:51], v[92:95], a[16:19], v[48:51]
  v_mul_f32 v56, s60, v56
  v_mul_f32 v57, s60, v57
  v_mfma_f32_16x16x32_bf16 v[48:51], v[96:99], a[28:31], v[48:51]
  buffer_load_dwordx4 v[180:183], v3, s[12:15], s56 offen offset:1024 sc1
  v_lshlrev_b32 v58, 16, v27
  v_and_b32 v59, 0xffff0000, v27
  v_mfma_f32_16x16x32_bf16 v[52:55], v[88:91], a[8:11], v[52:55]
  v_lshlrev_b32 v30, 16, v29
  v_and_b32 v29, 0xffff0000, v29
  v_mfma_f32_16x16x32_bf16 v[52:55], v[92:95], a[20:23], v[52:55]
  v_add_f32 v58, v58, v30
  v_add_f32 v59, v59, v29
  v_mfma_f32_16x16x32_bf16 v[52:55], v[96:99], a[32:35], v[52:55]
  v_mul_f32 v58, s60, v58
  v_mul_f32 v59, s60, v59
  s_waitcnt vmcnt(23)
  v_mfma_f32_16x16x32_bf16 v[40:43], v[100:103], v[196:199], v[40:43]
  buffer_load_dwordx4 v[88:91], v3, s[12:15], s56 offen offset:2048 sc1
  v_bfe_u32 v30, v15, 4, 6
  v_lshl_add_u32 v30, v30, 7, v31
  v_mfma_f32_16x16x32_bf16 v[40:43], v[104:107], v[200:203], v[40:43]
  ds_read_b64 v[26:27], v30
  v_add_u32 v30, 73728, v23
  v_mfma_f32_16x16x32_bf16 v[40:43], v[108:111], v[204:207], v[40:43]
  ds_read_b64 v[28:29], v30
  v_mfma_f32_16x16x32_bf16 v[44:47], v[100:103], a[36:39], v[44:47]
  v_mfma_f32_16x16x32_bf16 v[44:47], v[104:107], a[48:51], v[44:47]
  buffer_load_dwordx4 v[92:95], v3, s[12:15], s56 offen offset:3072 sc1
  v_mfma_f32_16x16x32_bf16 v[44:47], v[108:111], a[60:63], v[44:47]
  s_waitcnt lgkmcnt(1)
  v_lshlrev_b32 v60, 16, v26
  v_and_b32 v61, 0xffff0000, v26
  v_mfma_f32_16x16x32_bf16 v[48:51], v[100:103], a[40:43], v[48:51]
  s_waitcnt lgkmcnt(0)
  v_lshlrev_b32 v30, 16, v28
  v_and_b32 v28, 0xffff0000, v28
  v_mfma_f32_16x16x32_bf16 v[48:51], v[104:107], a[52:55], v[48:51]
  v_add_f32 v60, v60, v30
  v_add_f32 v61, v61, v28
  v_mfma_f32_16x16x32_bf16 v[48:51], v[108:111], a[64:67], v[48:51]
  s_add_u32 s56, s56, 4096
  ds_read_b128 v[96:99], v7 offset:0
  v_mul_f32 v60, s60, v60
  v_mul_f32 v61, s60, v61
  v_mfma_f32_16x16x32_bf16 v[52:55], v[100:103], a[44:47], v[52:55]
  v_lshlrev_b32 v62, 16, v27
  v_and_b32 v63, 0xffff0000, v27
  v_mfma_f32_16x16x32_bf16 v[52:55], v[104:107], a[56:59], v[52:55]
  v_lshlrev_b32 v30, 16, v29
  v_and_b32 v29, 0xffff0000, v29
  v_mfma_f32_16x16x32_bf16 v[52:55], v[108:111], a[68:71], v[52:55]
  v_add_f32 v62, v62, v30
  v_add_f32 v63, v63, v29
  s_waitcnt vmcnt(23)
  v_mfma_f32_16x16x32_bf16 v[40:43], v[112:115], v[208:211], v[40:43]
  ds_read_b128 v[100:103], v7 offset:1024
  v_mul_f32 v62, s60, v62
  v_mul_f32 v63, s60, v63
  v_mfma_f32_16x16x32_bf16 v[40:43], v[116:119], v[212:215], v[40:43]
  v_bfe_u32 v30, v16, 4, 6
  v_lshl_add_u32 v30, v30, 7, v31
  v_mfma_f32_16x16x32_bf16 v[40:43], v[120:123], v[216:219], v[40:43]
  ds_read_b64 v[26:27], v30
  v_add_u32 v30, 73728, v24
  v_mfma_f32_16x16x32_bf16 v[44:47], v[112:115], a[72:75], v[44:47]
  ds_read_b64 v[28:29], v30
  v_mfma_f32_16x16x32_bf16 v[44:47], v[116:119], a[84:87], v[44:47]
  buffer_load_dwordx4 v[104:107], v3, s[12:15], s56 offen offset:2048 sc1
  v_mfma_f32_16x16x32_bf16 v[44:47], v[120:123], a[96:99], v[44:47]
  v_mfma_f32_16x16x32_bf16 v[48:51], v[112:115], a[76:79], v[48:51]
  s_barrier
  s_waitcnt lgkmcnt(1)
  v_lshlrev_b32 v64, 16, v26
  v_and_b32 v65, 0xffff0000, v26
  v_mfma_f32_16x16x32_bf16 v[48:51], v[116:119], a[88:91], v[48:51]
  s_waitcnt lgkmcnt(0)
  v_lshlrev_b32 v30, 16, v28
  v_and_b32 v28, 0xffff0000, v28
  v_mfma_f32_16x16x32_bf16 v[48:51], v[120:123], a[100:103], v[48:51]
  buffer_load_dwordx4 v[108:111], v3, s[12:15], s56 offen offset:3072 sc1
  v_add_f32 v64, v64, v30
  v_add_f32 v65, v65, v28
  v_mfma_f32_16x16x32_bf16 v[52:55], v[112:115], a[80:83], v[52:55]
  v_mul_f32 v64, s60, v64
  v_mul_f32 v65, s60, v65
  v_mfma_f32_16x16x32_bf16 v[52:55], v[116:119], a[92:95], v[52:55]
  v_lshlrev_b32 v66, 16, v27
  v_and_b32 v67, 0xffff0000, v27
  v_mfma_f32_16x16x32_bf16 v[52:55], v[120:123], a[104:107], v[52:55]
  v_lshlrev_b32 v30, 16, v29
  v_and_b32 v29, 0xffff0000, v29
  s_waitcnt vmcnt(22)
  v_mfma_f32_16x16x32_bf16 v[40:43], v[124:127], v[220:223], v[40:43]
  s_add_u32 s56, s56, 4096
  buffer_load_dwordx4 v[112:115], v3, s[12:15], s56 offen offset:0 sc1
  v_add_f32 v66, v66, v30
  v_add_f32 v67, v67, v29
  v_mfma_f32_16x16x32_bf16 v[40:43], v[128:131], v[224:227], v[40:43]
  v_mul_f32 v66, s60, v66
  v_mul_f32 v67, s60, v67
  v_mfma_f32_16x16x32_bf16 v[40:43], v[132:135], v[228:231], v[40:43]
  v_bfe_u32 v30, v17, 4, 6
  v_lshl_add_u32 v30, v30, 7, v31
  v_mfma_f32_16x16x32_bf16 v[44:47], v[124:127], a[108:111], v[44:47]
  ds_read_b64 v[26:27], v30
  v_add_u32 v30, 73728, v25
  v_mfma_f32_16x16x32_bf16 v[44:47], v[128:131], a[120:123], v[44:47]
  buffer_load_dwordx4 v[116:119], v3, s[12:15], s56 offen offset:1024 sc1
  ds_read_b64 v[28:29], v30
  v_mfma_f32_16x16x32_bf16 v[44:47], v[132:135], a[132:135], v[44:47]
  v_mfma_f32_16x16x32_bf16 v[48:51], v[124:127], a[112:115], v[48:51]
  v_mfma_f32_16x16x32_bf16 v[48:51], v[128:131], a[124:127], v[48:51]
  s_waitcnt lgkmcnt(1)
  v_lshlrev_b32 v68, 16, v26
  v_and_b32 v69, 0xffff0000, v26
  v_mfma_f32_16x16x32_bf16 v[48:51], v[132:135], a[136:139], v[48:51]
  buffer_load_dwordx4 v[120:123], v3, s[12:15], s56 offen offset:2048 sc1
  s_waitcnt lgkmcnt(0)
  v_lshlrev_b32 v30, 16, v28
  v_and_b32 v28, 0xffff0000, v28
  v_mfma_f32_16x16x32_bf16 v[52:55], v[124:127], a[116:119], v[52:55]
  v_add_f32 v68, v68, v30
  v_add_f32 v69, v69, v28
  v_mfma_f32_16x16x32_bf16 v[52:55], v[128:131], a[128:131], v[52:55]
  v_mul_f32 v68, s60, v68
  v_mul_f32 v69, s60, v69
  v_mfma_f32_16x16x32_bf16 v[52:55], v[132:135], a[140:143], v[52:55]
  v_lshlrev_b32 v70, 16, v27
  v_and_b32 v71, 0xffff0000, v27
  s_waitcnt vmcnt(22)
  v_mfma_f32_16x16x32_bf16 v[40:43], v[136:139], v[232:235], v[40:43]
  buffer_load_dwordx4 v[124:127], v3, s[12:15], s56 offen offset:3072 sc1
  v_lshlrev_b32 v30, 16, v29
  v_and_b32 v29, 0xffff0000, v29
  v_mfma_f32_16x16x32_bf16 v[40:43], v[140:143], v[236:239], v[40:43]
  v_add_f32 v70, v70, v30
  v_add_f32 v71, v71, v29
  v_mfma_f32_16x16x32_bf16 v[40:43], v[144:147], v[240:243], v[40:43]
  v_mul_f32 v70, s60, v70
  v_mul_f32 v71, s60, v71
  v_mfma_f32_16x16x32_bf16 v[44:47], v[136:139], a[144:147], v[44:47]
  v_mfma_f32_16x16x32_bf16 v[44:47], v[140:143], a[156:159], v[44:47]
  s_add_u32 s56, s56, 4096
  buffer_load_dwordx4 v[128:131], v3, s[12:15], s56 offen offset:0 sc1
  v_mfma_f32_16x16x32_bf16 v[44:47], v[144:147], a[168:171], v[44:47]
  v_mfma_f32_16x16x32_bf16 v[48:51], v[136:139], a[148:151], v[48:51]
  v_mfma_f32_16x16x32_bf16 v[48:51], v[140:143], a[160:163], v[48:51]
  v_mfma_f32_16x16x32_bf16 v[48:51], v[144:147], a[172:175], v[48:51]
  buffer_load_dwordx4 v[132:135], v3, s[12:15], s56 offen offset:1024 sc1
  v_mfma_f32_16x16x32_bf16 v[52:55], v[136:139], a[152:155], v[52:55]
  v_mfma_f32_16x16x32_bf16 v[52:55], v[140:143], a[164:167], v[52:55]
  v_mfma_f32_16x16x32_bf16 v[52:55], v[144:147], a[176:179], v[52:55]
  s_waitcnt vmcnt(22)
  v_mfma_f32_16x16x32_bf16 v[40:43], v[148:151], v[244:247], v[40:43]
  buffer_load_dwordx4 v[136:139], v3, s[12:15], s56 offen offset:2048 sc1
  v_mfma_f32_16x16x32_bf16 v[40:43], v[152:155], v[248:251], v[40:43]
  v_mfma_f32_16x16x32_bf16 v[40:43], v[156:159], v[252:255], v[40:43]
  v_mfma_f32_16x16x32_bf16 v[44:47], v[148:151], a[180:183], v[44:47]
  v_mfma_f32_16x16x32_bf16 v[44:47], v[152:155], a[192:195], v[44:47]
  buffer_load_dwordx4 v[140:143], v3, s[12:15], s56 offen offset:3072 sc1
  v_mfma_f32_16x16x32_bf16 v[44:47], v[156:159], a[204:207], v[44:47]
  v_mfma_f32_16x16x32_bf16 v[48:51], v[148:151], a[184:187], v[48:51]
  v_mfma_f32_16x16x32_bf16 v[48:51], v[152:155], a[196:199], v[48:51]
  v_mfma_f32_16x16x32_bf16 v[48:51], v[156:159], a[208:211], v[48:51]
  s_add_u32 s56, s56, 4096
  buffer_load_dwordx4 v[144:147], v3, s[12:15], s56 offen offset:0 sc1
  v_mfma_f32_16x16x32_bf16 v[52:55], v[148:151], a[188:191], v[52:55]
  v_mfma_f32_16x16x32_bf16 v[52:55], v[152:155], a[200:203], v[52:55]
  v_mfma_f32_16x16x32_bf16 v[52:55], v[156:159], a[212:215], v[52:55]
  s_waitcnt vmcnt(20)
  v_mfma_f32_16x16x32_bf16 v[56:59], v[160:163], a[216:219], v[56:59]
  s_add_u32 s59, s29, 7
  s_and_b32 s59, s59, 7
  s_lshl_b32 s59, s59, 16
  s_add_u32 s59, s59, s35
  v_mfma_f32_16x16x32_bf16 v[56:59], v[164:167], a[232:235], v[56:59]
  v_cvt_pk_bf16_f32 v32, v40, v41
  v_cvt_pk_bf16_f32 v33, v42, v43
  v_mfma_f32_16x16x32_bf16 v[56:59], v[168:171], a[248:251], v[56:59]
  v_cvt_pk_bf16_f32 v34, v44, v45
  v_cvt_pk_bf16_f32 v35, v46, v47
  v_mfma_f32_16x16x32_bf16 v[60:63], v[160:163], a[220:223], v[60:63]
  buffer_store_dwordx4 v[32:35], v3, s[12:15], s59 offen offset:0 sc1
  v_mfma_f32_16x16x32_bf16 v[60:63], v[164:167], a[236:239], v[60:63]
  v_cvt_pk_bf16_f32 v36, v48, v49
  v_cvt_pk_bf16_f32 v37, v50, v51
  v_mfma_f32_16x16x32_bf16 v[60:63], v[168:171], a[252:255], v[60:63]
  v_cvt_pk_bf16_f32 v38, v52, v53
  v_cvt_pk_bf16_f32 v39, v54, v55
  v_mfma_f32_16x16x32_bf16 v[64:67], v[160:163], a[224:227], v[64:67]
  buffer_store_dwordx4 v[36:39], v3, s[12:15], s59 offen offset:1024 sc1
  v_mfma_f32_16x16x32_bf16 v[64:67], v[164:167], a[240:243], v[64:67]
  v_and_b32 v27, 1, v2
  v_lshlrev_b32 v27, 4, v27
  v_mfma_f32_16x16x32_bf16 v[64:67], v[168:171], v[76:79], v[64:67]
  v_lshrrev_b32 v28, 1, v2
  v_lshlrev_b32 v28, 4, v28
  v_mfma_f32_16x16x32_bf16 v[68:71], v[160:163], a[228:231], v[68:71]
  v_bfe_u32 v26, v14, 4, 6
  v_xor_b32 v26, v26, v27
  v_mfma_f32_16x16x32_bf16 v[68:71], v[164:167], a[244:247], v[68:71]
  s_waitcnt vmcnt(20)
  v_cmp_gt_u32 vcc, 1, v12
  s_mov_b32 s58, 0
  s_nop 3
  s_cbranch_vccz L_ok28
L_sp29:
  s_sleep 2
  s_mov_b32 s57, 459264
  buffer_load_dword v12, v9, s[12:15], s57 offen sc1
  s_add_u32 s58, s58, 1
  s_cmp_gt_u32 s58, 400000
  s_cbranch_scc1 L_ok28
  s_waitcnt vmcnt(0)
  v_cmp_gt_u32 vcc, 1, v12
  s_nop 4
  s_cbranch_vccnz L_sp29
L_ok28:
  v_mul_u32_u24 v26, 1152, v26
  v_add_u32 v22, v26, v28
  v_mfma_f32_16x16x32_bf16 v[68:71], v[168:171], v[80:83], v[68:71]
  v_bfe_u32 v26, v16, 4, 6
  v_xor_b32 v26, v26, v27
  s_waitcnt vmcnt(15)
  v_mfma_f32_16x16x32_bf16 v[56:59], v[172:175], v[184:187], v[56:59]
  v_mul_u32_u24 v26, 1152, v26
  v_add_u32 v23, v26, v28
  v_mfma_f32_16x16x32_bf16 v[56:59], v[176:179], v[188:191], v[56:59]
  v_and_b32 v26, 7, v0
  v_and_b32 v27, 8, v0
  v_mfma_f32_16x16x32_bf16 v[56:59], v[180:183], v[192:195], v[56:59]
  buffer_load_dwordx4 a[232:235], v3, s[12:15], s75 offen offset:0 sc1
  v_lshlrev_b32 v27, 1, v27
  v_lshl_add_u32 v27, v2, 2, v27
  v_mfma_f32_16x16x32_bf16 v[60:63], v[172:175], a[0:3], v[60:63]
  v_mul_u32_u24 v28, 1152, v26
  v_add_u32 v15, v28, v27
  v_mfma_f32_16x16x32_bf16 v[60:63], v[176:179], a[12:15], v[60:63]
  s_lshl_b32 s0, s24, 5
  s_add_u32 s0, s0, 90112
  v_mfma_f32_16x16x32_bf16 v[60:63], v[180:183], a[24:27], v[60:63]
  v_lshl_add_u32 v28, v26, 7, v27
  v_add_u32 v28, s0, v28
  v_mfma_f32_16x16x32_bf16 v[64:67], v[172:175], a[4:7], v[64:67]
  buffer_load_dwordx4 a[236:239], v3, s[12:15], s75 offen offset:1024 sc1
  ds_read_b32 v24, v28
  v_lshlrev_b32 v28, 2, v2
  v_mfma_f32_16x16x32_bf16 v[64:67], v[176:179], a[16:19], v[64:67]
  s_lshl_b32 s0, s24, 8
  s_add_u32 s0, s0, 90112
  v_mfma_f32_16x16x32_bf16 v[64:67], v[180:183], a[28:31], v[64:67]
  v_lshl_add_u32 v28, v1, 4, v28
  v_add_u32 v28, s0, v28
  v_mfma_f32_16x16x32_bf16 v[68:71], v[172:175], a[8:11], v[68:71]
  ds_read_b32 v25, v28 offset:1024
  v_mfma_f32_16x16x32_bf16 v[68:71], v[176:179], a[20:23], v[68:71]
  buffer_load_dwordx4 a[240:243], v3, s[12:15], s76 offen offset:0 sc1
  v_mfma_f32_16x16x32_bf16 v[68:71], v[180:183], a[32:35], v[68:71]
  ds_read_b128 v[72:75], v8
  s_waitcnt vmcnt(16)
  v_mfma_f32_16x16x32_bf16 v[56:59], v[88:91], v[196:199], v[56:59]
  ds_read_b128 v[18:21], v8 offset:1024
  v_mfma_f32_16x16x32_bf16 v[56:59], v[92:95], v[200:203], v[56:59]
  s_waitcnt lgkmcnt(3)
  v_lshlrev_b32 v26, 16, v24
  v_and_b32 v27, 0xffff0000, v24
  v_mfma_f32_16x16x32_bf16 v[56:59], v[96:99], v[204:207], v[56:59]
  buffer_load_dwordx4 a[244:247], v3, s[12:15], s76 offen offset:1024 sc1
  s_waitcnt lgkmcnt(2)
  v_lshlrev_b32 v28, 16, v25
  v_and_b32 v29, 0xffff0000, v25
  v_mfma_f32_16x16x32_bf16 v[60:63], v[88:91], a[36:39], v[60:63]
  v_add_f32 v26, v26, v28
  v_add_f32 v27, v27, v29
  v_mfma_f32_16x16x32_bf16 v[60:63], v[92:95], a[48:51], v[60:63]
  s_waitcnt lgkmcnt(1)
  v_lshlrev_b32 v32, 16, v72
  v_and_b32 v33, 0xffff0000, v72
  v_mfma_f32_16x16x32_bf16 v[60:63], v[96:99], a[60:63], v[60:63]
  v_lshlrev_b32 v34, 16, v73
  v_and_b32 v35, 0xffff0000, v73
  v_mfma_f32_16x16x32_bf16 v[64:67], v[88:91], a[40:43], v[64:67]
  v_lshlrev_b32 v36, 16, v74
  v_and_b32 v37, 0xffff0000, v74
  v_mfma_f32_16x16x32_bf16 v[64:67], v[92:95], a[52:55], v[64:67]
  v_lshlrev_b32 v38, 16, v75
  v_and_b32 v39, 0xffff0000, v75
  v_mfma_f32_16x16x32_bf16 v[64:67], v[96:99], a[64:67], v[64:67]
  s_waitcnt lgkmcnt(0)
  v_lshlrev_b32 v28, 16, v18
  v_and_b32 v29, 0xffff0000, v18
  v_mfma_f32_16x16x32_bf16 v[68:71], v[88:91], a[44:47], v[68:71]
  v_add_f32 v32, v32, v28
  v_add_f32 v33, v33, v29
  v_mfma_f32_16x16x32_bf16 v[68:71], v[92:95], a[56:59], v[68:71]
  s_waitcnt vmcnt(4)
  s_barrier
  s_cmp_lg_u32 s24, 0
  s_cbranch_scc1 L_fs30
  s_mul_i32 s57, s99, 1152
  s_add_u32 s57, s57, 459392
  s_mov_b64 exec, 1
  buffer_store_dword v5, v6, s[12:15], s57 offen sc1
  s_mov_b64 exec, -1
L_fs30:
  v_lshlrev_b32 v28, 16, v19
  v_and_b32 v29, 0xffff0000, v19
  v_mfma_f32_16x16x32_bf16 v[68:71], v[96:99], a[68:71], v[68:71]
  v_add_f32 v34, v34, v28
  v_add_f32 v35, v35, v29
  v_mfma_f32_16x16x32_bf16 v[56:59], v[100:103], v[208:211], v[56:59]
  v_lshlrev_b32 v28, 16, v20
  v_and_b32 v29, 0xffff0000, v20
  v_mfma_f32_16x16x32_bf16 v[56:59], v[104:107], v[212:215], v[56:59]
  v_add_f32 v36, v36, v28
  v_add_f32 v37, v37, v29
  v_mfma_f32_16x16x32_bf16 v[56:59], v[108:111], v[216:219], v[56:59]
  v_lshlrev_b32 v28, 16, v21
  v_and_b32 v29, 0xffff0000, v21
  v_mfma_f32_16x16x32_bf16 v[60:63], v[100:103], a[72:75], v[60:63]
  v_add_f32 v38, v38, v28
  v_add_f32 v39, v39, v29
  v_mfma_f32_16x16x32_bf16 v[60:63], v[104:107], a[84:87], v[60:63]
  v_permlane32_swap_b32 v32, v36
  v_permlane32_swap_b32 v33, v37
  v_mfma_f32_16x16x32_bf16 v[60:63], v[108:111], a[96:99], v[60:63]
  v_permlane32_swap_b32 v34, v38
  v_permlane32_swap_b32 v35, v39
  v_mfma_f32_16x16x32_bf16 v[64:67], v[100:103], a[76:79], v[64:67]
  v_add_f32 v32, v32, v36
  v_add_f32 v33, v33, v37
  v_mfma_f32_16x16x32_bf16 v[64:67], v[104:107], a[88:91], v[64:67]
  v_add_f32 v34, v34, v38
  v_add_f32 v35, v35, v39
  v_mfma_f32_16x16x32_bf16 v[64:67], v[108:111], a[100:103], v[64:67]
  v_mfma_f32_16x16x32_bf16 v[68:71], v[100:103], a[80:83], v[68:71]
  v_permlane16_swap_b32 v32, v34
  v_permlane16_swap_b32 v33, v35
  v_mfma_f32_16x16x32_bf16 v[68:71], v[104:107], a[92:95], v[68:71]
  v_add_f32 v32, v32, v34
  v_add_f32 v33, v33, v35
  v_mfma_f32_16x16x32_bf16 v[68:71], v[108:111], a[104:107], v[68:71]
  v_fmac_f32 v26, 0xc0088e99, v32
  v_fmac_f32 v27, 0xc0088e99, v33
  v_mfma_f32_16x16x32_bf16 v[56:59], v[112:115], v[220:223], v[56:59]
  v_cvt_pk_bf16_f32 v24, v26, v27
  v_mfma_f32_16x16x32_bf16 v[56:59], v[116:119], v[224:227], v[56:59]
  v_lshrrev_b32 v26, 2, v1
  v_cmp_eq_u32 s[0:1], v26, v2
  v_mfma_f32_16x16x32_bf16 v[56:59], v[120:123], v[228:231], v[56:59]
  v_and_b32 v27, 1, v0
  v_lshlrev_b32 v27, 4, v27
  v_mfma_f32_16x16x32_bf16 v[60:63], v[112:115], a[108:111], v[60:63]
  v_mov_b32 v26, 0x3f80
  v_lshlrev_b32 v26, v27, v26
  v_mfma_f32_16x16x32_bf16 v[60:63], v[116:119], a[120:123], v[60:63]
  v_cndmask_b32 v26, 0, v26, s[0:1]
  v_and_b32 v27, 2, v0
  v_mfma_f32_16x16x32_bf16 v[60:63], v[120:123], a[132:135], v[60:63]
  v_cmp_eq_u32 s[0:1], 0, v27
  v_mov_b32 v30, 0
  v_mfma_f32_16x16x32_bf16 v[64:67], v[112:115], a[112:115], v[64:67]
  v_mov_b32 v31, 0
  v_mov_b32 v27, 0
  v_mfma_f32_16x16x32_bf16 v[64:67], v[116:119], a[124:127], v[64:67]
  v_cndmask_b32 v28, 0, v26, s[0:1]
  v_cndmask_b32 v29, v26, 0, s[0:1]
  v_mfma_f32_16x16x32_bf16 v[64:67], v[120:123], a[136:139], v[64:67]
  v_mov_b32 v26, 0
  v_mfma_f32_16x16x32_bf16 v[68:71], v[112:115], a[116:119], v[68:71]
  v_mfma_f32_16x16x32_bf16 v[68:71], v[116:119], a[128:131], v[68:71]
  ds_read_b128 a[216:219], v8 offset:2048
  v_mfma_f32_16x16x32_bf16 v[68:71], v[120:123], a[140:143], v[68:71]
  ds_read_b128 a[220:223], v8 offset:3072
  v_mfma_f32_16x16x32_bf16 v[56:59], v[124:127], v[232:235], v[56:59]
  ds_read_b128 a[224:227], v8 offset:4096
  v_mfma_f32_16x16x32_bf16 v[56:59], v[128:131], v[236:239], v[56:59]
  ds_read_b128 a[228:231], v8 offset:5120
  v_mfma_f32_16x16x32_bf16 v[56:59], v[132:135], v[240:243], v[56:59]
  s_mov_b32 s57, 459392
  buffer_load_dword v12, v4, s[12:15], s57 offen sc1
  v_mfma_f32_16x16x32_bf16 v[60:63], v[124:127], a[144:147], v[60:63]
  v_mfma_f32_16x16x32_bf16 v[60:63], v[128:131], a[156:159], v[60:63]
  v_mfma_f32_16x16x32_bf16 v[60:63], v[132:135], a[168:171], v[60:63]
  v_mfma_f32_16x16x32_bf16 v[64:67], v[124:127], a[148:151], v[64:67]
  v_mfma_f32_16x16x32_bf16 v[64:67], v[128:131], a[160:163], v[64:67]
  v_mfma_f32_16x16x32_bf16 v[64:67], v[132:135], a[172:175], v[64:67]
  v_mfma_f32_16x16x32_bf16 v[68:71], v[124:127], a[152:155], v[68:71]
  v_mfma_f32_16x16x32_bf16 v[68:71], v[128:131], a[164:167], v[68:71]
  v_mfma_f32_16x16x32_bf16 v[68:71], v[132:135], a[176:179], v[68:71]
  v_mfma_f32_16x16x32_bf16 v[56:59], v[136:139], v[244:247], v[56:59]
  v_mfma_f32_16x16x32_bf16 v[56:59], v[140:143], v[248:251], v[56:59]
  v_mfma_f32_16x16x32_bf16 v[56:59], v[144:147], v[252:255], v[56:59]
  v_mfma_f32_16x16x32_bf16 v[60:63], v[136:139], a[180:183], v[60:63]
  v_mfma_f32_16x16x32_bf16 v[60:63], v[140:143], a[192:195], v[60:63]
  v_mfma_f32_16x16x32_bf16 v[60:63], v[144:147], a[204:207], v[60:63]
  v_mfma_f32_16x16x32_bf16 v[64:67], v[136:139], a[184:187], v[64:67]
  v_mfma_f32_16x16x32_bf16 v[64:67], v[140:143], a[196:199], v[64:67]
  v_mfma_f32_16x16x32_bf16 v[64:67], v[144:147], a[208:211], v[64:67]
  v_mfma_f32_16x16x32_bf16 v[68:71], v[136:139], a[188:191], v[68:71]
  v_mfma_f32_16x16x32_bf16 v[68:71], v[140:143], a[200:203], v[68:71]
  v_mfma_f32_16x16x32_bf16 v[68:71], v[144:147], a[212:215], v[68:71]
  buffer_store_dword v24, v15, s[16:19], s65 offen
  s_mov_b32 s60, 0xc0088e99
  s_mov_b32 s61, s60
  s_waitcnt vmcnt(1)
  v_cmp_gt_u32 vcc, 1, v12
  s_mov_b32 s58, 0
  s_nop 3
  s_cbranch_vccz L_ok31
L_sp32:
  s_sleep 2
  s_mov_b32 s57, 459392
  buffer_load_dword v12, v4, s[12:15], s57 offen sc1
  s_add_u32 s58, s58, 1
  s_cmp_gt_u32 s58, 400000
  s_cbranch_scc1 L_ok31
  s_waitcnt vmcnt(0)
  v_cmp_gt_u32 vcc, 1, v12
  s_nop 4
  s_cbranch_vccnz L_sp32
L_ok31:
  buffer_load_dwordx4 a[248:251], v3, s[12:15], s77 offen offset:0 sc1
  buffer_load_dwordx4 a[252:255], v3, s[12:15], s77 offen offset:1024 sc1
  buffer_load_dwordx4 v[148:151], v3, s[12:15], s78 offen offset:0 sc1
  buffer_load_dwordx4 v[152:155], v3, s[12:15], s78 offen offset:1024 sc1
  buffer_load_dwordx4 v[156:159], v3, s[12:15], s79 offen offset:0 sc1
  buffer_load_dwordx4 v[160:163], v3, s[12:15], s79 offen offset:1024 sc1
  s_waitcnt lgkmcnt(3)
  v_mfma_f32_16x16x32_bf16 v[56:59], v[28:31], a[216:219], v[56:59]
  v_mfma_f32_16x16x32_bf16 v[60:63], v[26:29], a[216:219], v[60:63]
  s_waitcnt lgkmcnt(2)
  v_mfma_f32_16x16x32_bf16 v[64:67], v[28:31], a[220:223], v[64:67]
  v_mfma_f32_16x16x32_bf16 v[68:71], v[26:29], a[220:223], v[68:71]
  s_waitcnt lgkmcnt(1)
  v_mfma_f32_16x16x32_bf16 v[56:59], v[28:31], a[224:227], v[56:59]
  v_mfma_f32_16x16x32_bf16 v[60:63], v[26:29], a[224:227], v[60:63]
  s_waitcnt lgkmcnt(0)
  v_mfma_f32_16x16x32_bf16 v[64:67], v[28:31], a[228:231], v[64:67]
  v_mfma_f32_16x16x32_bf16 v[68:71], v[26:29], a[228:231], v[68:71]
  v_mfma_f32_16x16x32_bf16 v[56:59], v[28:31], a[232:235], v[56:59]
  v_mfma_f32_16x16x32_bf16 v[60:63], v[26:29], a[232:235], v[60:63]
  v_mfma_f32_16x16x32_bf16 v[64:67], v[28:31], a[236:239], v[64:67]
  v_mfma_f32_16x16x32_bf16 v[68:71], v[26:29], a[236:239], v[68:71]
  v_mfma_f32_16x16x32_bf16 v[56:59], v[28:31], a[240:243], v[56:59]
  v_mfma_f32_16x16x32_bf16 v[60:63], v[26:29], a[240:243], v[60:63]
  v_mfma_f32_16x16x32_bf16 v[64:67], v[28:31], a[244:247], v[64:67]
  v_mfma_f32_16x16x32_bf16 v[68:71], v[26:29], a[244:247], v[68:71]
  s_waitcnt vmcnt(5)
  v_mfma_f32_16x16x32_bf16 v[56:59], v[28:31], a[248:251], v[56:59]
  v_mfma_f32_16x16x32_bf16 v[60:63], v[26:29], a[248:251], v[60:63]
  s_waitcnt vmcnt(4)
  v_mfma_f32_16x16x32_bf16 v[64:67], v[28:31], a[252:255], v[64:67]
  v_mfma_f32_16x16x32_bf16 v[68:71], v[26:29], a[252:255], v[68:71]
  s_waitcnt vmcnt(3)
  v_mfma_f32_16x16x32_bf16 v[56:59], v[28:31], v[148:151], v[56:59]
  v_mfma_f32_16x16x32_bf16 v[60:63], v[26:29], v[148:151], v[60:63]
  s_waitcnt vmcnt(2)
  v_mfma_f32_16x16x32_bf16 v[64:67], v[28:31], v[152:155], v[64:67]
  v_mfma_f32_16x16x32_bf16 v[68:71], v[26:29], v[152:155], v[68:71]
  s_waitcnt vmcnt(1)
  v_mfma_f32_16x16x32_bf16 v[56:59], v[28:31], v[156:159], v[56:59]
  v_mfma_f32_16x16x32_bf16 v[60:63], v[26:29], v[156:159], v[60:63]
  s_waitcnt vmcnt(0)
  v_mfma_f32_16x16x32_bf16 v[64:67], v[28:31], v[160:163], v[64:67]
  v_mfma_f32_16x16x32_bf16 v[68:71], v[26:29], v[160:163], v[68:71]
  s_nop 3
  v_pk_mul_f32 v[56:57], v[56:57], s[60:61]
  v_pk_mul_f32 v[58:59], v[58:59], s[60:61]
  v_pk_mul_f32 v[60:61], v[60:61], s[60:61]
  v_pk_mul_f32 v[62:63], v[62:63], s[60:61]
  v_cvt_pk_bf16_f32 v32, v56, v57
  v_cvt_pk_bf16_f32 v33, v58, v59
  v_cvt_pk_bf16_f32 v34, v60, v61
  v_cvt_pk_bf16_f32 v35, v62, v63
  s_nop 0
  v_permlane16_swap_b32 v32, v34
  v_permlane16_swap_b32 v33, v35
  buffer_store_dwordx4 v[32:35], v22, s[16:19], s62 offen
  v_pk_mul_f32 v[64:65], v[64:65], s[60:61]
  v_pk_mul_f32 v[66:67], v[66:67], s[60:61]
  v_pk_mul_f32 v[68:69], v[68:69], s[60:61]
  v_pk_mul_f32 v[70:71], v[70:71], s[60:61]
  v_cvt_pk_bf16_f32 v36, v64, v65
  v_cvt_pk_bf16_f32 v37, v66, v67
  v_cvt_pk_bf16_f32 v38, v68, v69
  v_cvt_pk_bf16_f32 v39, v70, v71
  s_nop 0
  v_permlane16_swap_b32 v36, v38
  v_permlane16_swap_b32 v37, v39
  buffer_store_dwordx4 v[36:39], v23, s[16:19], s62 offen
CODE_END:
PAD_12:
  s_cbranch_execz WRET_2
  s_endpgm
.section .rodata,"a"
.p2align 6
.amdhsa_kernel parallel_sum__sliding_local_dilated__mixer_s_mlp__prompt_kernel
  .amdhsa_next_free_vgpr 512
  .amdhsa_next_free_sgpr 102
  .amdhsa_accum_offset 256
  .amdhsa_group_segment_fixed_size 0
  .amdhsa_kernarg_size 88
  .amdhsa_user_sgpr_count 2
  .amdhsa_user_sgpr_kernarg_segment_ptr 1
  .amdhsa_system_sgpr_workgroup_id_x 1
.end_amdhsa_kernel
```
